```python
import torch

def _softmax(x, axis=-1):
    return torch.softmax(x, dim=axis)
def _gelu(x):
    return torch.nn.functional.gelu(x, approximate="tanh")
def _silu(x):
    return torch.nn.functional.silu(x)
def _sigmoid(x):
    return torch.sigmoid(x)
def _layernorm(x, axis=-1, eps=1e-5):
    m = x.mean(dim=axis, keepdim=True)
    v = x.var(dim=axis, keepdim=True, unbiased=False)
    return (x - m) / torch.sqrt(v + eps)
def _scatter_add(tgt, idx, src, axis=0):
    return tgt.clone().index_add_(axis, idx, src)
def _segment_sum(src, seg, n):
    out = torch.zeros((n,) + src.shape[1:], dtype=src.dtype)
    return out.index_add_(0, seg, src)
def _pad(x, pw):
    flat = tuple(v for pair in reversed(pw) for v in pair)
    return torch.nn.functional.pad(x, flat)

kernel_name = 'recurrent_scan__sliding_local_dilated__glu_gated_glu__prompt'

def setup_inputs():

    _w = (lambda a: (lambda t: t.to(torch.bfloat16) if t.is_floating_point() else t)(torch.as_tensor(a)))
    def _A_setup():
        B, S, D = 1, 2048, 512
        return {
            "x": _w((lambda *s: torch.randn(*s, dtype=torch.bfloat16) * 0.05)(B, S, D)),
            "wqkv": _w((lambda *s: torch.randn(*s, dtype=torch.bfloat16) * 0.05)(D, 3 * D)),
            "wo": _w((lambda *s: torch.randn(*s, dtype=torch.bfloat16) * 0.05)(D, D)),
        }
    _A_in = _A_setup()

    def _B_setup():
        B, S, D, F = 1, 2048, 512, 1792
        return {
            "x": _w((lambda *s: torch.randn(*s, dtype=torch.bfloat16) * 0.05)(B, S, D)),
            "w_gate": _w((lambda *s: torch.randn(*s, dtype=torch.bfloat16) * 0.05)(D, F)),
            "w_up": _w((lambda *s: torch.randn(*s, dtype=torch.bfloat16) * 0.05)(D, F)),
            "w_down": _w((lambda *s: torch.randn(*s, dtype=torch.bfloat16) * 0.05)(F, D)),
        }
    _B_in = _B_setup()

    return {
        "A_x": _A_in["x"],
        "A_wqkv": _A_in["wqkv"],
        "A_wo": _A_in["wo"],
        "B_x": _B_in["x"],
        "B_w_gate": _B_in["w_gate"],
        "B_w_up": _B_in["w_up"],
        "B_w_down": _B_in["w_down"],
    }

def reference(A_x, A_wqkv, A_wo, B_x, B_w_gate, B_w_up, B_w_down):
    def _A_ref(x, wqkv, wo):
        B, S, D = x.shape
        H = 32; Dh = D // H
        W, dil = 8, 2
        qkv = (lambda x, *d: x.permute(*d))((x @ wqkv).reshape(B, S, 3, H, Dh), 2, 0, 3, 1, 4)
        q, k, v = qkv[0], qkv[1], qkv[2]
        scale = Dh ** -0.5
        pos = torch.arange(S)
        off = torch.arange(W) * dil
        idx = pos[:, None] - off[None, :]
        mask = idx >= 0
        idx_c = torch.where(mask, idx, 0).reshape(-1)
        kg = k[:, :, idx_c, :].reshape(B, H, S, W, Dh)
        vg = v[:, :, idx_c, :].reshape(B, H, S, W, Dh)
        logits = torch.einsum("bhsd,bhswd->bhsw", q, kg) * scale
        logits = torch.where(mask[None, None, :, :], logits, -1e9)
        attn = _softmax(logits, axis=-1)
        o = torch.einsum("bhsw,bhswd->bhsd", attn, vg)
        return (lambda x, *d: x.permute(*d))(o, 0, 2, 1, 3).reshape(B, S, D) @ wo

    def _B_ref(x, w_gate, w_up, w_down):
        g = torch.einsum("bsd,df->bsf", x, w_gate)
        u = torch.einsum("bsd,df->bsf", x, w_up)
        h = _sigmoid(g) * u
        return torch.einsum("bsf,fd->bsd", h, w_down)

    x = A_x
    xn = _layernorm(x, axis=-1)
    s = _A_ref(xn, A_wqkv, A_wo)
    g = _silu(_B_ref(xn, B_w_gate, B_w_up, B_w_down))
    return x + s * g
```

```asm
; @launch grid=(256,1,1) block=(512,1,1) lds=163840
.amdgcn_target "amdgcn-amd-amdhsa--gfx950"
.text
.globl recurrent_scan__sliding_local_dilated__glu_gated_glu__prompt_kernel
.p2align 8
.type recurrent_scan__sliding_local_dilated__glu_gated_glu__prompt_kernel,@function
recurrent_scan__sliding_local_dilated__glu_gated_glu__prompt_kernel:
    s_load_dwordx4 s[4:7], s[0:1], 0
    s_load_dwordx4 s[84:87], s[0:1], 32
    s_load_dwordx2 s[82:83], s[0:1], 16
    s_load_dwordx8 s[88:95], s[0:1], 48
    s_cmp_ge_u32 s2, 256
    s_cbranch_scc1 K_exit
    s_getpc_b64 s[96:97]
PC0:
    s_sub_u32 s96, s96, PC0-recurrent_scan__sliding_local_dilated__glu_gated_glu__prompt_kernel
    s_subb_u32 s97, s97, 0
    v_lshrrev_b32 v52, 3, v0
    v_lshlrev_b32 v52, 7, v52
    v_mov_b32 v53, s97
    v_add_co_u32 v52, vcc, s96, v52
    s_nop 1
    v_addc_co_u32 v53, vcc, 0, v53, vcc
    global_load_dword v33, v[52:53], off
    s_lshr_b32 s98, s2, 3
    s_lshl_b32 s98, s98, 11
    v_lshrrev_b32 v54, 5, v0
    v_lshl_add_u32 v54, v54, 7, s98
    v_min_u32 v54, K_end-recurrent_scan__sliding_local_dilated__glu_gated_glu__prompt_kernel-4, v54
    v_mov_b32 v55, s97
    v_add_co_u32 v54, vcc, s96, v54
    s_nop 1
    v_addc_co_u32 v55, vcc, 0, v55, vcc
    global_load_dword v34, v[54:55], off
    v_and_b32 v1, 63, v0
    v_lshrrev_b32 v2, 6, v0
    s_nop 0
    v_readfirstlane_b32 s36, v2
    s_and_b32 s96, s2, 7
    s_lshr_b32 s97, s2, 3
    v_and_b32 v36, 15, v1
    v_lshrrev_b32 v37, 4, v1
    v_lshrrev_b32 v38, 3, v1
    v_and_b32 v39, 7, v1
    s_lshl_b32 s37, s36, 10
    s_and_b32 s98, s36, 1
    s_lshl_b32 s98, s98, 2
    v_or_b32 v42, s98, v37
    v_xor_b32 v42, v42, v39
    v_lshlrev_b32 v42, 4, v42
    v_lshl_add_u32 v43, v2, 3, v38
    v_lshl_add_u32 v42, v43, 10, v42
    v_mov_b32 v46, 0x80000000
    s_and_b32 s77, s36, 3
    s_lshr_b32 s78, s36, 2
    s_mul_i32 s74, s78, 6
    s_sub_u32 s98, 11, s96
    s_cmp_lt_u32 s96, 4
    s_cselect_b32 s96, s96, s98
    s_mul_i32 s98, s96, 21
    s_mul_i32 s99, s96, 11
    s_add_u32 s96, s98, s97
    s_sub_u32 s96, s96, 11
    s_cmp_lt_u32 s97, 11
    s_cselect_b32 s98, 1, 0
    s_add_u32 s97, s97, s99
    s_cmp_eq_u32 s98, 1
    s_cbranch_scc1 K_qkv
    s_mul_i32 s98, s96, 43691
    s_lshr_b32 s98, s98, 19
    s_mul_i32 s99, s98, 12
    s_sub_u32 s99, s96, s99
    s_lshl_b32 s96, s98, 3
    s_lshl_b32 s98, s98, 2
    s_add_u32 s98, s98, 192
    s_cmp_ge_u32 s99, 8
    s_cselect_b32 s96, s98, s96
    s_add_u32 s96, s96, s99
    s_lshr_b32 s98, s96, 3
    s_and_b32 s99, s96, 7
    s_mul_i32 s3, s99, 11
    s_sub_u32 s97, s96, 200
    s_lshr_b32 s38, s97, 2
    s_and_b32 s97, s97, 3
    s_add_u32 s97, s97, 8
    s_mul_i32 s39, s97, 10
    s_add_u32 s39, s39, 7
    s_max_u32 s58, s74, 1
    s_cmp_ge_u32 s96, 200
    s_cselect_b32 s98, s38, s98
    s_cselect_b32 s99, s97, s99
    s_cselect_b32 s3, s39, s3
    s_cselect_b32 s74, s58, s74
    s_cselect_b32 s39, 2, 0
    s_add_u32 s58, s98, s99
    s_and_b32 s58, s58, 3
    s_bfe_u32 s38, s99, 0x10002
    s_lshl_b32 s38, s38, 1
    s_cmp_eq_u32 s58, 1
    s_cselect_b32 s38, s38, s58
    s_cmp_lt_u32 s99, 8
    s_cselect_b32 s58, s38, s58
    s_lshl_b32 s40, s58, 8
    s_mul_i32 s48, s58, 458752
    s_lshl_b32 s96, s3, 14
    v_add_u32 v4, s96, v42
    v_add_u32 v5, 0x10000, v4
    v_add_u32 v6, 0x20000, v4
    s_cmp_lt_u32 s36, s39
    s_cselect_b64 vcc, -1, 0
    v_cndmask_b32 v4, v4, v46, vcc
    s_cmp_ge_u32 s36, 6
    s_cselect_b64 vcc, -1, 0
    v_cndmask_b32 v6, v6, v46, vcc
    s_bfe_u32 s96, s36, 0x10001
    s_lshl_b32 s96, s96, 2
    v_or_b32 v44, s96, v37
    v_lshrrev_b32 v45, 1, v36
    v_xor_b32 v44, v44, v45
    v_lshlrev_b32 v44, 5, v44
    v_and_b32 v45, 1, v1
    v_lshl_add_u32 v44, v45, 4, v44
    v_lshl_add_u32 v45, v2, 2, v37
    v_mul_u32_u24 v45, 3584, v45
    v_add_u32 v44, v44, v45
    s_lshl_b32 s96, s98, 8
    v_add_u32 v7, s96, v44
    v_lshlrev_b32 v56, 9, v38
    v_lshl_add_u32 v56, v39, 4, v56
    v_mov_b32 v48, 0
    v_mov_b32 v49, 0
    v_mov_b32 v50, 0
    v_mov_b32 v51, 0
    s_lshl_b32 s97, s58, 7
    s_lshl_b32 s64, s98, 12
    s_add_u32 s64, s64, s97
    s_add_u32 s64, s64, 100352
    s_cmp_ge_u32 s99, 8
    s_cselect_b32 s64, s64, 1073741824
    s_mul_i32 s67, s99, 14
    s_add_u32 s67, s67, s98
    s_lshl_b32 s67, s67, 7
    s_waitcnt lgkmcnt(0)
    s_mov_b32 s24, s94
    s_mov_b32 s25, s95
    s_mov_b32 s26, 190464
    s_mov_b32 s27, 0x20000
    s_cmp_lg_u32 s36, 0
    s_cbranch_scc1 K_gz
    buffer_store_dwordx4 v[48:51], v56, s[24:27], s64 offen sc1
    s_mov_b64 exec, 1
    buffer_store_dword v48, v56, s[24:27], s67 offen sc1
    s_mov_b64 exec, -1
K_gz:
    s_mov_b32 s8, s4
    s_mov_b32 s9, s5
    s_mov_b32 s10, 2097152
    s_mov_b32 s11, 0x20000
    s_mov_b32 s12, s84
    s_mov_b32 s13, s85
    s_mov_b32 s14, 1835008
    s_mov_b32 s15, 0x20000
    s_mov_b32 s16, s86
    s_mov_b32 s17, s87
    s_mov_b32 s18, 1835008
    s_mov_b32 s19, 0x20000
    s_add_u32 m0, s37, 40960
    s_nop 0
    buffer_load_dwordx4 v4, s[8:11], s40 offen lds
    s_add_u32 m0, s37, 49152
    s_nop 0
    buffer_load_dwordx4 v5, s[8:11], s40 offen lds
    s_add_u32 m0, s37, 57344
    s_nop 0
    buffer_load_dwordx4 v6, s[8:11], s40 offen lds
    s_add_u32 m0, s37, 98304
    s_add_u32 s38, s48, 0
    buffer_load_dwordx4 v7, s[12:15], s38 offen lds
    s_add_u32 m0, s37, 106496
    s_add_u32 s38, s48, 0
    buffer_load_dwordx4 v7, s[16:19], s38 offen lds
    s_add_u32 m0, s37, 24576
    s_add_u32 s38, s48, 114688
    buffer_load_dwordx4 v7, s[12:15], s38 offen lds
    s_add_u32 m0, s37, 32768
    s_add_u32 s38, s48, 114688
    buffer_load_dwordx4 v7, s[16:19], s38 offen lds
    s_mov_b32 s4, s98
    s_mov_b32 s5, s99
    s_mov_b32 s28, s92
    s_mov_b32 s29, s93
    s_mov_b32 s30, 256
    s_mov_b32 s31, 0x20000
    v_bfe_u32 v40, v1, 2, 2
    v_and_b32 v41, 3, v1
    v_lshrrev_b32 v43, 1, v36
    v_xor_b32 v43, v43, v37
    v_lshlrev_b32 v43, 4, v43
    v_lshl_add_u32 v43, v36, 7, v43
    s_lshl_b32 s96, s74, 11
    v_add_u32 v8, s96, v43
    v_xor_b32 v9, 64, v8
    s_lshl_b32 s96, s77, 1
    v_and_b32 v44, 1, v37
    v_lshl_or_b32 v44, v44, 2, v40
    v_xor_b32 v44, s96, v44
    v_lshlrev_b32 v44, 5, v44
    v_lshl_add_u32 v44, v41, 3, v44
    v_lshl_add_u32 v47, v37, 3, v40
    v_lshl_add_u32 v10, v47, 8, v44
    v_xor_b32 v11, 32, v10
    v_add_u32 v12, 0x10000, v10
    v_add_u32 v13, 0x10000, v11
    s_lshl_b32 s7, s58, 1
    s_add_u32 s6, s7, 1
    s_and_b32 s6, s6, 7
    s_lshl_b32 s41, s6, 7
    s_mul_i32 s49, s6, 229376
    s_add_u32 s6, s7, 2
    s_and_b32 s6, s6, 7
    s_lshl_b32 s42, s6, 7
    s_mul_i32 s50, s6, 229376
    s_add_u32 s6, s7, 3
    s_and_b32 s6, s6, 7
    s_lshl_b32 s43, s6, 7
    s_mul_i32 s51, s6, 229376
    s_add_u32 s6, s7, 4
    s_and_b32 s6, s6, 7
    s_lshl_b32 s44, s6, 7
    s_mul_i32 s52, s6, 229376
    s_add_u32 s6, s7, 5
    s_and_b32 s6, s6, 7
    s_lshl_b32 s45, s6, 7
    s_mul_i32 s53, s6, 229376
    s_add_u32 s6, s7, 6
    s_and_b32 s6, s6, 7
    s_lshl_b32 s46, s6, 7
    s_mul_i32 s54, s6, 229376
    s_add_u32 s6, s7, 7
    s_and_b32 s6, s6, 7
    s_lshl_b32 s47, s6, 7
    s_mul_i32 s55, s6, 229376
    s_barrier
    s_add_u32 m0, s37, 131072
    s_nop 0
    buffer_load_dwordx4 v4, s[8:11], s41 offen lds
    s_add_u32 m0, s37, 139264
    s_nop 0
    buffer_load_dwordx4 v5, s[8:11], s41 offen lds
    s_add_u32 m0, s37, 147456
    s_nop 0
    buffer_load_dwordx4 v6, s[8:11], s41 offen lds
    s_add_u32 m0, s37, 65536
    s_add_u32 s38, s49, 0
    buffer_load_dwordx4 v7, s[12:15], s38 offen lds
    s_cmp_ge_u32 s36, 4
    s_cbranch_scc1 K_glu5
    s_cmp_eq_u32 s74, 1
    s_cbranch_scc1 K_glu5o
    s_branch K_glu6
K_qkv:
    s_mul_i32 s98, s97, 5958
    s_lshr_b32 s98, s98, 16
    s_mul_i32 s99, s98, 11
    s_sub_u32 s99, s97, s99
    s_add_u32 s98, s98, 0
    s_and_b32 s98, s98, 7
    s_add_u32 s58, s98, s99
    s_and_b32 s58, s58, 3
    s_lshl_b32 s40, s58, 8
    s_mul_i32 s48, s58, 393216
    s_mul_i32 s96, s99, 196608
    s_sub_u32 s96, s96, 16384
    v_add_u32 v4, s96, v42
    v_add_u32 v5, 0x10000, v4
    v_add_u32 v6, 0x20000, v4
    v_add_u32 v16, 0x30000, v4
    s_cmp_ge_u32 s36, 2
    s_cselect_b64 vcc, -1, 0
    v_cndmask_b32 v16, v16, v46, vcc
    s_add_u32 s38, s37, 75776
    s_cmp_lt_u32 s36, 2
    s_cselect_b32 s59, s38, 153600
    s_add_u32 s38, s37, 126976
    s_cmp_lt_u32 s36, 2
    s_cselect_b32 s60, s38, 153600
    s_add_u32 s38, s37, 24576
    s_cmp_lt_u32 s36, 2
    s_cselect_b32 s61, s38, 153600
    s_and_b32 s96, s36, 1
    s_lshl_b32 s96, s96, 1
    v_and_b32 v44, 1, v37
    v_or_b32 v44, s96, v44
    v_lshrrev_b32 v45, 1, v39
    v_xor_b32 v44, v44, v45
    v_lshlrev_b32 v44, 5, v44
    v_and_b32 v45, 1, v1
    v_lshl_add_u32 v44, v45, 4, v44
    v_mul_u32_u24 v45, 3072, v43
    v_add_u32 v44, v44, v45
    s_lshl_b32 s96, s98, 7
    v_add_u32 v7, s96, v44
    v_lshlrev_b32 v56, 10, v37
    v_lshl_add_u32 v56, v36, 4, v56
    v_lshlrev_b32 v57, 9, v38
    v_lshl_add_u32 v57, v39, 4, v57
    v_mov_b32 v48, 0
    v_mov_b32 v49, 0
    v_mov_b32 v50, 0
    v_mov_b32 v51, 0
    s_lshl_b32 s97, s58, 8
    s_lshl_b32 s64, s98, 12
    s_add_u32 s64, s64, s97
    s_add_u32 s64, s64, 157696
    s_cmp_lt_u32 s99, 4
    s_cselect_b32 s64, s64, 1073741824
    s_lshl_b32 s62, s99, 1
    s_lshr_b32 s97, s98, 2
    s_add_u32 s62, s62, s97
    s_mul_i32 s62, s62, 3072
    s_lshl_b32 s97, s58, 7
    s_add_u32 s62, s62, s97
    s_add_u32 s62, s62, 32768
    s_lshl_b32 s67, s99, 3
    s_add_u32 s67, s67, s98
    s_add_u32 s67, s67, 168
    s_lshl_b32 s67, s67, 7
    s_waitcnt lgkmcnt(0)
    s_mov_b32 s24, s94
    s_mov_b32 s25, s95
    s_mov_b32 s26, 190464
    s_mov_b32 s27, 0x20000
    s_cmp_lg_u32 s36, 0
    s_cbranch_scc1 K_qz
    buffer_store_dwordx4 v[48:51], v56, s[24:27], s64 offen sc1
    s_mov_b32 exec_hi, 0xffff
    buffer_store_dwordx4 v[48:51], v57, s[24:27], s62 offen sc1
    s_mov_b64 exec, 1
    buffer_store_dword v48, v56, s[24:27], s67 offen sc1
    s_mov_b64 exec, -1
K_qz:
    s_mov_b32 s8, s4
    s_mov_b32 s9, s5
    s_mov_b32 s10, 2097152
    s_mov_b32 s11, 0x20000
    s_mov_b32 s12, s6
    s_mov_b32 s13, s7
    s_mov_b32 s14, 1572864
    s_mov_b32 s15, 0x20000
    s_add_u32 m0, s37, 51200
    s_nop 0
    buffer_load_dwordx4 v4, s[8:11], s40 offen lds
    s_add_u32 m0, s37, 59392
    s_nop 0
    buffer_load_dwordx4 v5, s[8:11], s40 offen lds
    s_add_u32 m0, s37, 67584
    s_nop 0
    buffer_load_dwordx4 v6, s[8:11], s40 offen lds
    s_mov_b32 m0, s59
    s_nop 0
    buffer_load_dwordx4 v16, s[8:11], s40 offen lds
    s_add_u32 m0, s37, 77824
    s_add_u32 s38, s48, 0
    buffer_load_dwordx4 v7, s[12:15], s38 offen lds
    s_add_u32 m0, s37, 86016
    s_add_u32 s38, s48, 1024
    buffer_load_dwordx4 v7, s[12:15], s38 offen lds
    s_add_u32 m0, s37, 94208
    s_add_u32 s38, s48, 2048
    buffer_load_dwordx4 v7, s[12:15], s38 offen lds
    s_mov_b32 s4, s98
    s_mov_b32 s5, s99
    s_mov_b32 s28, s92
    s_mov_b32 s29, s93
    s_mov_b32 s30, 256
    s_mov_b32 s31, 0x20000
    v_bfe_u32 v40, v1, 2, 2
    v_and_b32 v41, 3, v1
    v_lshrrev_b32 v43, 1, v36
    v_xor_b32 v43, v43, v37
    v_lshlrev_b32 v43, 4, v43
    v_lshl_add_u32 v43, v36, 7, v43
    s_lshl_b32 s96, s74, 11
    v_add_u32 v8, s96, v43
    v_xor_b32 v9, 64, v8
    v_and_b32 v44, 1, v37
    v_lshlrev_b32 v44, 1, v44
    v_lshrrev_b32 v47, 1, v40
    v_or_b32 v44, v44, v47
    v_xor_b32 v44, s77, v44
    v_lshlrev_b32 v44, 5, v44
    v_lshl_add_u32 v44, v41, 3, v44
    v_lshl_add_u32 v47, v37, 3, v40
    v_lshl_add_u32 v44, v47, 7, v44
    v_add_u32 v10, 77824, v44
    s_lshl_b32 s7, s58, 1
    s_add_u32 s6, s7, 1
    s_and_b32 s6, s6, 7
    s_lshl_b32 s41, s6, 7
    s_mul_i32 s49, s6, 196608
    s_add_u32 s6, s7, 2
    s_and_b32 s6, s6, 7
    s_lshl_b32 s42, s6, 7
    s_mul_i32 s50, s6, 196608
    s_add_u32 s6, s7, 3
    s_and_b32 s6, s6, 7
    s_lshl_b32 s43, s6, 7
    s_mul_i32 s51, s6, 196608
    s_add_u32 s6, s7, 4
    s_and_b32 s6, s6, 7
    s_lshl_b32 s44, s6, 7
    s_mul_i32 s52, s6, 196608
    s_add_u32 s6, s7, 5
    s_and_b32 s6, s6, 7
    s_lshl_b32 s45, s6, 7
    s_mul_i32 s53, s6, 196608
    s_add_u32 s6, s7, 6
    s_and_b32 s6, s6, 7
    s_lshl_b32 s46, s6, 7
    s_mul_i32 s54, s6, 196608
    s_add_u32 s6, s7, 7
    s_and_b32 s6, s6, 7
    s_lshl_b32 s47, s6, 7
    s_mul_i32 s55, s6, 196608
    s_barrier
    s_add_u32 m0, s37, 102400
    s_nop 0
    buffer_load_dwordx4 v4, s[8:11], s41 offen lds
    s_add_u32 m0, s37, 110592
    s_nop 0
    buffer_load_dwordx4 v5, s[8:11], s41 offen lds
    s_add_u32 m0, s37, 118784
    s_nop 0
    buffer_load_dwordx4 v6, s[8:11], s41 offen lds
    s_mov_b32 m0, s60
    s_nop 0
    buffer_load_dwordx4 v16, s[8:11], s41 offen lds
    s_cmp_ge_u32 s36, 4
    s_cbranch_scc1 K_qkvy
    s_branch K_qkvm
K_glu6:
    s_waitcnt vmcnt(4)
    s_cmp_lg_u32 s36, 0
    s_cbranch_scc1 AR_1
    s_bfe_u32 s96, s2, 0x10003
    s_lshl_b32 s96, s96, 7
    v_mov_b32 v254, 1
    v_mov_b32 v2, 0
    s_mov_b64 exec, 1
    buffer_atomic_add v254, v2, s[28:31], s96 offen sc1
    s_mov_b64 exec, -1
AR_1:
    s_barrier
    ds_read_b64_tr_b16 v[212:213], v12 offset:32768
    ds_read_b64_tr_b16 v[214:215], v12 offset:33792
    ds_read_b128 v[228:231], v8 offset:40960
    ds_read_b128 v[232:235], v8 offset:43008
    ds_read_b128 v[236:239], v8 offset:45056
    ds_read_b128 v[240:243], v8 offset:47104
    ds_read_b128 v[244:247], v8 offset:49152
    ds_read_b128 v[248:251], v8 offset:51200
    ds_read_b64_tr_b16 v[216:217], v12 offset:40960
    ds_read_b64_tr_b16 v[218:219], v12 offset:41984
    ds_read_b64_tr_b16 v[220:221], v13 offset:32768
    ds_read_b64_tr_b16 v[222:223], v13 offset:33792
    ds_read_b64_tr_b16 v[224:225], v13 offset:40960
    ds_read_b64_tr_b16 v[226:227], v13 offset:41984
    v_mov_b32 v16, 0x3f803f80
    v_mov_b32 v17, 0x3f803f80
    v_mov_b32 v18, 0x3f803f80
    v_mov_b32 v19, 0x3f803f80
    s_waitcnt lgkmcnt(0)
    s_setprio 1
    v_mfma_f32_16x16x32_bf16 v[36:39], v[212:215], v[228:231], 0
    s_add_u32 m0, s37, 73728
    s_add_u32 s38, s49, 0
    buffer_load_dwordx4 v7, s[16:19], s38 offen lds
    ds_read_b64_tr_b16 v[156:157], v10 offset:24576
    v_mfma_f32_16x16x32_bf16 v[52:55], v[212:215], v[232:235], 0
    s_add_u32 m0, s37, 81920
    s_add_u32 s38, s49, 114688
    buffer_load_dwordx4 v7, s[12:15], s38 offen lds
    ds_read_b64_tr_b16 v[158:159], v10 offset:25600
    v_mfma_f32_16x16x32_bf16 v[68:71], v[212:215], v[236:239], 0
    s_add_u32 m0, s37, 90112
    s_add_u32 s38, s49, 114688
    buffer_load_dwordx4 v7, s[16:19], s38 offen lds
    ds_read_b128 v[132:135], v9 offset:40960
    v_mfma_f32_16x16x32_bf16 v[84:87], v[212:215], v[240:243], 0
    ds_read_b128 v[136:139], v9 offset:43008
    v_mov_b32 v254, 0x80000000
    v_cmp_eq_u32 vcc, 0, v1
    v_mfma_f32_16x16x32_bf16 v[100:103], v[212:215], v[244:247], 0
    ds_read_b128 v[140:143], v9 offset:45056
    v_mfma_f32_16x16x32_bf16 v[116:119], v[212:215], v[248:251], 0
    ds_read_b128 v[144:147], v9 offset:47104
    v_mov_b32 v25, 1
    v_cndmask_b32 v24, v254, 0, vcc
    v_mfma_f32_16x16x32_bf16 v[40:43], v[216:219], v[228:231], 0
    ds_read_b128 v[148:151], v9 offset:49152
    v_mfma_f32_16x16x32_bf16 v[56:59], v[216:219], v[232:235], 0
    ds_read_b128 v[152:155], v9 offset:51200
    v_mfma_f32_16x16x32_bf16 v[72:75], v[216:219], v[236:239], 0
    ds_read_b64_tr_b16 v[160:161], v10 offset:32768
    v_and_b32 v2, 15, v1
    v_cmp_eq_u32 vcc, 0, v2
    v_mfma_f32_16x16x32_bf16 v[88:91], v[216:219], v[240:243], 0
    ds_read_b64_tr_b16 v[162:163], v10 offset:33792
    v_mfma_f32_16x16x32_bf16 v[104:107], v[216:219], v[244:247], 0
    ds_read_b64_tr_b16 v[164:165], v11 offset:24576
    v_and_b32 v26, 48, v1
    v_cndmask_b32 v23, v254, v26, vcc
    v_mfma_f32_16x16x32_bf16 v[120:123], v[216:219], v[248:251], 0
    s_setprio 0
    ds_read_b64_tr_b16 v[166:167], v11 offset:25600
    v_mfma_f32_16x16x32_bf16 v[44:47], v[220:223], v[228:231], 0
    ds_read_b64_tr_b16 v[168:169], v11 offset:32768
    v_mfma_f32_16x16x32_bf16 v[60:63], v[220:223], v[232:235], 0
    ds_read_b64_tr_b16 v[170:171], v11 offset:33792
    s_lshl_b32 s98, s36, 2
    s_add_u32 s98, s98, 161024
    v_mov_b32 v2, s98
    v_mov_b32 v26, 0
    ds_write_b32 v2, v26
    ds_write_b32 v2, v26 offset:32
    v_mfma_f32_16x16x32_bf16 v[76:79], v[220:223], v[236:239], 0
    v_mfma_f32_16x16x32_bf16 v[92:95], v[220:223], v[240:243], 0
    v_mfma_f32_16x16x32_bf16 v[108:111], v[220:223], v[244:247], 0
    s_lshl_b32 s56, s4, 2
    s_add_u32 s56, s56, s77
    s_lshl_b32 s98, s77, 10
    s_add_u32 s64, s64, s98
    s_lshl_b32 s98, s78, 9
    s_add_u32 s64, s64, s98
    s_cmp_eq_u32 s36, 0
    s_cselect_b32 s67, s67, 1073741824
    v_add_u32 v252, 131072, v8
    v_add_u32 v253, 131072, v9
    v_mfma_f32_16x16x32_bf16 v[124:127], v[220:223], v[248:251], 0
    v_mfma_f32_16x16x32_bf16 v[48:51], v[224:227], v[228:231], 0
    s_add_u32 m0, s37, 0
    s_nop 0
    buffer_load_dwordx4 v4, s[8:11], s42 offen lds
    v_mfma_f32_16x16x32_bf16 v[64:67], v[224:227], v[232:235], 0
    v_mfma_f32_16x16x32_bf16 v[80:83], v[224:227], v[236:239], 0
    v_mfma_f32_16x16x32_bf16 v[96:99], v[224:227], v[240:243], 0
    s_add_u32 m0, s37, 8192
    s_nop 0
    buffer_load_dwordx4 v5, s[8:11], s42 offen lds
    v_mfma_f32_16x16x32_bf16 v[112:115], v[224:227], v[244:247], 0
    v_mfma_f32_16x16x32_bf16 v[128:131], v[224:227], v[248:251], 0
    s_waitcnt lgkmcnt(0)
    s_cmp_ge_u32 s5, 8
    s_cbranch_scc0 SK_2
    v_mfma_f32_16x16x32_bf16 v[204:207], v[212:215], v[16:19], 0
    v_mfma_f32_16x16x32_bf16 v[208:211], v[216:219], v[16:19], 0
    v_mfma_f32_16x16x32_bf16 v[204:207], v[156:159], v[16:19], v[204:207]
    v_mfma_f32_16x16x32_bf16 v[208:211], v[160:163], v[16:19], v[208:211]
SK_2:
    s_barrier
    s_setprio 3
    v_mfma_f32_16x16x32_bf16 v[36:39], v[156:159], v[132:135], v[36:39]
    s_add_u32 m0, s37, 16384
    s_nop 0
    buffer_load_dwordx4 v6, s[8:11], s42 offen lds
    v_mfma_f32_16x16x32_bf16 v[52:55], v[156:159], v[136:139], v[52:55]
    s_add_u32 m0, s37, 114688
    s_add_u32 s38, s50, 0
    buffer_load_dwordx4 v7, s[12:15], s38 offen lds
    v_mfma_f32_16x16x32_bf16 v[68:71], v[156:159], v[140:143], v[68:71]
    s_add_u32 m0, s37, 122880
    s_add_u32 s38, s50, 0
    buffer_load_dwordx4 v7, s[16:19], s38 offen lds
    v_mfma_f32_16x16x32_bf16 v[84:87], v[156:159], v[144:147], v[84:87]
    s_add_u32 m0, s37, 98304
    s_add_u32 s38, s50, 114688
    buffer_load_dwordx4 v7, s[12:15], s38 offen lds
    v_mfma_f32_16x16x32_bf16 v[100:103], v[156:159], v[148:151], v[100:103]
    s_add_u32 m0, s37, 106496
    s_add_u32 s38, s50, 114688
    buffer_load_dwordx4 v7, s[16:19], s38 offen lds
    v_mfma_f32_16x16x32_bf16 v[116:119], v[156:159], v[152:155], v[116:119]
    s_lshl_b32 s98, s56, 10
    s_add_u32 s98, s98, 100352
    v_lshrrev_b32 v254, 5, v1
    v_lshlrev_b32 v254, 9, v254
    v_mfma_f32_16x16x32_bf16 v[40:43], v[160:163], v[132:135], v[40:43]
    v_and_b32 v2, 31, v1
    v_lshl_add_u32 v254, v2, 2, v254
    v_mfma_f32_16x16x32_bf16 v[56:59], v[160:163], v[136:139], v[56:59]
    s_mov_b32 s97, s3
    s_lshl_b32 s99, s77, 2
    s_add_u32 s99, s99, s97
    s_lshl_b32 s99, s99, 9
    s_add_u32 s99, s99, 32768
    v_add_u32 v254, s98, v254
    v_lshrrev_b32 v2, 4, v1
    v_mfma_f32_16x16x32_bf16 v[72:75], v[160:163], v[140:143], v[72:75]
    v_mfma_f32_16x16x32_bf16 v[88:91], v[160:163], v[144:147], v[88:91]
    v_lshlrev_b32 v2, 9, v2
    v_and_b32 v26, 15, v1
    v_mfma_f32_16x16x32_bf16 v[104:107], v[160:163], v[148:151], v[104:107]
    v_lshl_add_u32 v2, v26, 3, v2
    v_add_u32 v2, s99, v2
    v_mfma_f32_16x16x32_bf16 v[120:123], v[160:163], v[152:155], v[120:123]
    s_setprio 2
    s_cmp_ge_u32 s36, 4
    s_cselect_b64 vcc, -1, 0
    v_cndmask_b32 v28, v2, v254, vcc
    v_subrev_u32 v254, 176, v0
    v_mfma_f32_16x16x32_bf16 v[44:47], v[164:167], v[132:135], v[44:47]
    v_mfma_f32_16x16x32_bf16 v[60:63], v[164:167], v[136:139], v[60:63]
    v_cmp_lt_u32 vcc, 79, v254
    v_lshlrev_b32 v3, 4, v1
    s_mov_b64 s[100:101], vcc
    s_mov_b32 s96, s74
    s_add_u32 s96, s96, s97
    s_mul_i32 s96, s96, 73
    s_add_u32 s56, s56, s96
    s_add_u32 s56, s56, 16
    s_lshl_b32 s56, s56, 10
    v_mfma_f32_16x16x32_bf16 v[76:79], v[164:167], v[140:143], v[76:79]
    s_mov_b32 s68, 0x22222222
    s_mov_b32 s69, 0x22222222
    s_mov_b32 s70, 0x44444444
    s_mov_b32 s71, 0x44444444
    s_mov_b32 s72, 0x88888888
    s_mov_b32 s73, 0x88888888
    v_mov_b32 v254, 0x80000000
    v_cmp_gt_u32 vcc, 2, v1
    v_mfma_f32_16x16x32_bf16 v[92:95], v[164:167], v[144:147], v[92:95]
    s_add_u32 s20, s94, 1048576
    s_addc_u32 s21, s95, 0
    s_mov_b32 s22, 9568256
    s_mov_b32 s23, 0x20000
    v_lshlrev_b32 v2, 7, v1
    v_cndmask_b32 v27, v254, v2, vcc
    v_mfma_f32_16x16x32_bf16 v[108:111], v[164:167], v[148:151], v[108:111]
    v_mfma_f32_16x16x32_bf16 v[124:127], v[164:167], v[152:155], v[124:127]
    s_mov_b32 s57, 0xbfb8aa3b
    s_and_b32 s96, s2, 7
    s_lshr_b32 s97, s2, 3
    s_and_b32 s98, s97, 3
    s_lshl_b32 s79, s96, 2
    s_add_u32 s79, s79, s98
    s_lshr_b32 s80, s97, 2
    v_lshlrev_b32 v29, 3, v0
    v_add_u32 v29, 155648, v29
    v_mfma_f32_16x16x32_bf16 v[48:51], v[168:171], v[132:135], v[48:51]
    s_lshl_b32 s75, s80, 1
    s_lshl_b32 s98, s98, 2
    s_add_u32 s75, s75, s98
    v_bfe_u32 v254, v1, 1, 2
    v_lshrrev_b32 v2, 4, v1
    v_mfma_f32_16x16x32_bf16 v[64:67], v[168:171], v[136:139], v[64:67]
    v_xor_b32 v254, v254, v2
    v_lshlrev_b32 v254, 5, v254
    v_mfma_f32_16x16x32_bf16 v[80:83], v[168:171], v[140:143], v[80:83]
    v_mfma_f32_16x16x32_bf16 v[96:99], v[168:171], v[144:147], v[96:99]
    s_add_u32 m0, s37, 24576
    s_add_u32 s38, s51, 0
    buffer_load_dwordx4 v7, s[12:15], s38 offen lds
    v_mfma_f32_16x16x32_bf16 v[112:115], v[168:171], v[148:151], v[112:115]
    s_add_u32 m0, s37, 32768
    s_add_u32 s38, s51, 0
    buffer_load_dwordx4 v7, s[16:19], s38 offen lds
    v_mfma_f32_16x16x32_bf16 v[128:131], v[168:171], v[152:155], v[128:131]
    s_waitcnt vmcnt(9)
    s_barrier
    ds_read_b64_tr_b16 v[212:213], v12 offset:0
    ds_read_b64_tr_b16 v[214:215], v12 offset:1024
    ds_read_b128 v[228:231], v252 offset:0
    ds_read_b128 v[232:235], v252 offset:2048
    ds_read_b128 v[236:239], v252 offset:4096
    ds_read_b128 v[240:243], v252 offset:6144
    ds_read_b128 v[244:247], v252 offset:8192
    ds_read_b128 v[248:251], v252 offset:10240
    ds_read_b64_tr_b16 v[216:217], v12 offset:8192
    ds_read_b64_tr_b16 v[218:219], v12 offset:9216
    ds_read_b64_tr_b16 v[220:221], v13 offset:0
    ds_read_b64_tr_b16 v[222:223], v13 offset:1024
    ds_read_b64_tr_b16 v[224:225], v13 offset:8192
    ds_read_b64_tr_b16 v[226:227], v13 offset:9216
    s_waitcnt lgkmcnt(0)
    s_setprio 1
    v_mfma_f32_16x16x32_bf16 v[36:39], v[212:215], v[228:231], v[36:39]
    ds_read_b64_tr_b16 v[156:157], v12 offset:16384
    v_mfma_f32_16x16x32_bf16 v[52:55], v[212:215], v[232:235], v[52:55]
    ds_read_b64_tr_b16 v[158:159], v12 offset:17408
    s_add_u32 m0, s37, 40960
    s_nop 0
    buffer_load_dwordx4 v4, s[8:11], s43 offen lds
    v_mfma_f32_16x16x32_bf16 v[68:71], v[212:215], v[236:239], v[68:71]
    ds_read_b128 v[132:135], v253 offset:0
    s_add_u32 m0, s37, 49152
    s_nop 0
    buffer_load_dwordx4 v5, s[8:11], s43 offen lds
    v_mfma_f32_16x16x32_bf16 v[84:87], v[212:215], v[240:243], v[84:87]
    ds_read_b128 v[136:139], v253 offset:2048
    v_mfma_f32_16x16x32_bf16 v[100:103], v[212:215], v[244:247], v[100:103]
    ds_read_b128 v[140:143], v253 offset:4096
    s_add_u32 m0, s37, 57344
    s_nop 0
    buffer_load_dwordx4 v6, s[8:11], s43 offen lds
    v_mfma_f32_16x16x32_bf16 v[116:119], v[212:215], v[248:251], v[116:119]
    ds_read_b128 v[144:147], v253 offset:6144
    v_mfma_f32_16x16x32_bf16 v[40:43], v[216:219], v[228:231], v[40:43]
    ds_read_b128 v[148:151], v253 offset:8192
    s_sub_u32 s98, s77, 1
    s_lshl_b32 s98, s98, 19
    s_add_u32 s98, s88, s98
    s_addc_u32 s99, s89, 0
    s_cmp_eq_u32 s77, 0
    s_cselect_b32 s32, s82, s98
    s_cselect_b32 s33, s83, s99
    s_mov_b32 s34, 0x80000
    s_mov_b32 s35, 0x20000
    v_and_b32 v2, 1, v1
    v_lshl_add_u32 v254, v2, 4, v254
    v_mfma_f32_16x16x32_bf16 v[56:59], v[216:219], v[232:235], v[56:59]
    ds_read_b128 v[152:155], v253 offset:10240
    v_mfma_f32_16x16x32_bf16 v[72:75], v[216:219], v[236:239], v[72:75]
    ds_read_b64_tr_b16 v[160:161], v12 offset:24576
    s_lshl_b32 s76, s77, 12
    s_lshl_b32 s98, s78, 11
    s_add_u32 s76, s76, s98
    v_lshrrev_b32 v2, 3, v1
    v_and_b32 v26, 4, v2
    v_mfma_f32_16x16x32_bf16 v[88:91], v[216:219], v[240:243], v[88:91]
    ds_read_b64_tr_b16 v[162:163], v12 offset:25600
    v_mfma_f32_16x16x32_bf16 v[104:107], v[216:219], v[244:247], v[104:107]
    ds_read_b64_tr_b16 v[164:165], v13 offset:16384
    s_cmp_eq_u32 s77, 0
    s_cselect_b64 vcc, -1, 0
    s_cselect_b32 s81, 2, 1
    s_cselect_b32 s99, 12, 14
    s_lshl_b32 s81, s81, 13
    v_add_u32 v26, v26, v2
    v_cndmask_b32 v2, v2, v26, vcc
    v_mfma_f32_16x16x32_bf16 v[120:123], v[216:219], v[248:251], v[120:123]
    s_setprio 0
    ds_read_b64_tr_b16 v[166:167], v13 offset:17408
    v_mfma_f32_16x16x32_bf16 v[44:47], v[220:223], v[228:231], v[44:47]
    ds_read_b64_tr_b16 v[168:169], v13 offset:24576
    s_lshl_b32 s98, s80, 7
    s_lshl_b32 s99, s78, s99
    v_lshl_add_u32 v254, v2, 10, v254
    v_add_u32 v35, s98, v254
    v_mfma_f32_16x16x32_bf16 v[60:63], v[220:223], v[232:235], v[60:63]
    ds_read_b64_tr_b16 v[170:171], v13 offset:25600
    v_mfma_f32_16x16x32_bf16 v[76:79], v[220:223], v[236:239], v[76:79]
    v_add_u32 v30, s99, v35
    s_lshl_b32 s98, s2, 3
    s_add_u32 s98, s98, s36
    s_mul_i32 s99, s98, 896
    s_lshl_b32 s98, s98, 8
    v_min_u32 v254, 6, v1
    v_mfma_f32_16x16x32_bf16 v[92:95], v[220:223], v[240:243], v[92:95]
    v_mfma_f32_16x16x32_bf16 v[108:111], v[220:223], v[244:247], v[108:111]
    v_lshl_add_u32 v31, v254, 7, s99
    v_min_u32 v2, 1, v1
    v_mfma_f32_16x16x32_bf16 v[124:127], v[220:223], v[248:251], v[124:127]
    v_mfma_f32_16x16x32_bf16 v[48:51], v[224:227], v[228:231], v[48:51]
    v_lshl_add_u32 v32, v2, 7, s98
    v_and_b32 v2, 15, v1
    v_mfma_f32_16x16x32_bf16 v[64:67], v[224:227], v[232:235], v[64:67]
    v_mfma_f32_16x16x32_bf16 v[80:83], v[224:227], v[236:239], v[80:83]
    s_lshl_b32 s98, s74, 7
    s_add_u32 s98, s98, 155648
    v_lshl_add_u32 v14, v2, 3, s98
    v_mfma_f32_16x16x32_bf16 v[96:99], v[224:227], v[240:243], v[96:99]
    v_mfma_f32_16x16x32_bf16 v[112:115], v[224:227], v[244:247], v[112:115]
    s_lshl_b32 s98, s77, 9
    s_add_u32 s98, s98, 157696
    v_lshl_add_u32 v15, v2, 3, s98
    v_mfma_f32_16x16x32_bf16 v[128:131], v[224:227], v[248:251], v[128:131]
    s_waitcnt lgkmcnt(0)
    s_cmp_ge_u32 s5, 8
    s_cbranch_scc0 SK_3
    v_mfma_f32_16x16x32_bf16 v[204:207], v[212:215], v[16:19], v[204:207]
    v_mfma_f32_16x16x32_bf16 v[208:211], v[216:219], v[16:19], v[208:211]
    v_mfma_f32_16x16x32_bf16 v[204:207], v[156:159], v[16:19], v[204:207]
    v_mfma_f32_16x16x32_bf16 v[208:211], v[160:163], v[16:19], v[208:211]
SK_3:
    s_waitcnt vmcnt(5)
    s_barrier
    s_setprio 3
    v_mfma_f32_16x16x32_bf16 v[36:39], v[156:159], v[132:135], v[36:39]
    s_add_u32 m0, s37, 65536
    s_add_u32 s38, s51, 114688
    buffer_load_dwordx4 v7, s[12:15], s38 offen lds
    ds_read_b64_tr_b16 v[212:213], v12 offset:49152
    v_mfma_f32_16x16x32_bf16 v[52:55], v[156:159], v[136:139], v[52:55]
    s_add_u32 m0, s37, 73728
    s_add_u32 s38, s51, 114688
    buffer_load_dwordx4 v7, s[16:19], s38 offen lds
    ds_read_b64_tr_b16 v[214:215], v12 offset:50176
    v_mfma_f32_16x16x32_bf16 v[68:71], v[156:159], v[140:143], v[68:71]
    ds_read_b128 v[228:231], v8 offset:0
    v_mfma_f32_16x16x32_bf16 v[84:87], v[156:159], v[144:147], v[84:87]
    ds_read_b128 v[232:235], v8 offset:2048
    v_mfma_f32_16x16x32_bf16 v[100:103], v[156:159], v[148:151], v[100:103]
    ds_read_b128 v[236:239], v8 offset:4096
    v_mfma_f32_16x16x32_bf16 v[116:119], v[156:159], v[152:155], v[116:119]
    ds_read_b128 v[240:243], v8 offset:6144
    v_mfma_f32_16x16x32_bf16 v[40:43], v[160:163], v[132:135], v[40:43]
    ds_read_b128 v[244:247], v8 offset:8192
    s_cmp_ge_u32 s5, 8
    s_cbranch_scc0 SK_4
    v_or_b32 v204, 1, v204
    v_or_b32 v205, 1, v205
    v_or_b32 v206, 1, v206
    v_or_b32 v207, 1, v207
    buffer_store_dwordx4 v[204:207], v23, s[24:27], s64 offen offset:0 sc1
    v_or_b32 v208, 1, v208
    v_or_b32 v209, 1, v209
    v_or_b32 v210, 1, v210
    v_or_b32 v211, 1, v211
    buffer_store_dwordx4 v[208:211], v23, s[24:27], s64 offen offset:64 sc1
SK_4:
    v_mfma_f32_16x16x32_bf16 v[56:59], v[160:163], v[136:139], v[56:59]
    ds_read_b128 v[248:251], v8 offset:10240
    v_mfma_f32_16x16x32_bf16 v[72:75], v[160:163], v[140:143], v[72:75]
    ds_read_b64_tr_b16 v[216:217], v12 offset:57344
    v_mfma_f32_16x16x32_bf16 v[88:91], v[160:163], v[144:147], v[88:91]
    ds_read_b64_tr_b16 v[218:219], v12 offset:58368
    v_mfma_f32_16x16x32_bf16 v[104:107], v[160:163], v[148:151], v[104:107]
    ds_read_b64_tr_b16 v[220:221], v13 offset:49152
    v_mfma_f32_16x16x32_bf16 v[120:123], v[160:163], v[152:155], v[120:123]
    s_setprio 2
    ds_read_b64_tr_b16 v[222:223], v13 offset:50176
    v_mfma_f32_16x16x32_bf16 v[44:47], v[164:167], v[132:135], v[44:47]
    ds_read_b64_tr_b16 v[224:225], v13 offset:57344
    s_add_u32 m0, s37, 81920
    s_add_u32 s38, s52, 0
    buffer_load_dwordx4 v7, s[12:15], s38 offen lds
    v_mfma_f32_16x16x32_bf16 v[60:63], v[164:167], v[136:139], v[60:63]
    ds_read_b64_tr_b16 v[226:227], v13 offset:58368
    v_mfma_f32_16x16x32_bf16 v[76:79], v[164:167], v[140:143], v[76:79]
    v_mfma_f32_16x16x32_bf16 v[92:95], v[164:167], v[144:147], v[92:95]
    v_mfma_f32_16x16x32_bf16 v[108:111], v[164:167], v[148:151], v[108:111]
    v_mfma_f32_16x16x32_bf16 v[124:127], v[164:167], v[152:155], v[124:127]
    v_mfma_f32_16x16x32_bf16 v[48:51], v[168:171], v[132:135], v[48:51]
    s_add_u32 m0, s37, 90112
    s_add_u32 s38, s52, 0
    buffer_load_dwordx4 v7, s[16:19], s38 offen lds
    v_mfma_f32_16x16x32_bf16 v[64:67], v[168:171], v[136:139], v[64:67]
    v_mfma_f32_16x16x32_bf16 v[80:83], v[168:171], v[140:143], v[80:83]
    v_mfma_f32_16x16x32_bf16 v[96:99], v[168:171], v[144:147], v[96:99]
    v_mfma_f32_16x16x32_bf16 v[112:115], v[168:171], v[148:151], v[112:115]
    v_mfma_f32_16x16x32_bf16 v[128:131], v[168:171], v[152:155], v[128:131]
    s_waitcnt lgkmcnt(0)
    s_setprio 1
    v_mfma_f32_16x16x32_bf16 v[36:39], v[212:215], v[228:231], v[36:39]
    s_cmp_eq_u32 s36, 0
    s_cbranch_scc0 SK_5
    buffer_load_dword v26, v27, s[28:31], 0 offen sc1
SK_5:
    ds_read_b64_tr_b16 v[156:157], v12 offset:32768
    v_mfma_f32_16x16x32_bf16 v[52:55], v[212:215], v[232:235], v[52:55]
    ds_read_b64_tr_b16 v[158:159], v12 offset:33792
    s_add_u32 m0, s37, 131072
    s_nop 0
    buffer_load_dwordx4 v4, s[8:11], s44 offen lds
    v_mfma_f32_16x16x32_bf16 v[68:71], v[212:215], v[236:239], v[68:71]
    ds_read_b128 v[132:135], v9 offset:0
    v_mfma_f32_16x16x32_bf16 v[84:87], v[212:215], v[240:243], v[84:87]
    ds_read_b128 v[136:139], v9 offset:2048
    v_mfma_f32_16x16x32_bf16 v[100:103], v[212:215], v[244:247], v[100:103]
    ds_read_b128 v[140:143], v9 offset:4096
    v_mfma_f32_16x16x32_bf16 v[116:119], v[212:215], v[248:251], v[116:119]
    ds_read_b128 v[144:147], v9 offset:6144
    v_mfma_f32_16x16x32_bf16 v[40:43], v[216:219], v[228:231], v[40:43]
    ds_read_b128 v[148:151], v9 offset:8192
    s_add_u32 m0, s37, 139264
    s_nop 0
    buffer_load_dwordx4 v5, s[8:11], s44 offen lds
    v_mfma_f32_16x16x32_bf16 v[56:59], v[216:219], v[232:235], v[56:59]
    ds_read_b128 v[152:155], v9 offset:10240
    v_mfma_f32_16x16x32_bf16 v[72:75], v[216:219], v[236:239], v[72:75]
    ds_read_b64_tr_b16 v[160:161], v12 offset:40960
    v_mfma_f32_16x16x32_bf16 v[88:91], v[216:219], v[240:243], v[88:91]
    ds_read_b64_tr_b16 v[162:163], v12 offset:41984
    v_mfma_f32_16x16x32_bf16 v[104:107], v[216:219], v[244:247], v[104:107]
    ds_read_b64_tr_b16 v[164:165], v13 offset:32768
    v_mfma_f32_16x16x32_bf16 v[120:123], v[216:219], v[248:251], v[120:123]
    s_setprio 0
    ds_read_b64_tr_b16 v[166:167], v13 offset:33792
    v_mfma_f32_16x16x32_bf16 v[44:47], v[220:223], v[228:231], v[44:47]
    ds_read_b64_tr_b16 v[168:169], v13 offset:40960
    s_add_u32 m0, s37, 147456
    s_nop 0
    buffer_load_dwordx4 v6, s[8:11], s44 offen lds
    v_mfma_f32_16x16x32_bf16 v[60:63], v[220:223], v[232:235], v[60:63]
    ds_read_b64_tr_b16 v[170:171], v13 offset:41984
    v_mfma_f32_16x16x32_bf16 v[76:79], v[220:223], v[236:239], v[76:79]
    v_mfma_f32_16x16x32_bf16 v[92:95], v[220:223], v[240:243], v[92:95]
    v_mfma_f32_16x16x32_bf16 v[108:111], v[220:223], v[244:247], v[108:111]
    v_mfma_f32_16x16x32_bf16 v[124:127], v[220:223], v[248:251], v[124:127]
    v_mfma_f32_16x16x32_bf16 v[48:51], v[224:227], v[228:231], v[48:51]
    v_mfma_f32_16x16x32_bf16 v[64:67], v[224:227], v[232:235], v[64:67]
    v_mfma_f32_16x16x32_bf16 v[80:83], v[224:227], v[236:239], v[80:83]
    v_mfma_f32_16x16x32_bf16 v[96:99], v[224:227], v[240:243], v[96:99]
    v_mfma_f32_16x16x32_bf16 v[112:115], v[224:227], v[244:247], v[112:115]
    v_mfma_f32_16x16x32_bf16 v[128:131], v[224:227], v[248:251], v[128:131]
    s_waitcnt lgkmcnt(0)
    s_waitcnt vmcnt(5)
    s_barrier
    s_setprio 3
    v_mfma_f32_16x16x32_bf16 v[36:39], v[156:159], v[132:135], v[36:39]
    s_add_u32 m0, s37, 114688
    s_add_u32 s38, s52, 114688
    buffer_load_dwordx4 v7, s[12:15], s38 offen lds
    ds_read_b64_tr_b16 v[212:213], v10 offset:24576
    v_mfma_f32_16x16x32_bf16 v[52:55], v[156:159], v[136:139], v[52:55]
    s_add_u32 m0, s37, 122880
    s_add_u32 s38, s52, 114688
    buffer_load_dwordx4 v7, s[16:19], s38 offen lds
    ds_read_b64_tr_b16 v[214:215], v10 offset:25600
    v_mfma_f32_16x16x32_bf16 v[68:71], v[156:159], v[140:143], v[68:71]
    ds_read_b128 v[228:231], v8 offset:40960
    s_add_u32 m0, s37, 98304
    s_add_u32 s38, s53, 0
    buffer_load_dwordx4 v7, s[12:15], s38 offen lds
    v_mfma_f32_16x16x32_bf16 v[84:87], v[156:159], v[144:147], v[84:87]
    ds_read_b128 v[232:235], v8 offset:43008
    v_mfma_f32_16x16x32_bf16 v[100:103], v[156:159], v[148:151], v[100:103]
    ds_read_b128 v[236:239], v8 offset:45056
    v_mfma_f32_16x16x32_bf16 v[116:119], v[156:159], v[152:155], v[116:119]
    ds_read_b128 v[240:243], v8 offset:47104
    v_mfma_f32_16x16x32_bf16 v[40:43], v[160:163], v[132:135], v[40:43]
    ds_read_b128 v[244:247], v8 offset:49152
    v_mfma_f32_16x16x32_bf16 v[56:59], v[160:163], v[136:139], v[56:59]
    ds_read_b128 v[248:251], v8 offset:51200
    v_mfma_f32_16x16x32_bf16 v[72:75], v[160:163], v[140:143], v[72:75]
    ds_read_b64_tr_b16 v[216:217], v10 offset:32768
    v_mfma_f32_16x16x32_bf16 v[88:91], v[160:163], v[144:147], v[88:91]
    ds_read_b64_tr_b16 v[218:219], v10 offset:33792
    v_mfma_f32_16x16x32_bf16 v[104:107], v[160:163], v[148:151], v[104:107]
    ds_read_b64_tr_b16 v[220:221], v11 offset:24576
    v_mfma_f32_16x16x32_bf16 v[120:123], v[160:163], v[152:155], v[120:123]
    s_setprio 2
    ds_read_b64_tr_b16 v[222:223], v11 offset:25600
    v_mfma_f32_16x16x32_bf16 v[44:47], v[164:167], v[132:135], v[44:47]
    global_load_dword v33, v31, s[88:89]
    global_load_dword v34, v32, s[82:83]
    ds_read_b64_tr_b16 v[224:225], v11 offset:32768
    v_mfma_f32_16x16x32_bf16 v[60:63], v[164:167], v[136:139], v[60:63]
    ds_read_b64_tr_b16 v[226:227], v11 offset:33792
    s_add_u32 m0, s37, 106496
    s_add_u32 s38, s53, 0
    buffer_load_dwordx4 v7, s[16:19], s38 offen lds
    v_mfma_f32_16x16x32_bf16 v[76:79], v[164:167], v[140:143], v[76:79]
    v_mfma_f32_16x16x32_bf16 v[92:95], v[164:167], v[144:147], v[92:95]
    v_mfma_f32_16x16x32_bf16 v[108:111], v[164:167], v[148:151], v[108:111]
    v_mfma_f32_16x16x32_bf16 v[124:127], v[164:167], v[152:155], v[124:127]
    v_mfma_f32_16x16x32_bf16 v[48:51], v[168:171], v[132:135], v[48:51]
    v_mfma_f32_16x16x32_bf16 v[64:67], v[168:171], v[136:139], v[64:67]
    v_mfma_f32_16x16x32_bf16 v[80:83], v[168:171], v[140:143], v[80:83]
    v_mfma_f32_16x16x32_bf16 v[96:99], v[168:171], v[144:147], v[96:99]
    v_mfma_f32_16x16x32_bf16 v[112:115], v[168:171], v[148:151], v[112:115]
    v_mfma_f32_16x16x32_bf16 v[128:131], v[168:171], v[152:155], v[128:131]
    s_waitcnt lgkmcnt(0)
    s_setprio 1
    v_mfma_f32_16x16x32_bf16 v[36:39], v[212:215], v[228:231], v[36:39]
    ds_read_b64_tr_b16 v[156:157], v12 offset:0
    v_mfma_f32_16x16x32_bf16 v[52:55], v[212:215], v[232:235], v[52:55]
    ds_read_b64_tr_b16 v[158:159], v12 offset:1024
    s_add_u32 m0, s37, 0
    s_nop 0
    buffer_load_dwordx4 v4, s[8:11], s45 offen lds
    v_mfma_f32_16x16x32_bf16 v[68:71], v[212:215], v[236:239], v[68:71]
    ds_read_b128 v[132:135], v9 offset:40960
    v_mfma_f32_16x16x32_bf16 v[84:87], v[212:215], v[240:243], v[84:87]
    ds_read_b128 v[136:139], v9 offset:43008
    v_mfma_f32_16x16x32_bf16 v[100:103], v[212:215], v[244:247], v[100:103]
    ds_read_b128 v[140:143], v9 offset:45056
    v_mfma_f32_16x16x32_bf16 v[116:119], v[212:215], v[248:251], v[116:119]
    ds_read_b128 v[144:147], v9 offset:47104
    v_mfma_f32_16x16x32_bf16 v[40:43], v[216:219], v[228:231], v[40:43]
    ds_read_b128 v[148:151], v9 offset:49152
    s_add_u32 m0, s37, 8192
    s_nop 0
    buffer_load_dwordx4 v5, s[8:11], s45 offen lds
    v_mfma_f32_16x16x32_bf16 v[56:59], v[216:219], v[232:235], v[56:59]
    ds_read_b128 v[152:155], v9 offset:51200
    v_mfma_f32_16x16x32_bf16 v[72:75], v[216:219], v[236:239], v[72:75]
    ds_read_b64_tr_b16 v[160:161], v12 offset:8192
    v_mfma_f32_16x16x32_bf16 v[88:91], v[216:219], v[240:243], v[88:91]
    ds_read_b64_tr_b16 v[162:163], v12 offset:9216
    v_mfma_f32_16x16x32_bf16 v[104:107], v[216:219], v[244:247], v[104:107]
    ds_read_b64_tr_b16 v[164:165], v13 offset:0
    v_mfma_f32_16x16x32_bf16 v[120:123], v[216:219], v[248:251], v[120:123]
    s_setprio 0
    ds_read_b64_tr_b16 v[166:167], v13 offset:1024
    v_mfma_f32_16x16x32_bf16 v[44:47], v[220:223], v[228:231], v[44:47]
    ds_read_b64_tr_b16 v[168:169], v13 offset:8192
    s_add_u32 m0, s37, 16384
    s_nop 0
    buffer_load_dwordx4 v6, s[8:11], s45 offen lds
    v_mfma_f32_16x16x32_bf16 v[60:63], v[220:223], v[232:235], v[60:63]
    ds_read_b64_tr_b16 v[170:171], v13 offset:9216
    v_mfma_f32_16x16x32_bf16 v[76:79], v[220:223], v[236:239], v[76:79]
    v_mfma_f32_16x16x32_bf16 v[92:95], v[220:223], v[240:243], v[92:95]
    v_mfma_f32_16x16x32_bf16 v[108:111], v[220:223], v[244:247], v[108:111]
    v_mfma_f32_16x16x32_bf16 v[124:127], v[220:223], v[248:251], v[124:127]
    v_mfma_f32_16x16x32_bf16 v[48:51], v[224:227], v[228:231], v[48:51]
    v_mfma_f32_16x16x32_bf16 v[64:67], v[224:227], v[232:235], v[64:67]
    v_mfma_f32_16x16x32_bf16 v[80:83], v[224:227], v[236:239], v[80:83]
    v_mfma_f32_16x16x32_bf16 v[96:99], v[224:227], v[240:243], v[96:99]
    v_mfma_f32_16x16x32_bf16 v[112:115], v[224:227], v[244:247], v[112:115]
    v_mfma_f32_16x16x32_bf16 v[128:131], v[224:227], v[248:251], v[128:131]
    s_waitcnt lgkmcnt(0)
    s_waitcnt vmcnt(7)
    s_cmp_eq_u32 s36, 0
    s_cbranch_scc0 PA_ok_6
    s_waitcnt vmcnt(12)
    v_readlane_b32 s96, v26, 0
    v_readlane_b32 s97, v26, 1
    s_nop 0
    s_add_u32 s96, s96, s97
    s_cmp_ge_u32 s96, 256
    s_cbranch_scc1 PA_ok_6
    s_mov_b32 s98, 0
PA_spin_7:
    s_sleep 2
    buffer_load_dword v26, v27, s[28:31], 0 offen sc1
    s_waitcnt vmcnt(0)
    v_readlane_b32 s96, v26, 0
    v_readlane_b32 s97, v26, 1
    s_nop 0
    s_add_u32 s96, s96, s97
    s_add_u32 s98, s98, 1
    s_cmp_ge_u32 s98, 100000
    s_cbranch_scc1 PA_ok_6
    s_cmp_lt_u32 s96, 256
    s_cbranch_scc1 PA_spin_7
PA_ok_6:
    s_barrier
    s_setprio 3
    v_mfma_f32_16x16x32_bf16 v[36:39], v[156:159], v[132:135], v[36:39]
    s_add_u32 m0, s37, 24576
    s_add_u32 s38, s53, 114688
    buffer_load_dwordx4 v7, s[12:15], s38 offen lds
    ds_read_b64_tr_b16 v[212:213], v12 offset:16384
    v_mfma_f32_16x16x32_bf16 v[52:55], v[156:159], v[136:139], v[52:55]
    s_add_u32 m0, s37, 32768
    s_add_u32 s38, s53, 114688
    buffer_load_dwordx4 v7, s[16:19], s38 offen lds
    ds_read_b64_tr_b16 v[214:215], v12 offset:17408
    v_mfma_f32_16x16x32_bf16 v[68:71], v[156:159], v[140:143], v[68:71]
    ds_read_b128 v[228:231], v252 offset:0
    v_mfma_f32_16x16x32_bf16 v[84:87], v[156:159], v[144:147], v[84:87]
    ds_read_b128 v[232:235], v252 offset:2048
    v_mfma_f32_16x16x32_bf16 v[100:103], v[156:159], v[148:151], v[100:103]
    ds_read_b128 v[236:239], v252 offset:4096
    buffer_load_dwordx2 v[172:173], v28, s[24:27], 0 offen offset:0 sc1
    v_mfma_f32_16x16x32_bf16 v[116:119], v[156:159], v[152:155], v[116:119]
    ds_read_b128 v[240:243], v252 offset:6144
    v_mfma_f32_16x16x32_bf16 v[40:43], v[160:163], v[132:135], v[40:43]
    ds_read_b128 v[244:247], v252 offset:8192
    v_mfma_f32_16x16x32_bf16 v[56:59], v[160:163], v[136:139], v[56:59]
    ds_read_b128 v[248:251], v252 offset:10240
    v_mfma_f32_16x16x32_bf16 v[72:75], v[160:163], v[140:143], v[72:75]
    ds_read_b64_tr_b16 v[216:217], v12 offset:24576
    v_mfma_f32_16x16x32_bf16 v[88:91], v[160:163], v[144:147], v[88:91]
    ds_read_b64_tr_b16 v[218:219], v12 offset:25600
    buffer_load_dwordx2 v[174:175], v28, s[24:27], 0 offen offset:128 sc1
    v_mfma_f32_16x16x32_bf16 v[104:107], v[160:163], v[148:151], v[104:107]
    ds_read_b64_tr_b16 v[220:221], v13 offset:16384
    v_mfma_f32_16x16x32_bf16 v[120:123], v[160:163], v[152:155], v[120:123]
    s_setprio 2
    ds_read_b64_tr_b16 v[222:223], v13 offset:17408
    v_mfma_f32_16x16x32_bf16 v[44:47], v[164:167], v[132:135], v[44:47]
    ds_read_b64_tr_b16 v[224:225], v13 offset:24576
    v_mfma_f32_16x16x32_bf16 v[60:63], v[164:167], v[136:139], v[60:63]
    ds_read_b64_tr_b16 v[226:227], v13 offset:25600
    v_mfma_f32_16x16x32_bf16 v[76:79], v[164:167], v[140:143], v[76:79]
    s_add_u32 m0, s37, 65536
    s_add_u32 s38, s54, 0
    buffer_load_dwordx4 v7, s[12:15], s38 offen lds
    v_mfma_f32_16x16x32_bf16 v[92:95], v[164:167], v[144:147], v[92:95]
    v_mfma_f32_16x16x32_bf16 v[108:111], v[164:167], v[148:151], v[108:111]
    v_mfma_f32_16x16x32_bf16 v[124:127], v[164:167], v[152:155], v[124:127]
    v_mfma_f32_16x16x32_bf16 v[48:51], v[168:171], v[132:135], v[48:51]
    v_mfma_f32_16x16x32_bf16 v[64:67], v[168:171], v[136:139], v[64:67]
    s_add_u32 m0, s37, 73728
    s_add_u32 s38, s54, 0
    buffer_load_dwordx4 v7, s[16:19], s38 offen lds
    v_mfma_f32_16x16x32_bf16 v[80:83], v[168:171], v[140:143], v[80:83]
    v_mfma_f32_16x16x32_bf16 v[96:99], v[168:171], v[144:147], v[96:99]
    v_mfma_f32_16x16x32_bf16 v[112:115], v[168:171], v[148:151], v[112:115]
    v_mfma_f32_16x16x32_bf16 v[128:131], v[168:171], v[152:155], v[128:131]
    s_waitcnt lgkmcnt(0)
    s_setprio 1
    v_mfma_f32_16x16x32_bf16 v[36:39], v[212:215], v[228:231], v[36:39]
    buffer_load_dwordx2 v[176:177], v28, s[24:27], 0 offen offset:256 sc1
    ds_read_b64_tr_b16 v[156:157], v12 offset:49152
    v_mfma_f32_16x16x32_bf16 v[52:55], v[212:215], v[232:235], v[52:55]
    ds_read_b64_tr_b16 v[158:159], v12 offset:50176
    s_add_u32 m0, s37, 40960
    s_nop 0
    buffer_load_dwordx4 v4, s[8:11], s46 offen lds
    v_mfma_f32_16x16x32_bf16 v[68:71], v[212:215], v[236:239], v[68:71]
    ds_read_b128 v[132:135], v253 offset:0
    v_mfma_f32_16x16x32_bf16 v[84:87], v[212:215], v[240:243], v[84:87]
    ds_read_b128 v[136:139], v253 offset:2048
    v_mfma_f32_16x16x32_bf16 v[100:103], v[212:215], v[244:247], v[100:103]
    ds_read_b128 v[140:143], v253 offset:4096
    v_mfma_f32_16x16x32_bf16 v[116:119], v[212:215], v[248:251], v[116:119]
    ds_read_b128 v[144:147], v253 offset:6144
    v_mfma_f32_16x16x32_bf16 v[40:43], v[216:219], v[228:231], v[40:43]
    ds_read_b128 v[148:151], v253 offset:8192
    s_add_u32 m0, s37, 49152
    s_nop 0
    buffer_load_dwordx4 v5, s[8:11], s46 offen lds
    v_mfma_f32_16x16x32_bf16 v[56:59], v[216:219], v[232:235], v[56:59]
    ds_read_b128 v[152:155], v253 offset:10240
    v_mfma_f32_16x16x32_bf16 v[72:75], v[216:219], v[236:239], v[72:75]
    ds_read_b64_tr_b16 v[160:161], v12 offset:57344
    v_mfma_f32_16x16x32_bf16 v[88:91], v[216:219], v[240:243], v[88:91]
    ds_read_b64_tr_b16 v[162:163], v12 offset:58368
    v_mfma_f32_16x16x32_bf16 v[104:107], v[216:219], v[244:247], v[104:107]
    ds_read_b64_tr_b16 v[164:165], v13 offset:49152
    v_mfma_f32_16x16x32_bf16 v[120:123], v[216:219], v[248:251], v[120:123]
    s_setprio 0
    ds_read_b64_tr_b16 v[166:167], v13 offset:50176
    v_mfma_f32_16x16x32_bf16 v[44:47], v[220:223], v[228:231], v[44:47]
    ds_read_b64_tr_b16 v[168:169], v13 offset:57344
    s_add_u32 m0, s37, 57344
    s_nop 0
    buffer_load_dwordx4 v6, s[8:11], s46 offen lds
    v_mfma_f32_16x16x32_bf16 v[60:63], v[220:223], v[232:235], v[60:63]
    ds_read_b64_tr_b16 v[170:171], v13 offset:58368
    v_mfma_f32_16x16x32_bf16 v[76:79], v[220:223], v[236:239], v[76:79]
    v_mfma_f32_16x16x32_bf16 v[92:95], v[220:223], v[240:243], v[92:95]
    v_mfma_f32_16x16x32_bf16 v[108:111], v[220:223], v[244:247], v[108:111]
    v_mfma_f32_16x16x32_bf16 v[124:127], v[220:223], v[248:251], v[124:127]
    buffer_load_dwordx2 v[178:179], v28, s[24:27], 0 offen offset:384 sc1
    v_mfma_f32_16x16x32_bf16 v[48:51], v[224:227], v[228:231], v[48:51]
    v_mfma_f32_16x16x32_bf16 v[64:67], v[224:227], v[232:235], v[64:67]
    v_mfma_f32_16x16x32_bf16 v[80:83], v[224:227], v[236:239], v[80:83]
    v_mfma_f32_16x16x32_bf16 v[96:99], v[224:227], v[240:243], v[96:99]
    v_mfma_f32_16x16x32_bf16 v[112:115], v[224:227], v[244:247], v[112:115]
    v_mfma_f32_16x16x32_bf16 v[128:131], v[224:227], v[248:251], v[128:131]
    s_waitcnt lgkmcnt(0)
    s_waitcnt vmcnt(9)
    s_barrier
    s_setprio 3
    v_mfma_f32_16x16x32_bf16 v[36:39], v[156:159], v[132:135], v[36:39]
    s_add_u32 m0, s37, 81920
    s_add_u32 s38, s54, 114688
    buffer_load_dwordx4 v7, s[12:15], s38 offen lds
    ds_read_b64_tr_b16 v[212:213], v12 offset:32768
    v_mfma_f32_16x16x32_bf16 v[52:55], v[156:159], v[136:139], v[52:55]
    s_add_u32 m0, s37, 90112
    s_add_u32 s38, s54, 114688
    buffer_load_dwordx4 v7, s[16:19], s38 offen lds
    ds_read_b64_tr_b16 v[214:215], v12 offset:33792
    v_mfma_f32_16x16x32_bf16 v[68:71], v[156:159], v[140:143], v[68:71]
    ds_read_b128 v[228:231], v8 offset:0
    s_add_u32 m0, s37, 114688
    s_add_u32 s38, s55, 0
    buffer_load_dwordx4 v7, s[12:15], s38 offen lds
    v_mfma_f32_16x16x32_bf16 v[84:87], v[156:159], v[144:147], v[84:87]
    ds_read_b128 v[232:235], v8 offset:2048
    v_mfma_f32_16x16x32_bf16 v[100:103], v[156:159], v[148:151], v[100:103]
    ds_read_b128 v[236:239], v8 offset:4096
    v_mfma_f32_16x16x32_bf16 v[116:119], v[156:159], v[152:155], v[116:119]
    ds_read_b128 v[240:243], v8 offset:6144
    v_mfma_f32_16x16x32_bf16 v[40:43], v[160:163], v[132:135], v[40:43]
    ds_read_b128 v[244:247], v8 offset:8192
    v_mfma_f32_16x16x32_bf16 v[56:59], v[160:163], v[136:139], v[56:59]
    ds_read_b128 v[248:251], v8 offset:10240
    v_mfma_f32_16x16x32_bf16 v[72:75], v[160:163], v[140:143], v[72:75]
    ds_read_b64_tr_b16 v[216:217], v12 offset:40960
    v_mfma_f32_16x16x32_bf16 v[88:91], v[160:163], v[144:147], v[88:91]
    ds_read_b64_tr_b16 v[218:219], v12 offset:41984
    v_mfma_f32_16x16x32_bf16 v[104:107], v[160:163], v[148:151], v[104:107]
    ds_read_b64_tr_b16 v[220:221], v13 offset:32768
    v_mfma_f32_16x16x32_bf16 v[120:123], v[160:163], v[152:155], v[120:123]
    s_setprio 2
    ds_read_b64_tr_b16 v[222:223], v13 offset:33792
    v_mfma_f32_16x16x32_bf16 v[44:47], v[164:167], v[132:135], v[44:47]
    ds_read_b64_tr_b16 v[224:225], v13 offset:40960
    v_mfma_f32_16x16x32_bf16 v[60:63], v[164:167], v[136:139], v[60:63]
    ds_read_b64_tr_b16 v[226:227], v13 offset:41984
    s_add_u32 m0, s37, 122880
    s_add_u32 s38, s55, 0
    buffer_load_dwordx4 v7, s[16:19], s38 offen lds
    v_mfma_f32_16x16x32_bf16 v[76:79], v[164:167], v[140:143], v[76:79]
    v_mfma_f32_16x16x32_bf16 v[92:95], v[164:167], v[144:147], v[92:95]
    v_mfma_f32_16x16x32_bf16 v[108:111], v[164:167], v[148:151], v[108:111]
    v_mfma_f32_16x16x32_bf16 v[124:127], v[164:167], v[152:155], v[124:127]
    v_mfma_f32_16x16x32_bf16 v[48:51], v[168:171], v[132:135], v[48:51]
    v_mfma_f32_16x16x32_bf16 v[64:67], v[168:171], v[136:139], v[64:67]
    v_mfma_f32_16x16x32_bf16 v[80:83], v[168:171], v[140:143], v[80:83]
    v_mfma_f32_16x16x32_bf16 v[96:99], v[168:171], v[144:147], v[96:99]
    v_mfma_f32_16x16x32_bf16 v[112:115], v[168:171], v[148:151], v[112:115]
    v_mfma_f32_16x16x32_bf16 v[128:131], v[168:171], v[152:155], v[128:131]
    s_waitcnt lgkmcnt(0)
    s_setprio 1
    v_mfma_f32_16x16x32_bf16 v[36:39], v[212:215], v[228:231], v[36:39]
    ds_read_b64_tr_b16 v[156:157], v10 offset:24576
    v_mfma_f32_16x16x32_bf16 v[52:55], v[212:215], v[232:235], v[52:55]
    ds_read_b64_tr_b16 v[158:159], v10 offset:25600
    s_add_u32 m0, s37, 131072
    s_nop 0
    buffer_load_dwordx4 v4, s[8:11], s47 offen lds
    v_mfma_f32_16x16x32_bf16 v[68:71], v[212:215], v[236:239], v[68:71]
    ds_read_b128 v[132:135], v9 offset:0
    v_mfma_f32_16x16x32_bf16 v[84:87], v[212:215], v[240:243], v[84:87]
    ds_read_b128 v[136:139], v9 offset:2048
    v_mfma_f32_16x16x32_bf16 v[100:103], v[212:215], v[244:247], v[100:103]
    ds_read_b128 v[140:143], v9 offset:4096
    v_mfma_f32_16x16x32_bf16 v[116:119], v[212:215], v[248:251], v[116:119]
    ds_read_b128 v[144:147], v9 offset:6144
    v_mfma_f32_16x16x32_bf16 v[40:43], v[216:219], v[228:231], v[40:43]
    ds_read_b128 v[148:151], v9 offset:8192
    s_add_u32 m0, s37, 139264
    s_nop 0
    buffer_load_dwordx4 v5, s[8:11], s47 offen lds
    v_mfma_f32_16x16x32_bf16 v[56:59], v[216:219], v[232:235], v[56:59]
    ds_read_b128 v[152:155], v9 offset:10240
    v_mfma_f32_16x16x32_bf16 v[72:75], v[216:219], v[236:239], v[72:75]
    ds_read_b64_tr_b16 v[160:161], v10 offset:32768
    v_mfma_f32_16x16x32_bf16 v[88:91], v[216:219], v[240:243], v[88:91]
    ds_read_b64_tr_b16 v[162:163], v10 offset:33792
    v_mfma_f32_16x16x32_bf16 v[104:107], v[216:219], v[244:247], v[104:107]
    ds_read_b64_tr_b16 v[164:165], v11 offset:24576
    v_mfma_f32_16x16x32_bf16 v[120:123], v[216:219], v[248:251], v[120:123]
    s_setprio 0
    ds_read_b64_tr_b16 v[166:167], v11 offset:25600
    v_mfma_f32_16x16x32_bf16 v[44:47], v[220:223], v[228:231], v[44:47]
    ds_read_b64_tr_b16 v[168:169], v11 offset:32768
    s_add_u32 m0, s37, 147456
    s_nop 0
    buffer_load_dwordx4 v6, s[8:11], s47 offen lds
    v_mfma_f32_16x16x32_bf16 v[60:63], v[220:223], v[232:235], v[60:63]
    ds_read_b64_tr_b16 v[170:171], v11 offset:33792
    v_mfma_f32_16x16x32_bf16 v[76:79], v[220:223], v[236:239], v[76:79]
    v_mfma_f32_16x16x32_bf16 v[92:95], v[220:223], v[240:243], v[92:95]
    v_mfma_f32_16x16x32_bf16 v[108:111], v[220:223], v[244:247], v[108:111]
    v_mfma_f32_16x16x32_bf16 v[124:127], v[220:223], v[248:251], v[124:127]
    v_mfma_f32_16x16x32_bf16 v[48:51], v[224:227], v[228:231], v[48:51]
    v_mfma_f32_16x16x32_bf16 v[64:67], v[224:227], v[232:235], v[64:67]
    v_mfma_f32_16x16x32_bf16 v[80:83], v[224:227], v[236:239], v[80:83]
    v_mfma_f32_16x16x32_bf16 v[96:99], v[224:227], v[240:243], v[96:99]
    v_mfma_f32_16x16x32_bf16 v[112:115], v[224:227], v[244:247], v[112:115]
    v_mfma_f32_16x16x32_bf16 v[128:131], v[224:227], v[248:251], v[128:131]
    s_waitcnt lgkmcnt(0)
    s_waitcnt vmcnt(5)
    s_mov_b32 s98, 0
PC_chk_9:
    v_and_b32 v188, v172, v173
    v_and_b32 v189, v174, v175
    v_and_b32 v188, v188, v189
    v_and_b32 v189, v176, v177
    v_and_b32 v188, v188, v189
    v_and_b32 v189, v178, v179
    v_and_b32 v188, v188, v189
    v_and_b32 v188, 1, v188
    v_cmp_eq_u32 vcc, 0, v188
    s_nop 0
    s_and_b64 vcc, vcc, s[100:101]
    s_cbranch_scc0 PC_ok_8
    s_add_u32 s98, s98, 1
    s_cmp_ge_u32 s98, 100000
    s_cbranch_scc1 PC_ok_8
    s_sleep 2
    buffer_load_dwordx2 v[172:173], v28, s[24:27], 0 offen offset:0 sc1
    buffer_load_dwordx2 v[174:175], v28, s[24:27], 0 offen offset:128 sc1
    buffer_load_dwordx2 v[176:177], v28, s[24:27], 0 offen offset:256 sc1
    buffer_load_dwordx2 v[178:179], v28, s[24:27], 0 offen offset:384 sc1
    s_waitcnt vmcnt(0)
    s_branch PC_chk_9
PC_ok_8:
    s_barrier
    s_setprio 3
    v_mfma_f32_16x16x32_bf16 v[36:39], v[156:159], v[132:135], v[36:39]
    s_add_u32 m0, s37, 98304
    s_add_u32 s38, s55, 114688
    buffer_load_dwordx4 v7, s[12:15], s38 offen lds
    ds_read_b64_tr_b16 v[212:213], v12 offset:0
    v_mfma_f32_16x16x32_bf16 v[52:55], v[156:159], v[136:139], v[52:55]
    s_add_u32 m0, s37, 106496
    s_add_u32 s38, s55, 114688
    buffer_load_dwordx4 v7, s[16:19], s38 offen lds
    ds_read_b64_tr_b16 v[214:215], v12 offset:1024
    v_mfma_f32_16x16x32_bf16 v[68:71], v[156:159], v[140:143], v[68:71]
    ds_read_b128 v[228:231], v8 offset:40960
    v_add_f32 v172, v172, v174
    v_add_f32 v173, v173, v175
    v_mfma_f32_16x16x32_bf16 v[84:87], v[156:159], v[144:147], v[84:87]
    ds_read_b128 v[232:235], v8 offset:43008
    v_add_f32 v172, v172, v176
    v_add_f32 v173, v173, v177
    v_mfma_f32_16x16x32_bf16 v[100:103], v[156:159], v[148:151], v[100:103]
    ds_read_b128 v[236:239], v8 offset:45056
    v_mfma_f32_16x16x32_bf16 v[116:119], v[156:159], v[152:155], v[116:119]
    ds_read_b128 v[240:243], v8 offset:47104
    v_add_f32 v172, v172, v178
    v_add_f32 v173, v173, v179
    v_mfma_f32_16x16x32_bf16 v[40:43], v[160:163], v[132:135], v[40:43]
    ds_read_b128 v[244:247], v8 offset:49152
    v_mul_f32 v172, 0xbb000000, v172
    v_mul_f32 v173, 0x3b000000, v173
    v_mfma_f32_16x16x32_bf16 v[56:59], v[160:163], v[136:139], v[56:59]
    ds_read_b128 v[248:251], v8 offset:51200
    v_mfma_f32_16x16x32_bf16 v[72:75], v[160:163], v[140:143], v[72:75]
    ds_read_b64_tr_b16 v[216:217], v12 offset:8192
    v_fma_f32 v173, -v172, v172, v173
    v_max_f32 v173, 0, v173
    v_mfma_f32_16x16x32_bf16 v[88:91], v[160:163], v[144:147], v[88:91]
    ds_read_b64_tr_b16 v[218:219], v12 offset:9216
    v_cvt_pk_bf16_f32 v173, v173, v173
    v_lshlrev_b32 v173, 16, v173
    v_mfma_f32_16x16x32_bf16 v[104:107], v[160:163], v[148:151], v[104:107]
    ds_read_b64_tr_b16 v[220:221], v13 offset:0
    v_mfma_f32_16x16x32_bf16 v[120:123], v[160:163], v[152:155], v[120:123]
    s_setprio 2
    ds_read_b64_tr_b16 v[222:223], v13 offset:1024
    v_add_f32 v173, 0x3727c5ac, v173
    v_cvt_pk_bf16_f32 v172, v172, v172
    v_mfma_f32_16x16x32_bf16 v[44:47], v[164:167], v[132:135], v[44:47]
    ds_read_b64_tr_b16 v[224:225], v13 offset:8192
    v_mfma_f32_16x16x32_bf16 v[60:63], v[164:167], v[136:139], v[60:63]
    ds_read_b64_tr_b16 v[226:227], v13 offset:9216
    v_cvt_pk_bf16_f32 v173, v173, v173
    v_lshlrev_b32 v173, 16, v173
    v_mfma_f32_16x16x32_bf16 v[76:79], v[164:167], v[140:143], v[76:79]
    v_sqrt_f32 v173, v173
    v_mfma_f32_16x16x32_bf16 v[92:95], v[164:167], v[144:147], v[92:95]
    v_mfma_f32_16x16x32_bf16 v[108:111], v[164:167], v[148:151], v[108:111]
    v_cvt_pk_bf16_f32 v173, v173, v173
    v_lshlrev_b32 v173, 16, v173
    v_mfma_f32_16x16x32_bf16 v[124:127], v[164:167], v[152:155], v[124:127]
    v_and_b32 v172, 0xffff, v172
    v_or_b32 v172, v172, v173
    v_mfma_f32_16x16x32_bf16 v[48:51], v[168:171], v[132:135], v[48:51]
    v_mfma_f32_16x16x32_bf16 v[64:67], v[168:171], v[136:139], v[64:67]
    v_rcp_f32 v173, v173
    v_mfma_f32_16x16x32_bf16 v[80:83], v[168:171], v[140:143], v[80:83]
    ds_write_b64 v29, v[172:173]
    v_mfma_f32_16x16x32_bf16 v[96:99], v[168:171], v[144:147], v[96:99]
    v_mfma_f32_16x16x32_bf16 v[112:115], v[168:171], v[148:151], v[112:115]
    s_add_u32 m0, s76, 0
    s_add_u32 s85, s75, 0
    s_and_b32 s85, s85, 15
    s_lshl_b32 s85, s85, 15
    buffer_load_dwordx4 v30, s[32:35], s85 offen lds
    v_mfma_f32_16x16x32_bf16 v[128:131], v[168:171], v[152:155], v[128:131]
    s_waitcnt lgkmcnt(0)
    s_setprio 1
    v_mfma_f32_16x16x32_bf16 v[36:39], v[212:215], v[228:231], v[36:39]
    s_add_u32 m0, s76, 1024
    s_add_u32 s85, s85, s81
    buffer_load_dwordx4 v30, s[32:35], s85 offen lds
    ds_read_b64_tr_b16 v[156:157], v12 offset:16384
    v_mfma_f32_16x16x32_bf16 v[52:55], v[212:215], v[232:235], v[52:55]
    s_add_u32 m0, s76, 16384
    s_add_u32 s85, s75, 1
    s_and_b32 s85, s85, 15
    s_lshl_b32 s85, s85, 15
    buffer_load_dwordx4 v30, s[32:35], s85 offen lds
    ds_read_b64_tr_b16 v[158:159], v12 offset:17408
    v_mfma_f32_16x16x32_bf16 v[68:71], v[212:215], v[236:239], v[68:71]
    s_add_u32 m0, s76, 17408
    s_add_u32 s85, s85, s81
    buffer_load_dwordx4 v30, s[32:35], s85 offen lds
    ds_read_b128 v[132:135], v9 offset:40960
    v_mfma_f32_16x16x32_bf16 v[84:87], v[212:215], v[240:243], v[84:87]
    ds_read_b128 v[136:139], v9 offset:43008
    v_lshrrev_b32 v26, 4, v1
    v_bfe_u32 v27, v1, 2, 2
    s_lshl_b32 s6, s77, 14
    s_lshl_b32 s7, s75, 10
    v_mfma_f32_16x16x32_bf16 v[100:103], v[212:215], v[244:247], v[100:103]
    ds_read_b128 v[140:143], v9 offset:45056
    v_and_b32 v28, 1, v26
    v_lshlrev_b32 v28, 1, v28
    s_add_u32 s40, s7, 0
    s_and_b32 s40, s40, 0x3c00
    s_or_b32 s40, s40, s6
    s_add_u32 s41, s7, 1024
    s_and_b32 s41, s41, 0x3c00
    s_or_b32 s41, s41, s6
    v_mfma_f32_16x16x32_bf16 v[116:119], v[212:215], v[248:251], v[116:119]
    ds_read_b128 v[144:147], v9 offset:47104
    v_lshrrev_b32 v29, 1, v27
    v_or_b32 v28, v28, v29
    s_add_u32 s42, s7, 2048
    s_and_b32 s42, s42, 0x3c00
    s_or_b32 s42, s42, s6
    s_add_u32 s43, s7, 3072
    s_and_b32 s43, s43, 0x3c00
    s_or_b32 s43, s43, s6
    v_mfma_f32_16x16x32_bf16 v[40:43], v[216:219], v[228:231], v[40:43]
    ds_read_b128 v[148:151], v9 offset:49152
    v_lshlrev_b32 v28, 5, v28
    v_and_b32 v29, 3, v1
    s_add_u32 s44, s7, 4096
    s_and_b32 s44, s44, 0x3c00
    s_or_b32 s44, s44, s6
    s_add_u32 s45, s7, 5120
    s_and_b32 s45, s45, 0x3c00
    s_or_b32 s45, s45, s6
    v_mfma_f32_16x16x32_bf16 v[56:59], v[216:219], v[232:235], v[56:59]
    ds_read_b128 v[152:155], v9 offset:51200
    v_mfma_f32_16x16x32_bf16 v[72:75], v[216:219], v[236:239], v[72:75]
    ds_read_b64_tr_b16 v[160:161], v12 offset:24576
    v_lshl_add_u32 v28, v29, 3, v28
    v_lshl_add_u32 v29, v26, 2, v27
    s_add_u32 s46, s7, 6144
    s_and_b32 s46, s46, 0x3c00
    s_or_b32 s46, s46, s6
    s_add_u32 s47, s7, 7168
    s_and_b32 s47, s47, 0x3c00
    s_or_b32 s47, s47, s6
    v_mfma_f32_16x16x32_bf16 v[88:91], v[216:219], v[240:243], v[88:91]
    ds_read_b64_tr_b16 v[162:163], v12 offset:25600
    v_lshl_add_u32 v28, v29, 7, v28
    s_lshl_b32 s86, s77, 12
    v_add_u32 v20, s86, v28
    v_mfma_f32_16x16x32_bf16 v[104:107], v[216:219], v[244:247], v[104:107]
    ds_read_b64_tr_b16 v[164:165], v13 offset:16384
    v_xor_b32 v21, 32, v20
    v_xor_b32 v22, 64, v20
    s_add_u32 s48, s7, 8192
    s_and_b32 s48, s48, 0x3c00
    s_or_b32 s48, s48, s6
    s_add_u32 s49, s7, 9216
    s_and_b32 s49, s49, 0x3c00
    s_or_b32 s49, s49, s6
    v_mfma_f32_16x16x32_bf16 v[120:123], v[216:219], v[248:251], v[120:123]
    s_setprio 0
    ds_read_b64_tr_b16 v[166:167], v13 offset:17408
    v_mfma_f32_16x16x32_bf16 v[44:47], v[220:223], v[228:231], v[44:47]
    ds_read_b64_tr_b16 v[168:169], v13 offset:24576
    v_xor_b32 v23, 0x60, v20
    v_and_b32 v28, 0x3ff, v35
    s_add_u32 s50, s7, 10240
    s_and_b32 s50, s50, 0x3c00
    s_or_b32 s50, s50, s6
    s_add_u32 s51, s7, 11264
    s_and_b32 s51, s51, 0x3c00
    s_or_b32 s51, s51, s6
    v_mfma_f32_16x16x32_bf16 v[60:63], v[220:223], v[232:235], v[60:63]
    ds_read_b64_tr_b16 v[170:171], v13 offset:25600
    s_lshl_b32 s86, s77, 16
    s_lshl_b32 s87, s78, 14
    s_add_u32 s86, s86, s87
    s_add_u32 s86, s86, 1572864
    v_lshrrev_b32 v29, 3, v1
    v_lshl_add_u32 v28, v29, 10, v28
    v_mfma_f32_16x16x32_bf16 v[76:79], v[220:223], v[236:239], v[76:79]
    v_add_u32 v31, s86, v28
    s_lshl_b32 s86, s79, 2
    s_lshl_b32 s87, s78, 1
    s_add_u32 s86, s86, s87
    s_mul_i32 s87, s86, 74752
    v_mfma_f32_16x16x32_bf16 v[92:95], v[220:223], v[240:243], v[92:95]
    v_mfma_f32_16x16x32_bf16 v[108:111], v[220:223], v[244:247], v[108:111]
    v_lshl_add_u32 v4, v1, 4, s87
    v_add_u32 v5, 74752, v4
    s_add_u32 s52, s7, 12288
    s_and_b32 s52, s52, 0x3c00
    s_or_b32 s52, s52, s6
    s_add_u32 s53, s7, 13312
    s_and_b32 s53, s53, 0x3c00
    s_or_b32 s53, s53, s6
    v_mfma_f32_16x16x32_bf16 v[124:127], v[220:223], v[248:251], v[124:127]
    v_lshrrev_b32 v26, 1, v1
    v_add_u32 v26, s75, v26
    v_and_b32 v26, 15, v26
    s_add_u32 s54, s7, 14336
    s_and_b32 s54, s54, 0x3c00
    s_or_b32 s54, s54, s6
    s_add_u32 s55, s7, 15360
    s_and_b32 s55, s55, 0x3c00
    s_or_b32 s55, s55, s6
    v_mfma_f32_16x16x32_bf16 v[48:51], v[224:227], v[228:231], v[48:51]
    v_and_b32 v27, 1, v1
    v_add_u32 v27, s86, v27
    s_lshl_b32 s6, s77, 11
    s_add_u32 s59, s6, 65536
    s_add_u32 s60, s6, 66560
    v_mfma_f32_16x16x32_bf16 v[64:67], v[224:227], v[232:235], v[64:67]
    v_mfma_f32_16x16x32_bf16 v[80:83], v[224:227], v[236:239], v[80:83]
    v_add_u32 v28, 2, v27
    v_mul_u32_u24 v28, 6554, v28
    v_lshrrev_b32 v28, 16, v28
    s_mov_b32 s16, s90
    s_mov_b32 s17, s91
    s_mov_b32 s18, 2097152
    s_mov_b32 s19, 0x20000
    v_mfma_f32_16x16x32_bf16 v[96:99], v[224:227], v[240:243], v[96:99]
    v_mul_u32_u24 v27, 5958, v27
    v_lshrrev_b32 v27, 16, v27
    s_mov_b32 s12, s88
    s_mov_b32 s13, s89
    s_mov_b32 s14, 1835008
    s_mov_b32 s15, 0x20000
    v_mfma_f32_16x16x32_bf16 v[112:115], v[224:227], v[244:247], v[112:115]
    v_add_u32 v28, -1, v28
    v_max_i32 v27, v27, v28
    v_mfma_f32_16x16x32_bf16 v[128:131], v[224:227], v[248:251], v[128:131]
    s_waitcnt lgkmcnt(0)
    s_waitcnt vmcnt(4)
    s_barrier
    s_setprio 2
    v_mfma_f32_16x16x32_bf16 v[36:39], v[156:159], v[132:135], v[36:39]
    ds_read_b64_tr_b16 v[212:213], v12 offset:49152
    v_mul_u32_u24 v27, 14, v27
    v_lshrrev_b32 v28, 2, v26
    s_lshl_b32 s99, s77, 2
    s_sub_u32 s99, s99, 4
    v_mfma_f32_16x16x32_bf16 v[52:55], v[156:159], v[136:139], v[52:55]
    ds_read_b64_tr_b16 v[214:215], v12 offset:50176
    v_add3_u32 v28, v28, s99, v27
    s_mul_i32 s86, s79, 21846
    s_lshr_b32 s86, s86, 16
    s_lshl_b32 s86, s86, 3
    s_add_u32 s86, s86, 168
    v_lshrrev_b32 v26, 1, v26
    v_mfma_f32_16x16x32_bf16 v[68:71], v[156:159], v[140:143], v[68:71]
    ds_read_b128 v[228:231], v252 offset:0
    v_add_u32 v26, s86, v26
    s_cmp_eq_u32 s77, 0
    s_cselect_b64 s[100:101], -1, 0
    v_cndmask_b32 v28, v28, v26, s[100:101]
    v_mfma_f32_16x16x32_bf16 v[84:87], v[156:159], v[144:147], v[84:87]
    ds_read_b128 v[232:235], v252 offset:2048
    v_mfma_f32_16x16x32_bf16 v[100:103], v[156:159], v[148:151], v[100:103]
    ds_read_b128 v[236:239], v252 offset:4096
    s_lshr_b32 s99, s77, 1
    s_add_u32 s99, s99, 12
    v_add_u32 v27, s99, v27
    s_mov_b32 s100, 0
    s_mov_b32 s101, -1
    v_cndmask_b32 v28, v28, v27, s[100:101]
    v_mfma_f32_16x16x32_bf16 v[116:119], v[156:159], v[152:155], v[116:119]
    ds_read_b128 v[240:243], v252 offset:6144
    v_lshlrev_b32 v6, 7, v28
    v_lshrrev_b32 v26, 3, v0
    v_mfma_f32_16x16x32_bf16 v[40:43], v[160:163], v[132:135], v[40:43]
    ds_read_b128 v[244:247], v252 offset:8192
    v_mfma_f32_16x16x32_bf16 v[56:59], v[160:163], v[136:139], v[56:59]
    ds_read_b128 v[248:251], v252 offset:10240
    v_and_b32 v29, 7, v0
    v_lshlrev_b32 v26, 10, v26
    v_mfma_f32_16x16x32_bf16 v[72:75], v[160:163], v[140:143], v[72:75]
    ds_read_b64_tr_b16 v[216:217], v12 offset:57344
    s_lshl_b32 s86, s79, 16
    s_lshl_b32 s87, s80, 7
    s_add_u32 s86, s86, s87
    v_lshl_add_u32 v26, v29, 4, v26
    v_add_u32 v7, s86, v26
    v_mfma_f32_16x16x32_bf16 v[88:91], v[160:163], v[144:147], v[88:91]
    ds_read_b64_tr_b16 v[218:219], v12 offset:58368
    ds_read_b64 v[188:189], v14 offset:0
    v_mfma_f32_16x16x32_bf16 v[104:107], v[160:163], v[148:151], v[104:107]
    ds_read_b64_tr_b16 v[220:221], v13 offset:49152
    v_mfma_f32_16x16x32_bf16 v[120:123], v[160:163], v[152:155], v[120:123]
    ds_read_b64_tr_b16 v[222:223], v13 offset:50176
    ds_read_b64 v[190:191], v14 offset:128
    v_mfma_f32_16x16x32_bf16 v[44:47], v[164:167], v[132:135], v[44:47]
    ds_read_b64_tr_b16 v[224:225], v13 offset:57344
    ds_read_b64 v[192:193], v14 offset:256
    v_mfma_f32_16x16x32_bf16 v[60:63], v[164:167], v[136:139], v[60:63]
    ds_read_b64_tr_b16 v[226:227], v13 offset:58368
    v_mfma_f32_16x16x32_bf16 v[76:79], v[164:167], v[140:143], v[76:79]
    ds_read_b64 v[194:195], v14 offset:384
    v_mfma_f32_16x16x32_bf16 v[92:95], v[164:167], v[144:147], v[92:95]
    ds_read_b64 v[196:197], v14 offset:512
    v_mfma_f32_16x16x32_bf16 v[108:111], v[164:167], v[148:151], v[108:111]
    ds_read_b64 v[198:199], v14 offset:640
    v_mfma_f32_16x16x32_bf16 v[124:127], v[164:167], v[152:155], v[124:127]
    v_mfma_f32_16x16x32_bf16 v[48:51], v[168:171], v[132:135], v[48:51]
    ds_read_b64 v[200:201], v15 offset:0
    v_mfma_f32_16x16x32_bf16 v[64:67], v[168:171], v[136:139], v[64:67]
    ds_read_b64 v[202:203], v15 offset:128
    v_mfma_f32_16x16x32_bf16 v[80:83], v[168:171], v[140:143], v[80:83]
    v_mfma_f32_16x16x32_bf16 v[96:99], v[168:171], v[144:147], v[96:99]
    ds_read_b64 v[204:205], v15 offset:256
    v_mfma_f32_16x16x32_bf16 v[112:115], v[168:171], v[148:151], v[112:115]
    ds_read_b64 v[206:207], v15 offset:384
    v_mfma_f32_16x16x32_bf16 v[128:131], v[168:171], v[152:155], v[128:131]
    s_waitcnt lgkmcnt(0)
    v_mfma_f32_16x16x32_bf16 v[36:39], v[212:215], v[228:231], v[36:39]
    ds_read_b64_tr_b16 v[156:157], v12 offset:32768
    v_cmp_gt_u32 vcc, 16, v1
    v_mov_b32 v184, 0xffff
    s_nop 0
    v_cndmask_b32 v185, 0, v184, vcc
    v_mfma_f32_16x16x32_bf16 v[40:43], v[216:219], v[228:231], v[40:43]
    ds_read_b64_tr_b16 v[158:159], v12 offset:33792
    v_and_b32 v173, v188, v185
    v_lshl_or_b32 v172, v173, 16, v173
    v_mfma_f32_16x16x32_bf16 v[44:47], v[220:223], v[228:231], v[44:47]
    ds_read_b128 v[132:135], v253 offset:0
    v_and_b32 v188, 0xffff0000, v188
    v_mul_f32 v189, s57, v189
    v_and_b32 v175, v190, v185
    v_lshl_or_b32 v174, v175, 16, v175
    v_mfma_f32_16x16x32_bf16 v[48:51], v[224:227], v[228:231], v[48:51]
    ds_read_b128 v[136:139], v253 offset:2048
    v_and_b32 v190, 0xffff0000, v190
    v_mul_f32 v191, s57, v191
    v_mfma_f32_16x16x32_bf16 v[52:55], v[212:215], v[232:235], v[52:55]
    ds_read_b128 v[140:143], v253 offset:4096
    v_and_b32 v177, v192, v185
    v_lshl_or_b32 v176, v177, 16, v177
    v_mfma_f32_16x16x32_bf16 v[56:59], v[216:219], v[232:235], v[56:59]
    ds_read_b128 v[144:147], v253 offset:6144
    v_and_b32 v192, 0xffff0000, v192
    v_mul_f32 v193, s57, v193
    v_and_b32 v179, v194, v185
    v_lshl_or_b32 v178, v179, 16, v179
    v_mfma_f32_16x16x32_bf16 v[60:63], v[220:223], v[232:235], v[60:63]
    ds_read_b128 v[148:151], v253 offset:8192
    v_and_b32 v194, 0xffff0000, v194
    v_mul_f32 v195, s57, v195
    v_mfma_f32_16x16x32_bf16 v[64:67], v[224:227], v[232:235], v[64:67]
    ds_read_b128 v[152:155], v253 offset:10240
    v_and_b32 v181, v196, v185
    v_lshl_or_b32 v180, v181, 16, v181
    v_and_b32 v196, 0xffff0000, v196
    v_mul_f32 v197, s57, v197
    v_mfma_f32_16x16x32_bf16 v[68:71], v[212:215], v[236:239], v[68:71]
    ds_read_b64_tr_b16 v[160:161], v12 offset:40960
    v_and_b32 v183, v198, v185
    v_lshl_or_b32 v182, v183, 16, v183
    v_mfma_f32_16x16x32_bf16 v[72:75], v[216:219], v[236:239], v[72:75]
    ds_read_b64_tr_b16 v[162:163], v12 offset:41984
    v_and_b32 v198, 0xffff0000, v198
    v_mul_f32 v199, s57, v199
    v_mfma_f32_16x16x32_bf16 v[76:79], v[220:223], v[236:239], v[76:79]
    ds_read_b64_tr_b16 v[164:165], v13 offset:32768
    v_mfma_f32_16x16x32_bf16 v[80:83], v[224:227], v[236:239], v[80:83]
    ds_read_b64_tr_b16 v[166:167], v13 offset:33792
    v_mfma_f32_16x16x16_bf16 v[36:39], v[200:201], v[172:173], v[36:39]
    ds_read_b64_tr_b16 v[168:169], v13 offset:40960
    v_mfma_f32_16x16x16_bf16 v[44:47], v[204:205], v[172:173], v[44:47]
    ds_read_b64_tr_b16 v[170:171], v13 offset:41984
    v_mfma_f32_16x16x16_bf16 v[40:43], v[202:203], v[172:173], v[40:43]
    v_mfma_f32_16x16x16_bf16 v[48:51], v[206:207], v[172:173], v[48:51]
    v_mfma_f32_16x16x16_bf16 v[52:55], v[200:201], v[174:175], v[52:55]
    v_mfma_f32_16x16x16_bf16 v[60:63], v[204:205], v[174:175], v[60:63]
    v_mfma_f32_16x16x16_bf16 v[56:59], v[202:203], v[174:175], v[56:59]
    v_mfma_f32_16x16x16_bf16 v[64:67], v[206:207], v[174:175], v[64:67]
    s_lshl_b32 s86, s36, 2
    s_add_u32 s86, s86, 161024
    v_mov_b32 v254, s86
    s_waitcnt vmcnt(0) lgkmcnt(0)
    ds_write_b32 v254, v25
    v_mfma_f32_16x16x32_bf16 v[36:39], v[156:159], v[132:135], v[36:39]
    v_mfma_f32_16x16x32_bf16 v[44:47], v[164:167], v[132:135], v[44:47]
    v_mfma_f32_16x16x32_bf16 v[40:43], v[160:163], v[132:135], v[40:43]
    v_mfma_f32_16x16x32_bf16 v[48:51], v[168:171], v[132:135], v[48:51]
    v_mfma_f32_16x16x32_bf16 v[84:87], v[212:215], v[240:243], v[84:87]
    v_mfma_f32_16x16x32_bf16 v[88:91], v[216:219], v[240:243], v[88:91]
    v_mfma_f32_16x16x32_bf16 v[92:95], v[220:223], v[240:243], v[92:95]
    v_mfma_f32_16x16x32_bf16 v[96:99], v[224:227], v[240:243], v[96:99]
    v_mfma_f32_16x16x32_bf16 v[52:55], v[156:159], v[136:139], v[52:55]
    v_mfma_f32_16x16x32_bf16 v[60:63], v[164:167], v[136:139], v[60:63]
    v_mfma_f32_16x16x32_bf16 v[56:59], v[160:163], v[136:139], v[56:59]
    v_mfma_f32_16x16x32_bf16 v[64:67], v[168:171], v[136:139], v[64:67]
    v_mfma_f32_16x16x32_bf16 v[100:103], v[212:215], v[244:247], v[100:103]
    v_mfma_f32_16x16x32_bf16 v[104:107], v[216:219], v[244:247], v[104:107]
    v_mfma_f32_16x16x32_bf16 v[108:111], v[220:223], v[244:247], v[108:111]
    v_mfma_f32_16x16x32_bf16 v[112:115], v[224:227], v[244:247], v[112:115]
    s_setprio 0
    v_mul_f32 v36, v36, v189
    v_mul_f32 v37, v37, v189
    v_mul_f32 v38, v38, v189
    v_mfma_f32_16x16x16_bf16 v[68:71], v[200:201], v[176:177], v[68:71]
    v_mul_f32 v39, v39, v189
    v_mul_f32 v44, v44, v189
    v_mul_f32 v45, v45, v189
    v_mfma_f32_16x16x16_bf16 v[76:79], v[204:205], v[176:177], v[76:79]
    v_mul_f32 v46, v46, v189
    v_mul_f32 v47, v47, v189
    v_exp_f32 v36, v36
    v_exp_f32 v37, v37
    v_mfma_f32_16x16x16_bf16 v[72:75], v[202:203], v[176:177], v[72:75]
    v_exp_f32 v38, v38
    v_exp_f32 v39, v39
    v_mfma_f32_16x16x16_bf16 v[80:83], v[206:207], v[176:177], v[80:83]
    v_exp_f32 v44, v44
    v_exp_f32 v45, v45
    v_mfma_f32_16x16x32_bf16 v[68:71], v[156:159], v[140:143], v[68:71]
    v_exp_f32 v46, v46
    v_exp_f32 v47, v47
    v_mfma_f32_16x16x32_bf16 v[76:79], v[164:167], v[140:143], v[76:79]
    v_fma_f32 v36, v36, v188, v188
    v_fma_f32 v37, v37, v188, v188
    v_fma_f32 v38, v38, v188, v188
    v_mfma_f32_16x16x32_bf16 v[72:75], v[160:163], v[140:143], v[72:75]
    v_fma_f32 v39, v39, v188, v188
    v_fma_f32 v44, v44, v188, v188
    v_fma_f32 v45, v45, v188, v188
    v_mfma_f32_16x16x32_bf16 v[80:83], v[168:171], v[140:143], v[80:83]
    v_fma_f32 v46, v46, v188, v188
    v_fma_f32 v47, v47, v188, v188
    v_rcp_f32 v36, v36
    v_rcp_f32 v37, v37
    v_mfma_f32_16x16x32_bf16 v[116:119], v[212:215], v[248:251], v[116:119]
    v_rcp_f32 v38, v38
    v_rcp_f32 v39, v39
    v_mfma_f32_16x16x32_bf16 v[120:123], v[216:219], v[248:251], v[120:123]
    v_rcp_f32 v44, v44
    v_rcp_f32 v45, v45
    v_mfma_f32_16x16x32_bf16 v[124:127], v[220:223], v[248:251], v[124:127]
    v_rcp_f32 v46, v46
    v_rcp_f32 v47, v47
    v_mfma_f32_16x16x32_bf16 v[128:131], v[224:227], v[248:251], v[128:131]
    v_mul_f32 v40, v40, v36
    v_mul_f32 v41, v41, v37
    v_mul_f32 v42, v42, v38
    v_mul_f32 v43, v43, v39
    v_mul_f32 v48, v48, v44
    v_mul_f32 v49, v49, v45
    v_mul_f32 v50, v50, v46
    v_mul_f32 v51, v51, v47
    v_cvt_pk_bf16_f32 v16, v40, v41
    v_cvt_pk_bf16_f32 v17, v42, v43
    v_cvt_pk_bf16_f32 v18, v48, v49
    v_cvt_pk_bf16_f32 v19, v50, v51
    s_add_u32 s38, s56, 0
    buffer_store_dwordx4 v[16:19], v3, s[20:23], s38 offen sc1
    v_mul_f32 v52, v52, v191
    v_mul_f32 v53, v53, v191
    v_mul_f32 v54, v54, v191
    v_mul_f32 v55, v55, v191
    v_mul_f32 v60, v60, v191
    v_mul_f32 v61, v61, v191
    v_mul_f32 v62, v62, v191
    v_mul_f32 v63, v63, v191
    s_add_u32 s85, s75, 6
    s_and_b32 s85, s85, 15
    s_lshl_b32 s85, s85, 15
    buffer_load_dwordx4 v[220:223], v30, s[32:35], s85 offen
    v_exp_f32 v52, v52
    v_exp_f32 v53, v53
    v_mfma_f32_16x16x16_bf16 v[84:87], v[200:201], v[178:179], v[84:87]
    v_exp_f32 v54, v54
    v_exp_f32 v55, v55
    v_mfma_f32_16x16x16_bf16 v[92:95], v[204:205], v[178:179], v[92:95]
    v_exp_f32 v60, v60
    v_exp_f32 v61, v61
    v_mfma_f32_16x16x16_bf16 v[88:91], v[202:203], v[178:179], v[88:91]
    v_exp_f32 v62, v62
    v_exp_f32 v63, v63
    v_mfma_f32_16x16x16_bf16 v[96:99], v[206:207], v[178:179], v[96:99]
    s_add_u32 s85, s85, s81
    buffer_load_dwordx4 v[224:227], v30, s[32:35], s85 offen
    v_fma_f32 v52, v52, v190, v190
    v_fma_f32 v53, v53, v190, v190
    v_fma_f32 v54, v54, v190, v190
    v_fma_f32 v55, v55, v190, v190
    v_fma_f32 v60, v60, v190, v190
    v_fma_f32 v61, v61, v190, v190
    v_fma_f32 v62, v62, v190, v190
    v_fma_f32 v63, v63, v190, v190
    s_add_u32 s85, s75, 7
    s_and_b32 s85, s85, 15
    s_lshl_b32 s85, s85, 15
    buffer_load_dwordx4 v[228:231], v30, s[32:35], s85 offen
    v_rcp_f32 v52, v52
    v_rcp_f32 v53, v53
    v_mfma_f32_16x16x32_bf16 v[84:87], v[156:159], v[144:147], v[84:87]
    v_rcp_f32 v54, v54
    v_rcp_f32 v55, v55
    v_mfma_f32_16x16x32_bf16 v[92:95], v[164:167], v[144:147], v[92:95]
    v_rcp_f32 v60, v60
    v_rcp_f32 v61, v61
    v_mfma_f32_16x16x32_bf16 v[88:91], v[160:163], v[144:147], v[88:91]
    v_rcp_f32 v62, v62
    v_rcp_f32 v63, v63
    v_mfma_f32_16x16x32_bf16 v[96:99], v[168:171], v[144:147], v[96:99]
    s_add_u32 s85, s85, s81
    buffer_load_dwordx4 v[232:235], v30, s[32:35], s85 offen
    v_mul_f32 v56, v56, v52
    v_mul_f32 v57, v57, v53
    v_mul_f32 v58, v58, v54
    v_mul_f32 v59, v59, v55
    v_mul_f32 v64, v64, v60
    v_mul_f32 v65, v65, v61
    v_mul_f32 v66, v66, v62
    v_mul_f32 v67, v67, v63
    s_add_u32 s85, s75, 8
    s_and_b32 s85, s85, 15
    s_lshl_b32 s85, s85, 15
    buffer_load_dwordx4 v[236:239], v30, s[32:35], s85 offen
    v_cvt_pk_bf16_f32 v208, v56, v57
    v_cvt_pk_bf16_f32 v209, v58, v59
    v_cvt_pk_bf16_f32 v210, v64, v65
    v_cvt_pk_bf16_f32 v211, v66, v67
    s_add_u32 s38, s56, 74752
    buffer_store_dwordx4 v[208:211], v3, s[20:23], s38 offen sc1
    v_mul_f32 v68, v68, v193
    v_mul_f32 v69, v69, v193
    v_mul_f32 v70, v70, v193
    v_mul_f32 v71, v71, v193
    v_mul_f32 v76, v76, v193
    v_mul_f32 v77, v77, v193
    v_mul_f32 v78, v78, v193
    v_mul_f32 v79, v79, v193
    s_add_u32 s85, s85, s81
    buffer_load_dwordx4 v[240:243], v30, s[32:35], s85 offen
    v_exp_f32 v68, v68
    v_exp_f32 v69, v69
    v_mfma_f32_16x16x16_bf16 v[100:103], v[200:201], v[180:181], v[100:103]
    v_exp_f32 v70, v70
    v_exp_f32 v71, v71
    v_mfma_f32_16x16x16_bf16 v[108:111], v[204:205], v[180:181], v[108:111]
    v_exp_f32 v76, v76
    v_exp_f32 v77, v77
    v_mfma_f32_16x16x16_bf16 v[104:107], v[202:203], v[180:181], v[104:107]
    v_exp_f32 v78, v78
    v_exp_f32 v79, v79
    v_mfma_f32_16x16x16_bf16 v[112:115], v[206:207], v[180:181], v[112:115]
    s_add_u32 s85, s75, 9
    s_and_b32 s85, s85, 15
    s_lshl_b32 s85, s85, 15
    buffer_load_dwordx4 v[244:247], v30, s[32:35], s85 offen
    v_fma_f32 v68, v68, v192, v192
    v_fma_f32 v69, v69, v192, v192
    v_fma_f32 v70, v70, v192, v192
    v_fma_f32 v71, v71, v192, v192
    v_fma_f32 v76, v76, v192, v192
    v_fma_f32 v77, v77, v192, v192
    v_fma_f32 v78, v78, v192, v192
    v_fma_f32 v79, v79, v192, v192
    s_add_u32 s85, s85, s81
    buffer_load_dwordx4 v[248:251], v30, s[32:35], s85 offen
    v_rcp_f32 v68, v68
    v_rcp_f32 v69, v69
    v_mfma_f32_16x16x32_bf16 v[100:103], v[156:159], v[148:151], v[100:103]
    v_rcp_f32 v70, v70
    v_rcp_f32 v71, v71
    v_mfma_f32_16x16x32_bf16 v[108:111], v[164:167], v[148:151], v[108:111]
    v_rcp_f32 v76, v76
    v_rcp_f32 v77, v77
    v_mfma_f32_16x16x32_bf16 v[104:107], v[160:163], v[148:151], v[104:107]
    v_rcp_f32 v78, v78
    v_rcp_f32 v79, v79
    v_mfma_f32_16x16x32_bf16 v[112:115], v[168:171], v[148:151], v[112:115]
    v_mul_f32 v72, v72, v68
    v_mul_f32 v73, v73, v69
    v_mul_f32 v74, v74, v70
    v_mul_f32 v75, v75, v71
    v_mul_f32 v80, v80, v76
    v_mul_f32 v81, v81, v77
    v_mul_f32 v82, v82, v78
    v_mul_f32 v83, v83, v79
    v_cvt_pk_bf16_f32 v16, v72, v73
    v_cvt_pk_bf16_f32 v17, v74, v75
    v_cvt_pk_bf16_f32 v18, v80, v81
    v_cvt_pk_bf16_f32 v19, v82, v83
    s_add_u32 s38, s56, 149504
    buffer_store_dwordx4 v[16:19], v3, s[20:23], s38 offen sc1
    v_mul_f32 v84, v84, v195
    v_mul_f32 v85, v85, v195
    v_mul_f32 v86, v86, v195
    v_mul_f32 v87, v87, v195
    v_mul_f32 v92, v92, v195
    v_mul_f32 v93, v93, v195
    v_mul_f32 v94, v94, v195
    v_mul_f32 v95, v95, v195
    v_exp_f32 v84, v84
    v_exp_f32 v85, v85
    v_mfma_f32_16x16x16_bf16 v[116:119], v[200:201], v[182:183], v[116:119]
    v_exp_f32 v86, v86
    v_exp_f32 v87, v87
    v_mfma_f32_16x16x16_bf16 v[124:127], v[204:205], v[182:183], v[124:127]
    v_exp_f32 v92, v92
    v_exp_f32 v93, v93
    v_mfma_f32_16x16x16_bf16 v[120:123], v[202:203], v[182:183], v[120:123]
    v_exp_f32 v94, v94
    v_exp_f32 v95, v95
    v_mfma_f32_16x16x16_bf16 v[128:131], v[206:207], v[182:183], v[128:131]
    v_fma_f32 v84, v84, v194, v194
    v_fma_f32 v85, v85, v194, v194
    v_fma_f32 v86, v86, v194, v194
    v_fma_f32 v87, v87, v194, v194
    v_fma_f32 v92, v92, v194, v194
    v_fma_f32 v93, v93, v194, v194
    v_fma_f32 v94, v94, v194, v194
    v_fma_f32 v95, v95, v194, v194
    v_rcp_f32 v84, v84
    v_rcp_f32 v85, v85
    v_mfma_f32_16x16x32_bf16 v[116:119], v[156:159], v[152:155], v[116:119]
    v_rcp_f32 v86, v86
    v_rcp_f32 v87, v87
    v_mfma_f32_16x16x32_bf16 v[124:127], v[164:167], v[152:155], v[124:127]
    v_rcp_f32 v92, v92
    v_rcp_f32 v93, v93
    v_mfma_f32_16x16x32_bf16 v[120:123], v[160:163], v[152:155], v[120:123]
    v_rcp_f32 v94, v94
    v_rcp_f32 v95, v95
    v_mfma_f32_16x16x32_bf16 v[128:131], v[168:171], v[152:155], v[128:131]
    v_mul_f32 v88, v88, v84
    v_mul_f32 v89, v89, v85
    v_mul_f32 v90, v90, v86
    v_mul_f32 v91, v91, v87
    v_mul_f32 v96, v96, v92
    v_mul_f32 v97, v97, v93
    v_mul_f32 v98, v98, v94
    v_mul_f32 v99, v99, v95
    v_cvt_pk_bf16_f32 v208, v88, v89
    v_cvt_pk_bf16_f32 v209, v90, v91
    v_cvt_pk_bf16_f32 v210, v96, v97
    v_cvt_pk_bf16_f32 v211, v98, v99
    s_add_u32 s38, s56, 224256
    buffer_store_dwordx4 v[208:211], v3, s[20:23], s38 offen sc1
    v_mul_f32 v100, v100, v197
    v_mul_f32 v101, v101, v197
    v_mul_f32 v102, v102, v197
    v_mul_f32 v103, v103, v197
    v_mul_f32 v108, v108, v197
    v_mul_f32 v109, v109, v197
    v_mul_f32 v110, v110, v197
    v_mul_f32 v111, v111, v197
    v_exp_f32 v100, v100
    v_exp_f32 v101, v101
    v_exp_f32 v102, v102
    v_exp_f32 v103, v103
    v_exp_f32 v108, v108
    v_exp_f32 v109, v109
    v_exp_f32 v110, v110
    v_exp_f32 v111, v111
    v_fma_f32 v100, v100, v196, v196
    v_fma_f32 v101, v101, v196, v196
    v_fma_f32 v102, v102, v196, v196
    v_fma_f32 v103, v103, v196, v196
    v_fma_f32 v108, v108, v196, v196
    v_fma_f32 v109, v109, v196, v196
    v_fma_f32 v110, v110, v196, v196
    v_fma_f32 v111, v111, v196, v196
    v_rcp_f32 v100, v100
    v_rcp_f32 v101, v101
    v_rcp_f32 v102, v102
    v_rcp_f32 v103, v103
    v_rcp_f32 v108, v108
    v_rcp_f32 v109, v109
    v_rcp_f32 v110, v110
    v_rcp_f32 v111, v111
    v_mul_f32 v104, v104, v100
    v_mul_f32 v105, v105, v101
    v_mul_f32 v106, v106, v102
    v_mul_f32 v107, v107, v103
    v_mul_f32 v112, v112, v108
    v_mul_f32 v113, v113, v109
    v_mul_f32 v114, v114, v110
    v_mul_f32 v115, v115, v111
    v_cvt_pk_bf16_f32 v16, v104, v105
    v_cvt_pk_bf16_f32 v17, v106, v107
    v_cvt_pk_bf16_f32 v18, v112, v113
    v_cvt_pk_bf16_f32 v19, v114, v115
    s_add_u32 s38, s56, 299008
    buffer_store_dwordx4 v[16:19], v3, s[20:23], s38 offen sc1
    v_mul_f32 v116, v116, v199
    v_mul_f32 v117, v117, v199
    v_mul_f32 v118, v118, v199
    v_mul_f32 v119, v119, v199
    v_mul_f32 v124, v124, v199
    v_mul_f32 v125, v125, v199
    v_mul_f32 v126, v126, v199
    v_mul_f32 v127, v127, v199
    v_exp_f32 v116, v116
    v_exp_f32 v117, v117
    v_exp_f32 v118, v118
    v_exp_f32 v119, v119
    v_exp_f32 v124, v124
    v_exp_f32 v125, v125
    v_exp_f32 v126, v126
    v_exp_f32 v127, v127
    v_fma_f32 v116, v116, v198, v198
    v_fma_f32 v117, v117, v198, v198
    v_fma_f32 v118, v118, v198, v198
    v_fma_f32 v119, v119, v198, v198
    v_fma_f32 v124, v124, v198, v198
    v_fma_f32 v125, v125, v198, v198
    v_fma_f32 v126, v126, v198, v198
    v_fma_f32 v127, v127, v198, v198
    v_rcp_f32 v116, v116
    v_rcp_f32 v117, v117
    v_rcp_f32 v118, v118
    v_rcp_f32 v119, v119
    v_rcp_f32 v124, v124
    v_rcp_f32 v125, v125
    v_rcp_f32 v126, v126
    v_rcp_f32 v127, v127
    v_mul_f32 v120, v120, v116
    v_mul_f32 v121, v121, v117
    v_mul_f32 v122, v122, v118
    v_mul_f32 v123, v123, v119
    v_mul_f32 v128, v128, v124
    v_mul_f32 v129, v129, v125
    v_mul_f32 v130, v130, v126
    v_mul_f32 v131, v131, v127
    v_cvt_pk_bf16_f32 v208, v120, v121
    v_cvt_pk_bf16_f32 v209, v122, v123
    v_cvt_pk_bf16_f32 v210, v128, v129
    v_cvt_pk_bf16_f32 v211, v130, v131
    s_add_u32 s38, s56, 373760
    buffer_store_dwordx4 v[208:211], v3, s[20:23], s38 offen sc1
    s_branch P2_start
K_glu5:
    s_waitcnt vmcnt(4)
    s_cmp_lg_u32 s36, 0
    s_cbranch_scc1 AR_10
    s_bfe_u32 s96, s2, 0x10003
    s_lshl_b32 s96, s96, 7
    v_mov_b32 v254, 1
    v_mov_b32 v2, 0
    s_mov_b64 exec, 1
    buffer_atomic_add v254, v2, s[28:31], s96 offen sc1
    s_mov_b64 exec, -1
AR_10:
    s_barrier
    ds_read_b64_tr_b16 v[216:217], v12 offset:32768
    ds_read_b64_tr_b16 v[218:219], v12 offset:33792
    ds_read_b128 v[232:235], v8 offset:40960
    ds_read_b128 v[236:239], v8 offset:43008
    ds_read_b128 v[240:243], v8 offset:45056
    ds_read_b128 v[244:247], v8 offset:47104
    ds_read_b128 v[248:251], v8 offset:49152
    ds_read_b64_tr_b16 v[220:221], v12 offset:40960
    ds_read_b64_tr_b16 v[222:223], v12 offset:41984
    ds_read_b64_tr_b16 v[224:225], v13 offset:32768
    ds_read_b64_tr_b16 v[226:227], v13 offset:33792
    ds_read_b64_tr_b16 v[228:229], v13 offset:40960
    ds_read_b64_tr_b16 v[230:231], v13 offset:41984
    v_mov_b32 v16, 0x3f803f80
    v_mov_b32 v17, 0x3f803f80
    v_mov_b32 v18, 0x3f803f80
    v_mov_b32 v19, 0x3f803f80
    s_waitcnt lgkmcnt(0)
    s_setprio 1
    v_mfma_f32_16x16x32_bf16 v[36:39], v[216:219], v[232:235], 0
    s_add_u32 m0, s37, 73728
    s_add_u32 s38, s49, 0
    buffer_load_dwordx4 v7, s[16:19], s38 offen lds
    ds_read_b64_tr_b16 v[136:137], v10 offset:24576
    v_mfma_f32_16x16x32_bf16 v[52:55], v[216:219], v[236:239], 0
    s_add_u32 m0, s37, 81920
    s_add_u32 s38, s49, 114688
    buffer_load_dwordx4 v7, s[12:15], s38 offen lds
    ds_read_b64_tr_b16 v[138:139], v10 offset:25600
    v_mfma_f32_16x16x32_bf16 v[68:71], v[216:219], v[240:243], 0
    s_add_u32 m0, s37, 90112
    s_add_u32 s38, s49, 114688
    buffer_load_dwordx4 v7, s[16:19], s38 offen lds
    ds_read_b128 v[116:119], v9 offset:40960
    v_mfma_f32_16x16x32_bf16 v[84:87], v[216:219], v[244:247], 0
    ds_read_b128 v[120:123], v9 offset:43008
    v_mov_b32 v254, 0x80000000
    v_cmp_eq_u32 vcc, 0, v1
    v_mfma_f32_16x16x32_bf16 v[100:103], v[216:219], v[248:251], 0
    ds_read_b128 v[124:127], v9 offset:45056
    v_mfma_f32_16x16x32_bf16 v[40:43], v[220:223], v[232:235], 0
    ds_read_b128 v[128:131], v9 offset:47104
    v_mov_b32 v25, 1
    v_cndmask_b32 v24, v254, 0, vcc
    v_mfma_f32_16x16x32_bf16 v[56:59], v[220:223], v[236:239], 0
    ds_read_b128 v[132:135], v9 offset:49152
    v_mfma_f32_16x16x32_bf16 v[72:75], v[220:223], v[240:243], 0
    ds_read_b64_tr_b16 v[140:141], v10 offset:32768
    v_and_b32 v2, 15, v1
    v_cmp_eq_u32 vcc, 0, v2
    v_mfma_f32_16x16x32_bf16 v[88:91], v[220:223], v[244:247], 0
    ds_read_b64_tr_b16 v[142:143], v10 offset:33792
    v_mfma_f32_16x16x32_bf16 v[104:107], v[220:223], v[248:251], 0
    s_setprio 0
    ds_read_b64_tr_b16 v[144:145], v11 offset:24576
    v_and_b32 v26, 48, v1
    v_cndmask_b32 v23, v254, v26, vcc
    v_mfma_f32_16x16x32_bf16 v[44:47], v[224:227], v[232:235], 0
    ds_read_b64_tr_b16 v[146:147], v11 offset:25600
    v_mfma_f32_16x16x32_bf16 v[60:63], v[224:227], v[236:239], 0
    ds_read_b64_tr_b16 v[148:149], v11 offset:32768
    s_lshl_b32 s98, s36, 2
    s_add_u32 s98, s98, 161024
    v_mov_b32 v2, s98
    v_mov_b32 v26, 0
    ds_write_b32 v2, v26
    ds_write_b32 v2, v26 offset:32
    v_mfma_f32_16x16x32_bf16 v[76:79], v[224:227], v[240:243], 0
    ds_read_b64_tr_b16 v[150:151], v11 offset:33792
    v_mfma_f32_16x16x32_bf16 v[92:95], v[224:227], v[244:247], 0
    s_lshl_b32 s56, s4, 2
    s_add_u32 s56, s56, s77
    s_lshl_b32 s98, s77, 10
    s_add_u32 s64, s64, s98
    s_lshl_b32 s98, s78, 9
    s_add_u32 s64, s64, s98
    s_cmp_eq_u32 s36, 0
    s_cselect_b32 s67, s67, 1073741824
    v_add_u32 v252, 131072, v8
    v_add_u32 v253, 131072, v9
    v_mfma_f32_16x16x32_bf16 v[108:111], v[224:227], v[248:251], 0
    v_mfma_f32_16x16x32_bf16 v[48:51], v[228:231], v[232:235], 0
    s_add_u32 m0, s37, 0
    s_nop 0
    buffer_load_dwordx4 v4, s[8:11], s42 offen lds
    v_mfma_f32_16x16x32_bf16 v[64:67], v[228:231], v[236:239], 0
    v_mfma_f32_16x16x32_bf16 v[80:83], v[228:231], v[240:243], 0
    s_add_u32 m0, s37, 8192
    s_nop 0
    buffer_load_dwordx4 v5, s[8:11], s42 offen lds
    v_mfma_f32_16x16x32_bf16 v[96:99], v[228:231], v[244:247], 0
    v_mfma_f32_16x16x32_bf16 v[112:115], v[228:231], v[248:251], 0
    s_waitcnt lgkmcnt(0)
    s_cmp_ge_u32 s5, 8
    s_cbranch_scc0 SK_11
    v_mfma_f32_16x16x32_bf16 v[184:187], v[224:227], v[16:19], 0
    v_mfma_f32_16x16x32_bf16 v[188:191], v[228:231], v[16:19], 0
    v_mfma_f32_16x16x32_bf16 v[184:187], v[144:147], v[16:19], v[184:187]
    v_mfma_f32_16x16x32_bf16 v[188:191], v[148:151], v[16:19], v[188:191]
SK_11:
    s_barrier
    s_setprio 3
    v_mfma_f32_16x16x32_bf16 v[36:39], v[136:139], v[116:119], v[36:39]
    s_add_u32 m0, s37, 16384
    s_nop 0
    buffer_load_dwordx4 v6, s[8:11], s42 offen lds
    v_mfma_f32_16x16x32_bf16 v[52:55], v[136:139], v[120:123], v[52:55]
    s_add_u32 m0, s37, 114688
    s_add_u32 s38, s50, 0
    buffer_load_dwordx4 v7, s[12:15], s38 offen lds
    v_mfma_f32_16x16x32_bf16 v[68:71], v[136:139], v[124:127], v[68:71]
    s_add_u32 m0, s37, 122880
    s_add_u32 s38, s50, 0
    buffer_load_dwordx4 v7, s[16:19], s38 offen lds
    v_mfma_f32_16x16x32_bf16 v[84:87], v[136:139], v[128:131], v[84:87]
    s_add_u32 m0, s37, 98304
    s_add_u32 s38, s50, 114688
    buffer_load_dwordx4 v7, s[12:15], s38 offen lds
    v_mfma_f32_16x16x32_bf16 v[100:103], v[136:139], v[132:135], v[100:103]
    s_add_u32 m0, s37, 106496
    s_add_u32 s38, s50, 114688
    buffer_load_dwordx4 v7, s[16:19], s38 offen lds
    v_mfma_f32_16x16x32_bf16 v[40:43], v[140:143], v[116:119], v[40:43]
    s_lshl_b32 s98, s56, 10
    s_add_u32 s98, s98, 100352
    v_lshrrev_b32 v254, 5, v1
    v_lshlrev_b32 v254, 9, v254
    v_mfma_f32_16x16x32_bf16 v[56:59], v[140:143], v[120:123], v[56:59]
    v_and_b32 v2, 31, v1
    v_lshl_add_u32 v254, v2, 2, v254
    v_mfma_f32_16x16x32_bf16 v[72:75], v[140:143], v[124:127], v[72:75]
    s_mov_b32 s97, s3
    s_lshl_b32 s99, s77, 2
    s_add_u32 s99, s99, s97
    s_lshl_b32 s99, s99, 9
    s_add_u32 s99, s99, 32768
    v_add_u32 v254, s98, v254
    v_lshrrev_b32 v2, 4, v1
    v_mfma_f32_16x16x32_bf16 v[88:91], v[140:143], v[128:131], v[88:91]
    v_lshlrev_b32 v2, 9, v2
    v_and_b32 v26, 15, v1
    v_mfma_f32_16x16x32_bf16 v[104:107], v[140:143], v[132:135], v[104:107]
    s_setprio 2
    v_lshl_add_u32 v2, v26, 3, v2
    v_add_u32 v2, s99, v2
    v_mfma_f32_16x16x32_bf16 v[44:47], v[144:147], v[116:119], v[44:47]
    s_cmp_ge_u32 s36, 4
    s_cselect_b64 vcc, -1, 0
    v_cndmask_b32 v28, v2, v254, vcc
    v_subrev_u32 v254, 176, v0
    v_mfma_f32_16x16x32_bf16 v[60:63], v[144:147], v[120:123], v[60:63]
    v_cmp_lt_u32 vcc, 79, v254
    v_lshlrev_b32 v3, 4, v1
    s_mov_b64 s[100:101], vcc
    s_mov_b32 s96, s74
    s_add_u32 s96, s96, s97
    s_mul_i32 s96, s96, 73
    s_add_u32 s56, s56, s96
    s_add_u32 s56, s56, 16
    s_lshl_b32 s56, s56, 10
    v_mfma_f32_16x16x32_bf16 v[76:79], v[144:147], v[124:127], v[76:79]
    s_mov_b32 s68, 0x22222222
    s_mov_b32 s69, 0x22222222
    s_mov_b32 s70, 0x44444444
    s_mov_b32 s71, 0x44444444
    s_mov_b32 s72, 0x88888888
    s_mov_b32 s73, 0x88888888
    v_mov_b32 v254, 0x80000000
    v_cmp_gt_u32 vcc, 2, v1
    v_mfma_f32_16x16x32_bf16 v[92:95], v[144:147], v[128:131], v[92:95]
    s_add_u32 s20, s94, 1048576
    s_addc_u32 s21, s95, 0
    s_mov_b32 s22, 9568256
    s_mov_b32 s23, 0x20000
    v_lshlrev_b32 v2, 7, v1
    v_cndmask_b32 v27, v254, v2, vcc
    v_mfma_f32_16x16x32_bf16 v[108:111], v[144:147], v[132:135], v[108:111]
    s_mov_b32 s57, 0xbfb8aa3b
    s_and_b32 s96, s2, 7
    s_lshr_b32 s97, s2, 3
    s_and_b32 s98, s97, 3
    s_lshl_b32 s79, s96, 2
    s_add_u32 s79, s79, s98
    s_lshr_b32 s80, s97, 2
    v_lshlrev_b32 v29, 3, v0
    v_add_u32 v29, 155648, v29
    v_mfma_f32_16x16x32_bf16 v[48:51], v[148:151], v[116:119], v[48:51]
    s_lshl_b32 s75, s80, 1
    s_lshl_b32 s98, s98, 2
    s_add_u32 s75, s75, s98
    v_bfe_u32 v254, v1, 1, 2
    v_lshrrev_b32 v2, 4, v1
    v_mfma_f32_16x16x32_bf16 v[64:67], v[148:151], v[120:123], v[64:67]
    v_xor_b32 v254, v254, v2
    v_lshlrev_b32 v254, 5, v254
    v_mfma_f32_16x16x32_bf16 v[80:83], v[148:151], v[124:127], v[80:83]
    s_add_u32 m0, s37, 24576
    s_add_u32 s38, s51, 0
    buffer_load_dwordx4 v7, s[12:15], s38 offen lds
    v_mfma_f32_16x16x32_bf16 v[96:99], v[148:151], v[128:131], v[96:99]
    s_add_u32 m0, s37, 32768
    s_add_u32 s38, s51, 0
    buffer_load_dwordx4 v7, s[16:19], s38 offen lds
    v_mfma_f32_16x16x32_bf16 v[112:115], v[148:151], v[132:135], v[112:115]
    s_waitcnt vmcnt(9)
    s_barrier
    ds_read_b64_tr_b16 v[216:217], v12 offset:0
    ds_read_b64_tr_b16 v[218:219], v12 offset:1024
    ds_read_b128 v[232:235], v252 offset:0
    ds_read_b128 v[236:239], v252 offset:2048
    ds_read_b128 v[240:243], v252 offset:4096
    ds_read_b128 v[244:247], v252 offset:6144
    ds_read_b128 v[248:251], v252 offset:8192
    ds_read_b64_tr_b16 v[220:221], v12 offset:8192
    ds_read_b64_tr_b16 v[222:223], v12 offset:9216
    ds_read_b64_tr_b16 v[224:225], v13 offset:0
    ds_read_b64_tr_b16 v[226:227], v13 offset:1024
    ds_read_b64_tr_b16 v[228:229], v13 offset:8192
    ds_read_b64_tr_b16 v[230:231], v13 offset:9216
    s_waitcnt lgkmcnt(0)
    s_setprio 1
    v_mfma_f32_16x16x32_bf16 v[36:39], v[216:219], v[232:235], v[36:39]
    ds_read_b64_tr_b16 v[136:137], v12 offset:16384
    v_mfma_f32_16x16x32_bf16 v[52:55], v[216:219], v[236:239], v[52:55]
    ds_read_b64_tr_b16 v[138:139], v12 offset:17408
    s_add_u32 m0, s37, 40960
    s_nop 0
    buffer_load_dwordx4 v4, s[8:11], s43 offen lds
    v_mfma_f32_16x16x32_bf16 v[68:71], v[216:219], v[240:243], v[68:71]
    ds_read_b128 v[116:119], v253 offset:0
    s_add_u32 m0, s37, 49152
    s_nop 0
    buffer_load_dwordx4 v5, s[8:11], s43 offen lds
    v_mfma_f32_16x16x32_bf16 v[84:87], v[216:219], v[244:247], v[84:87]
    ds_read_b128 v[120:123], v253 offset:2048
    v_mfma_f32_16x16x32_bf16 v[100:103], v[216:219], v[248:251], v[100:103]
    ds_read_b128 v[124:127], v253 offset:4096
    s_add_u32 m0, s37, 57344
    s_nop 0
    buffer_load_dwordx4 v6, s[8:11], s43 offen lds
    v_mfma_f32_16x16x32_bf16 v[40:43], v[220:223], v[232:235], v[40:43]
    ds_read_b128 v[128:131], v253 offset:6144
    s_sub_u32 s98, s77, 1
    s_lshl_b32 s98, s98, 19
    s_add_u32 s98, s88, s98
    s_addc_u32 s99, s89, 0
    s_cmp_eq_u32 s77, 0
    s_cselect_b32 s32, s82, s98
    s_cselect_b32 s33, s83, s99
    s_mov_b32 s34, 0x80000
    s_mov_b32 s35, 0x20000
    v_and_b32 v2, 1, v1
    v_lshl_add_u32 v254, v2, 4, v254
    v_mfma_f32_16x16x32_bf16 v[56:59], v[220:223], v[236:239], v[56:59]
    ds_read_b128 v[132:135], v253 offset:8192
    v_mfma_f32_16x16x32_bf16 v[72:75], v[220:223], v[240:243], v[72:75]
    ds_read_b64_tr_b16 v[140:141], v12 offset:24576
    s_lshl_b32 s76, s77, 12
    s_lshl_b32 s98, s78, 11
    s_add_u32 s76, s76, s98
    v_lshrrev_b32 v2, 3, v1
    v_and_b32 v26, 4, v2
    v_mfma_f32_16x16x32_bf16 v[88:91], v[220:223], v[244:247], v[88:91]
    ds_read_b64_tr_b16 v[142:143], v12 offset:25600
    s_cmp_eq_u32 s77, 0
    s_cselect_b64 vcc, -1, 0
    s_cselect_b32 s81, 2, 1
    s_cselect_b32 s99, 12, 14
    s_lshl_b32 s81, s81, 13
    v_add_u32 v26, v26, v2
    v_cndmask_b32 v2, v2, v26, vcc
    v_mfma_f32_16x16x32_bf16 v[104:107], v[220:223], v[248:251], v[104:107]
    s_setprio 0
    ds_read_b64_tr_b16 v[144:145], v13 offset:16384
    v_mfma_f32_16x16x32_bf16 v[44:47], v[224:227], v[232:235], v[44:47]
    ds_read_b64_tr_b16 v[146:147], v13 offset:17408
    s_lshl_b32 s98, s80, 7
    s_lshl_b32 s99, s78, s99
    v_lshl_add_u32 v254, v2, 10, v254
    v_add_u32 v35, s98, v254
    v_mfma_f32_16x16x32_bf16 v[60:63], v[224:227], v[236:239], v[60:63]
    ds_read_b64_tr_b16 v[148:149], v13 offset:24576
    v_mfma_f32_16x16x32_bf16 v[76:79], v[224:227], v[240:243], v[76:79]
    ds_read_b64_tr_b16 v[150:151], v13 offset:25600
    v_add_u32 v30, s99, v35
    s_lshl_b32 s98, s2, 3
    s_add_u32 s98, s98, s36
    s_mul_i32 s99, s98, 896
    s_lshl_b32 s98, s98, 8
    v_min_u32 v254, 6, v1
    v_mfma_f32_16x16x32_bf16 v[92:95], v[224:227], v[244:247], v[92:95]
    v_lshl_add_u32 v31, v254, 7, s99
    v_min_u32 v2, 1, v1
    v_mfma_f32_16x16x32_bf16 v[108:111], v[224:227], v[248:251], v[108:111]
    v_mfma_f32_16x16x32_bf16 v[48:51], v[228:231], v[232:235], v[48:51]
    v_lshl_add_u32 v32, v2, 7, s98
    v_and_b32 v2, 15, v1
    v_mfma_f32_16x16x32_bf16 v[64:67], v[228:231], v[236:239], v[64:67]
    s_lshl_b32 s98, s74, 7
    s_add_u32 s98, s98, 155648
    v_lshl_add_u32 v14, v2, 3, s98
    v_mfma_f32_16x16x32_bf16 v[80:83], v[228:231], v[240:243], v[80:83]
    v_mfma_f32_16x16x32_bf16 v[96:99], v[228:231], v[244:247], v[96:99]
    s_lshl_b32 s98, s77, 9
    s_add_u32 s98, s98, 157696
    v_lshl_add_u32 v15, v2, 3, s98
    v_mfma_f32_16x16x32_bf16 v[112:115], v[228:231], v[248:251], v[112:115]
    s_waitcnt lgkmcnt(0)
    s_cmp_ge_u32 s5, 8
    s_cbranch_scc0 SK_12
    v_mfma_f32_16x16x32_bf16 v[184:187], v[224:227], v[16:19], v[184:187]
    v_mfma_f32_16x16x32_bf16 v[188:191], v[228:231], v[16:19], v[188:191]
    v_mfma_f32_16x16x32_bf16 v[184:187], v[144:147], v[16:19], v[184:187]
    v_mfma_f32_16x16x32_bf16 v[188:191], v[148:151], v[16:19], v[188:191]
SK_12:
    s_waitcnt vmcnt(5)
    s_barrier
    s_setprio 3
    v_mfma_f32_16x16x32_bf16 v[36:39], v[136:139], v[116:119], v[36:39]
    s_add_u32 m0, s37, 65536
    s_add_u32 s38, s51, 114688
    buffer_load_dwordx4 v7, s[12:15], s38 offen lds
    ds_read_b64_tr_b16 v[216:217], v12 offset:49152
    v_mfma_f32_16x16x32_bf16 v[52:55], v[136:139], v[120:123], v[52:55]
    s_add_u32 m0, s37, 73728
    s_add_u32 s38, s51, 114688
    buffer_load_dwordx4 v7, s[16:19], s38 offen lds
    ds_read_b64_tr_b16 v[218:219], v12 offset:50176
    v_mfma_f32_16x16x32_bf16 v[68:71], v[136:139], v[124:127], v[68:71]
    ds_read_b128 v[232:235], v8 offset:0
    v_mfma_f32_16x16x32_bf16 v[84:87], v[136:139], v[128:131], v[84:87]
    ds_read_b128 v[236:239], v8 offset:2048
    v_mfma_f32_16x16x32_bf16 v[100:103], v[136:139], v[132:135], v[100:103]
    ds_read_b128 v[240:243], v8 offset:4096
    v_mfma_f32_16x16x32_bf16 v[40:43], v[140:143], v[116:119], v[40:43]
    ds_read_b128 v[244:247], v8 offset:6144
    v_mfma_f32_16x16x32_bf16 v[56:59], v[140:143], v[120:123], v[56:59]
    ds_read_b128 v[248:251], v8 offset:8192
    s_cmp_ge_u32 s5, 8
    s_cbranch_scc0 SK_13
    v_or_b32 v184, 1, v184
    v_or_b32 v185, 1, v185
    v_or_b32 v186, 1, v186
    v_or_b32 v187, 1, v187
    buffer_store_dwordx4 v[184:187], v23, s[24:27], s64 offen offset:0 sc1
    v_or_b32 v188, 1, v188
    v_or_b32 v189, 1, v189
    v_or_b32 v190, 1, v190
    v_or_b32 v191, 1, v191
    buffer_store_dwordx4 v[188:191], v23, s[24:27], s64 offen offset:64 sc1
SK_13:
    v_mfma_f32_16x16x32_bf16 v[72:75], v[140:143], v[124:127], v[72:75]
    ds_read_b64_tr_b16 v[220:221], v12 offset:57344
    v_mfma_f32_16x16x32_bf16 v[88:91], v[140:143], v[128:131], v[88:91]
    ds_read_b64_tr_b16 v[222:223], v12 offset:58368
    v_mfma_f32_16x16x32_bf16 v[104:107], v[140:143], v[132:135], v[104:107]
    s_setprio 2
    ds_read_b64_tr_b16 v[224:225], v13 offset:49152
    v_mfma_f32_16x16x32_bf16 v[44:47], v[144:147], v[116:119], v[44:47]
    ds_read_b64_tr_b16 v[226:227], v13 offset:50176
    s_add_u32 m0, s37, 81920
    s_add_u32 s38, s52, 0
    buffer_load_dwordx4 v7, s[12:15], s38 offen lds
    v_mfma_f32_16x16x32_bf16 v[60:63], v[144:147], v[120:123], v[60:63]
    ds_read_b64_tr_b16 v[228:229], v13 offset:57344
    v_mfma_f32_16x16x32_bf16 v[76:79], v[144:147], v[124:127], v[76:79]
    ds_read_b64_tr_b16 v[230:231], v13 offset:58368
    v_mfma_f32_16x16x32_bf16 v[92:95], v[144:147], v[128:131], v[92:95]
    v_mfma_f32_16x16x32_bf16 v[108:111], v[144:147], v[132:135], v[108:111]
    v_mfma_f32_16x16x32_bf16 v[48:51], v[148:151], v[116:119], v[48:51]
    s_add_u32 m0, s37, 90112
    s_add_u32 s38, s52, 0
    buffer_load_dwordx4 v7, s[16:19], s38 offen lds
    v_mfma_f32_16x16x32_bf16 v[64:67], v[148:151], v[120:123], v[64:67]
    v_mfma_f32_16x16x32_bf16 v[80:83], v[148:151], v[124:127], v[80:83]
    v_mfma_f32_16x16x32_bf16 v[96:99], v[148:151], v[128:131], v[96:99]
    v_mfma_f32_16x16x32_bf16 v[112:115], v[148:151], v[132:135], v[112:115]
    s_waitcnt lgkmcnt(0)
    s_setprio 1
    v_mfma_f32_16x16x32_bf16 v[36:39], v[216:219], v[232:235], v[36:39]
    ds_read_b64_tr_b16 v[136:137], v12 offset:32768
    v_mfma_f32_16x16x32_bf16 v[52:55], v[216:219], v[236:239], v[52:55]
    ds_read_b64_tr_b16 v[138:139], v12 offset:33792
    s_add_u32 m0, s37, 131072
    s_nop 0
    buffer_load_dwordx4 v4, s[8:11], s44 offen lds
    v_mfma_f32_16x16x32_bf16 v[68:71], v[216:219], v[240:243], v[68:71]
    ds_read_b128 v[116:119], v9 offset:0
    v_mfma_f32_16x16x32_bf16 v[84:87], v[216:219], v[244:247], v[84:87]
    ds_read_b128 v[120:123], v9 offset:2048
    v_mfma_f32_16x16x32_bf16 v[100:103], v[216:219], v[248:251], v[100:103]
    ds_read_b128 v[124:127], v9 offset:4096
    v_mfma_f32_16x16x32_bf16 v[40:43], v[220:223], v[232:235], v[40:43]
    ds_read_b128 v[128:131], v9 offset:6144
    s_add_u32 m0, s37, 139264
    s_nop 0
    buffer_load_dwordx4 v5, s[8:11], s44 offen lds
    v_mfma_f32_16x16x32_bf16 v[56:59], v[220:223], v[236:239], v[56:59]
    ds_read_b128 v[132:135], v9 offset:8192
    v_mfma_f32_16x16x32_bf16 v[72:75], v[220:223], v[240:243], v[72:75]
    ds_read_b64_tr_b16 v[140:141], v12 offset:40960
    v_mfma_f32_16x16x32_bf16 v[88:91], v[220:223], v[244:247], v[88:91]
    ds_read_b64_tr_b16 v[142:143], v12 offset:41984
    v_mfma_f32_16x16x32_bf16 v[104:107], v[220:223], v[248:251], v[104:107]
    s_setprio 0
    ds_read_b64_tr_b16 v[144:145], v13 offset:32768
    v_mfma_f32_16x16x32_bf16 v[44:47], v[224:227], v[232:235], v[44:47]
    ds_read_b64_tr_b16 v[146:147], v13 offset:33792
    s_add_u32 m0, s37, 147456
    s_nop 0
    buffer_load_dwordx4 v6, s[8:11], s44 offen lds
    v_mfma_f32_16x16x32_bf16 v[60:63], v[224:227], v[236:239], v[60:63]
    ds_read_b64_tr_b16 v[148:149], v13 offset:40960
    v_mfma_f32_16x16x32_bf16 v[76:79], v[224:227], v[240:243], v[76:79]
    ds_read_b64_tr_b16 v[150:151], v13 offset:41984
    v_mfma_f32_16x16x32_bf16 v[92:95], v[224:227], v[244:247], v[92:95]
    v_mfma_f32_16x16x32_bf16 v[108:111], v[224:227], v[248:251], v[108:111]
    v_mfma_f32_16x16x32_bf16 v[48:51], v[228:231], v[232:235], v[48:51]
    v_mfma_f32_16x16x32_bf16 v[64:67], v[228:231], v[236:239], v[64:67]
    v_mfma_f32_16x16x32_bf16 v[80:83], v[228:231], v[240:243], v[80:83]
    v_mfma_f32_16x16x32_bf16 v[96:99], v[228:231], v[244:247], v[96:99]
    v_mfma_f32_16x16x32_bf16 v[112:115], v[228:231], v[248:251], v[112:115]
    s_waitcnt lgkmcnt(0)
    s_waitcnt vmcnt(5)
    s_barrier
    s_setprio 3
    v_mfma_f32_16x16x32_bf16 v[36:39], v[136:139], v[116:119], v[36:39]
    s_add_u32 m0, s37, 114688
    s_add_u32 s38, s52, 114688
    buffer_load_dwordx4 v7, s[12:15], s38 offen lds
    ds_read_b64_tr_b16 v[216:217], v10 offset:24576
    v_mfma_f32_16x16x32_bf16 v[52:55], v[136:139], v[120:123], v[52:55]
    s_add_u32 m0, s37, 122880
    s_add_u32 s38, s52, 114688
    buffer_load_dwordx4 v7, s[16:19], s38 offen lds
    ds_read_b64_tr_b16 v[218:219], v10 offset:25600
    v_mfma_f32_16x16x32_bf16 v[68:71], v[136:139], v[124:127], v[68:71]
    ds_read_b128 v[232:235], v8 offset:40960
    s_add_u32 m0, s37, 98304
    s_add_u32 s38, s53, 0
    buffer_load_dwordx4 v7, s[12:15], s38 offen lds
    v_mfma_f32_16x16x32_bf16 v[84:87], v[136:139], v[128:131], v[84:87]
    ds_read_b128 v[236:239], v8 offset:43008
    v_mfma_f32_16x16x32_bf16 v[100:103], v[136:139], v[132:135], v[100:103]
    ds_read_b128 v[240:243], v8 offset:45056
    v_mfma_f32_16x16x32_bf16 v[40:43], v[140:143], v[116:119], v[40:43]
    ds_read_b128 v[244:247], v8 offset:47104
    v_mfma_f32_16x16x32_bf16 v[56:59], v[140:143], v[120:123], v[56:59]
    ds_read_b128 v[248:251], v8 offset:49152
    v_mfma_f32_16x16x32_bf16 v[72:75], v[140:143], v[124:127], v[72:75]
    ds_read_b64_tr_b16 v[220:221], v10 offset:32768
    v_mfma_f32_16x16x32_bf16 v[88:91], v[140:143], v[128:131], v[88:91]
    ds_read_b64_tr_b16 v[222:223], v10 offset:33792
    v_mfma_f32_16x16x32_bf16 v[104:107], v[140:143], v[132:135], v[104:107]
    s_setprio 2
    ds_read_b64_tr_b16 v[224:225], v11 offset:24576
    v_mfma_f32_16x16x32_bf16 v[44:47], v[144:147], v[116:119], v[44:47]
    global_load_dword v33, v31, s[88:89]
    global_load_dword v34, v32, s[82:83]
    ds_read_b64_tr_b16 v[226:227], v11 offset:25600
    v_mfma_f32_16x16x32_bf16 v[60:63], v[144:147], v[120:123], v[60:63]
    ds_read_b64_tr_b16 v[228:229], v11 offset:32768
    s_add_u32 m0, s37, 106496
    s_add_u32 s38, s53, 0
    buffer_load_dwordx4 v7, s[16:19], s38 offen lds
    v_mfma_f32_16x16x32_bf16 v[76:79], v[144:147], v[124:127], v[76:79]
    ds_read_b64_tr_b16 v[230:231], v11 offset:33792
    v_mfma_f32_16x16x32_bf16 v[92:95], v[144:147], v[128:131], v[92:95]
    v_mfma_f32_16x16x32_bf16 v[108:111], v[144:147], v[132:135], v[108:111]
    v_mfma_f32_16x16x32_bf16 v[48:51], v[148:151], v[116:119], v[48:51]
    v_mfma_f32_16x16x32_bf16 v[64:67], v[148:151], v[120:123], v[64:67]
    v_mfma_f32_16x16x32_bf16 v[80:83], v[148:151], v[124:127], v[80:83]
    v_mfma_f32_16x16x32_bf16 v[96:99], v[148:151], v[128:131], v[96:99]
    v_mfma_f32_16x16x32_bf16 v[112:115], v[148:151], v[132:135], v[112:115]
    s_waitcnt lgkmcnt(0)
    s_setprio 1
    v_mfma_f32_16x16x32_bf16 v[36:39], v[216:219], v[232:235], v[36:39]
    ds_read_b64_tr_b16 v[136:137], v12 offset:0
    v_mfma_f32_16x16x32_bf16 v[52:55], v[216:219], v[236:239], v[52:55]
    ds_read_b64_tr_b16 v[138:139], v12 offset:1024
    s_add_u32 m0, s37, 0
    s_nop 0
    buffer_load_dwordx4 v4, s[8:11], s45 offen lds
    v_mfma_f32_16x16x32_bf16 v[68:71], v[216:219], v[240:243], v[68:71]
    ds_read_b128 v[116:119], v9 offset:40960
    v_mfma_f32_16x16x32_bf16 v[84:87], v[216:219], v[244:247], v[84:87]
    ds_read_b128 v[120:123], v9 offset:43008
    v_mfma_f32_16x16x32_bf16 v[100:103], v[216:219], v[248:251], v[100:103]
    ds_read_b128 v[124:127], v9 offset:45056
    v_mfma_f32_16x16x32_bf16 v[40:43], v[220:223], v[232:235], v[40:43]
    ds_read_b128 v[128:131], v9 offset:47104
    s_add_u32 m0, s37, 8192
    s_nop 0
    buffer_load_dwordx4 v5, s[8:11], s45 offen lds
    v_mfma_f32_16x16x32_bf16 v[56:59], v[220:223], v[236:239], v[56:59]
    ds_read_b128 v[132:135], v9 offset:49152
    v_mfma_f32_16x16x32_bf16 v[72:75], v[220:223], v[240:243], v[72:75]
    ds_read_b64_tr_b16 v[140:141], v12 offset:8192
    v_mfma_f32_16x16x32_bf16 v[88:91], v[220:223], v[244:247], v[88:91]
    ds_read_b64_tr_b16 v[142:143], v12 offset:9216
    v_mfma_f32_16x16x32_bf16 v[104:107], v[220:223], v[248:251], v[104:107]
    s_setprio 0
    ds_read_b64_tr_b16 v[144:145], v13 offset:0
    v_mfma_f32_16x16x32_bf16 v[44:47], v[224:227], v[232:235], v[44:47]
    ds_read_b64_tr_b16 v[146:147], v13 offset:1024
    s_add_u32 m0, s37, 16384
    s_nop 0
    buffer_load_dwordx4 v6, s[8:11], s45 offen lds
    v_mfma_f32_16x16x32_bf16 v[60:63], v[224:227], v[236:239], v[60:63]
    ds_read_b64_tr_b16 v[148:149], v13 offset:8192
    v_mfma_f32_16x16x32_bf16 v[76:79], v[224:227], v[240:243], v[76:79]
    ds_read_b64_tr_b16 v[150:151], v13 offset:9216
    v_mfma_f32_16x16x32_bf16 v[92:95], v[224:227], v[244:247], v[92:95]
    v_mfma_f32_16x16x32_bf16 v[108:111], v[224:227], v[248:251], v[108:111]
    v_mfma_f32_16x16x32_bf16 v[48:51], v[228:231], v[232:235], v[48:51]
    v_mfma_f32_16x16x32_bf16 v[64:67], v[228:231], v[236:239], v[64:67]
    v_mfma_f32_16x16x32_bf16 v[80:83], v[228:231], v[240:243], v[80:83]
    v_mfma_f32_16x16x32_bf16 v[96:99], v[228:231], v[244:247], v[96:99]
    v_mfma_f32_16x16x32_bf16 v[112:115], v[228:231], v[248:251], v[112:115]
    s_waitcnt lgkmcnt(0)
    s_waitcnt vmcnt(7)
    s_barrier
    s_setprio 3
    v_mfma_f32_16x16x32_bf16 v[36:39], v[136:139], v[116:119], v[36:39]
    s_add_u32 m0, s37, 24576
    s_add_u32 s38, s53, 114688
    buffer_load_dwordx4 v7, s[12:15], s38 offen lds
    ds_read_b64_tr_b16 v[216:217], v12 offset:16384
    v_mfma_f32_16x16x32_bf16 v[52:55], v[136:139], v[120:123], v[52:55]
    s_add_u32 m0, s37, 32768
    s_add_u32 s38, s53, 114688
    buffer_load_dwordx4 v7, s[16:19], s38 offen lds
    ds_read_b64_tr_b16 v[218:219], v12 offset:17408
    v_mfma_f32_16x16x32_bf16 v[68:71], v[136:139], v[124:127], v[68:71]
    ds_read_b128 v[232:235], v252 offset:0
    v_mfma_f32_16x16x32_bf16 v[84:87], v[136:139], v[128:131], v[84:87]
    ds_read_b128 v[236:239], v252 offset:2048
    v_mfma_f32_16x16x32_bf16 v[100:103], v[136:139], v[132:135], v[100:103]
    ds_read_b128 v[240:243], v252 offset:4096
    buffer_load_dword v152, v28, s[24:27], 0 offen offset:0 sc1
    v_mfma_f32_16x16x32_bf16 v[40:43], v[140:143], v[116:119], v[40:43]
    ds_read_b128 v[244:247], v252 offset:6144
    v_mfma_f32_16x16x32_bf16 v[56:59], v[140:143], v[120:123], v[56:59]
    ds_read_b128 v[248:251], v252 offset:8192
    v_mfma_f32_16x16x32_bf16 v[72:75], v[140:143], v[124:127], v[72:75]
    ds_read_b64_tr_b16 v[220:221], v12 offset:24576
    v_mfma_f32_16x16x32_bf16 v[88:91], v[140:143], v[128:131], v[88:91]
    ds_read_b64_tr_b16 v[222:223], v12 offset:25600
    buffer_load_dword v153, v28, s[24:27], 0 offen offset:128 sc1
    v_mfma_f32_16x16x32_bf16 v[104:107], v[140:143], v[132:135], v[104:107]
    s_setprio 2
    ds_read_b64_tr_b16 v[224:225], v13 offset:16384
    v_mfma_f32_16x16x32_bf16 v[44:47], v[144:147], v[116:119], v[44:47]
    ds_read_b64_tr_b16 v[226:227], v13 offset:17408
    v_mfma_f32_16x16x32_bf16 v[60:63], v[144:147], v[120:123], v[60:63]
    ds_read_b64_tr_b16 v[228:229], v13 offset:24576
    v_mfma_f32_16x16x32_bf16 v[76:79], v[144:147], v[124:127], v[76:79]
    ds_read_b64_tr_b16 v[230:231], v13 offset:25600
    s_add_u32 m0, s37, 65536
    s_add_u32 s38, s54, 0
    buffer_load_dwordx4 v7, s[12:15], s38 offen lds
    v_mfma_f32_16x16x32_bf16 v[92:95], v[144:147], v[128:131], v[92:95]
    v_mfma_f32_16x16x32_bf16 v[108:111], v[144:147], v[132:135], v[108:111]
    v_mfma_f32_16x16x32_bf16 v[48:51], v[148:151], v[116:119], v[48:51]
    v_mfma_f32_16x16x32_bf16 v[64:67], v[148:151], v[120:123], v[64:67]
    s_add_u32 m0, s37, 73728
    s_add_u32 s38, s54, 0
    buffer_load_dwordx4 v7, s[16:19], s38 offen lds
    v_mfma_f32_16x16x32_bf16 v[80:83], v[148:151], v[124:127], v[80:83]
    v_mfma_f32_16x16x32_bf16 v[96:99], v[148:151], v[128:131], v[96:99]
    v_mfma_f32_16x16x32_bf16 v[112:115], v[148:151], v[132:135], v[112:115]
    s_waitcnt lgkmcnt(0)
    s_setprio 1
    v_mfma_f32_16x16x32_bf16 v[36:39], v[216:219], v[232:235], v[36:39]
    buffer_load_dword v154, v28, s[24:27], 0 offen offset:256 sc1
    ds_read_b64_tr_b16 v[136:137], v12 offset:49152
    v_mfma_f32_16x16x32_bf16 v[52:55], v[216:219], v[236:239], v[52:55]
    ds_read_b64_tr_b16 v[138:139], v12 offset:50176
    s_add_u32 m0, s37, 40960
    s_nop 0
    buffer_load_dwordx4 v4, s[8:11], s46 offen lds
    v_mfma_f32_16x16x32_bf16 v[68:71], v[216:219], v[240:243], v[68:71]
    ds_read_b128 v[116:119], v253 offset:0
    v_mfma_f32_16x16x32_bf16 v[84:87], v[216:219], v[244:247], v[84:87]
    ds_read_b128 v[120:123], v253 offset:2048
    v_mfma_f32_16x16x32_bf16 v[100:103], v[216:219], v[248:251], v[100:103]
    ds_read_b128 v[124:127], v253 offset:4096
    v_mfma_f32_16x16x32_bf16 v[40:43], v[220:223], v[232:235], v[40:43]
    ds_read_b128 v[128:131], v253 offset:6144
    s_add_u32 m0, s37, 49152
    s_nop 0
    buffer_load_dwordx4 v5, s[8:11], s46 offen lds
    v_mfma_f32_16x16x32_bf16 v[56:59], v[220:223], v[236:239], v[56:59]
    ds_read_b128 v[132:135], v253 offset:8192
    v_mfma_f32_16x16x32_bf16 v[72:75], v[220:223], v[240:243], v[72:75]
    ds_read_b64_tr_b16 v[140:141], v12 offset:57344
    v_mfma_f32_16x16x32_bf16 v[88:91], v[220:223], v[244:247], v[88:91]
    ds_read_b64_tr_b16 v[142:143], v12 offset:58368
    v_mfma_f32_16x16x32_bf16 v[104:107], v[220:223], v[248:251], v[104:107]
    s_setprio 0
    ds_read_b64_tr_b16 v[144:145], v13 offset:49152
    v_mfma_f32_16x16x32_bf16 v[44:47], v[224:227], v[232:235], v[44:47]
    ds_read_b64_tr_b16 v[146:147], v13 offset:50176
    s_add_u32 m0, s37, 57344
    s_nop 0
    buffer_load_dwordx4 v6, s[8:11], s46 offen lds
    v_mfma_f32_16x16x32_bf16 v[60:63], v[224:227], v[236:239], v[60:63]
    ds_read_b64_tr_b16 v[148:149], v13 offset:57344
    v_mfma_f32_16x16x32_bf16 v[76:79], v[224:227], v[240:243], v[76:79]
    ds_read_b64_tr_b16 v[150:151], v13 offset:58368
    v_mfma_f32_16x16x32_bf16 v[92:95], v[224:227], v[244:247], v[92:95]
    v_mfma_f32_16x16x32_bf16 v[108:111], v[224:227], v[248:251], v[108:111]
    buffer_load_dword v155, v28, s[24:27], 0 offen offset:384 sc1
    v_mfma_f32_16x16x32_bf16 v[48:51], v[228:231], v[232:235], v[48:51]
    v_mfma_f32_16x16x32_bf16 v[64:67], v[228:231], v[236:239], v[64:67]
    v_mfma_f32_16x16x32_bf16 v[80:83], v[228:231], v[240:243], v[80:83]
    v_mfma_f32_16x16x32_bf16 v[96:99], v[228:231], v[244:247], v[96:99]
    v_mfma_f32_16x16x32_bf16 v[112:115], v[228:231], v[248:251], v[112:115]
    s_waitcnt lgkmcnt(0)
    s_waitcnt vmcnt(9)
    s_barrier
    s_setprio 3
    v_mfma_f32_16x16x32_bf16 v[36:39], v[136:139], v[116:119], v[36:39]
    s_add_u32 m0, s37, 81920
    s_add_u32 s38, s54, 114688
    buffer_load_dwordx4 v7, s[12:15], s38 offen lds
    ds_read_b64_tr_b16 v[216:217], v12 offset:32768
    v_mfma_f32_16x16x32_bf16 v[52:55], v[136:139], v[120:123], v[52:55]
    s_add_u32 m0, s37, 90112
    s_add_u32 s38, s54, 114688
    buffer_load_dwordx4 v7, s[16:19], s38 offen lds
    ds_read_b64_tr_b16 v[218:219], v12 offset:33792
    v_mfma_f32_16x16x32_bf16 v[68:71], v[136:139], v[124:127], v[68:71]
    ds_read_b128 v[232:235], v8 offset:0
    s_add_u32 m0, s37, 114688
    s_add_u32 s38, s55, 0
    buffer_load_dwordx4 v7, s[12:15], s38 offen lds
    v_mfma_f32_16x16x32_bf16 v[84:87], v[136:139], v[128:131], v[84:87]
    ds_read_b128 v[236:239], v8 offset:2048
    v_mfma_f32_16x16x32_bf16 v[100:103], v[136:139], v[132:135], v[100:103]
    ds_read_b128 v[240:243], v8 offset:4096
    v_mfma_f32_16x16x32_bf16 v[40:43], v[140:143], v[116:119], v[40:43]
    ds_read_b128 v[244:247], v8 offset:6144
    v_mfma_f32_16x16x32_bf16 v[56:59], v[140:143], v[120:123], v[56:59]
    ds_read_b128 v[248:251], v8 offset:8192
    v_mfma_f32_16x16x32_bf16 v[72:75], v[140:143], v[124:127], v[72:75]
    ds_read_b64_tr_b16 v[220:221], v12 offset:40960
    v_mfma_f32_16x16x32_bf16 v[88:91], v[140:143], v[128:131], v[88:91]
    ds_read_b64_tr_b16 v[222:223], v12 offset:41984
    v_mfma_f32_16x16x32_bf16 v[104:107], v[140:143], v[132:135], v[104:107]
    s_setprio 2
    ds_read_b64_tr_b16 v[224:225], v13 offset:32768
    v_mfma_f32_16x16x32_bf16 v[44:47], v[144:147], v[116:119], v[44:47]
    ds_read_b64_tr_b16 v[226:227], v13 offset:33792
    v_mfma_f32_16x16x32_bf16 v[60:63], v[144:147], v[120:123], v[60:63]
    ds_read_b64_tr_b16 v[228:229], v13 offset:40960
    s_add_u32 m0, s37, 122880
    s_add_u32 s38, s55, 0
    buffer_load_dwordx4 v7, s[16:19], s38 offen lds
    v_mfma_f32_16x16x32_bf16 v[76:79], v[144:147], v[124:127], v[76:79]
    ds_read_b64_tr_b16 v[230:231], v13 offset:41984
    v_mfma_f32_16x16x32_bf16 v[92:95], v[144:147], v[128:131], v[92:95]
    v_mfma_f32_16x16x32_bf16 v[108:111], v[144:147], v[132:135], v[108:111]
    v_mfma_f32_16x16x32_bf16 v[48:51], v[148:151], v[116:119], v[48:51]
    v_mfma_f32_16x16x32_bf16 v[64:67], v[148:151], v[120:123], v[64:67]
    v_mfma_f32_16x16x32_bf16 v[80:83], v[148:151], v[124:127], v[80:83]
    v_mfma_f32_16x16x32_bf16 v[96:99], v[148:151], v[128:131], v[96:99]
    v_mfma_f32_16x16x32_bf16 v[112:115], v[148:151], v[132:135], v[112:115]
    s_waitcnt lgkmcnt(0)
    s_setprio 1
    v_mfma_f32_16x16x32_bf16 v[36:39], v[216:219], v[232:235], v[36:39]
    ds_read_b64_tr_b16 v[136:137], v10 offset:24576
    v_mfma_f32_16x16x32_bf16 v[52:55], v[216:219], v[236:239], v[52:55]
    ds_read_b64_tr_b16 v[138:139], v10 offset:25600
    s_add_u32 m0, s37, 131072
    s_nop 0
    buffer_load_dwordx4 v4, s[8:11], s47 offen lds
    v_mfma_f32_16x16x32_bf16 v[68:71], v[216:219], v[240:243], v[68:71]
    ds_read_b128 v[116:119], v9 offset:0
    v_mfma_f32_16x16x32_bf16 v[84:87], v[216:219], v[244:247], v[84:87]
    ds_read_b128 v[120:123], v9 offset:2048
    v_mfma_f32_16x16x32_bf16 v[100:103], v[216:219], v[248:251], v[100:103]
    ds_read_b128 v[124:127], v9 offset:4096
    v_mfma_f32_16x16x32_bf16 v[40:43], v[220:223], v[232:235], v[40:43]
    ds_read_b128 v[128:131], v9 offset:6144
    s_add_u32 m0, s37, 139264
    s_nop 0
    buffer_load_dwordx4 v5, s[8:11], s47 offen lds
    v_mfma_f32_16x16x32_bf16 v[56:59], v[220:223], v[236:239], v[56:59]
    ds_read_b128 v[132:135], v9 offset:8192
    v_mfma_f32_16x16x32_bf16 v[72:75], v[220:223], v[240:243], v[72:75]
    ds_read_b64_tr_b16 v[140:141], v10 offset:32768
    v_mfma_f32_16x16x32_bf16 v[88:91], v[220:223], v[244:247], v[88:91]
    ds_read_b64_tr_b16 v[142:143], v10 offset:33792
    v_mfma_f32_16x16x32_bf16 v[104:107], v[220:223], v[248:251], v[104:107]
    s_setprio 0
    ds_read_b64_tr_b16 v[144:145], v11 offset:24576
    v_mfma_f32_16x16x32_bf16 v[44:47], v[224:227], v[232:235], v[44:47]
    ds_read_b64_tr_b16 v[146:147], v11 offset:25600
    s_add_u32 m0, s37, 147456
    s_nop 0
    buffer_load_dwordx4 v6, s[8:11], s47 offen lds
    v_mfma_f32_16x16x32_bf16 v[60:63], v[224:227], v[236:239], v[60:63]
    ds_read_b64_tr_b16 v[148:149], v11 offset:32768
    v_mfma_f32_16x16x32_bf16 v[76:79], v[224:227], v[240:243], v[76:79]
    ds_read_b64_tr_b16 v[150:151], v11 offset:33792
    v_mfma_f32_16x16x32_bf16 v[92:95], v[224:227], v[244:247], v[92:95]
    v_mfma_f32_16x16x32_bf16 v[108:111], v[224:227], v[248:251], v[108:111]
    v_mfma_f32_16x16x32_bf16 v[48:51], v[228:231], v[232:235], v[48:51]
    v_mfma_f32_16x16x32_bf16 v[64:67], v[228:231], v[236:239], v[64:67]
    v_mfma_f32_16x16x32_bf16 v[80:83], v[228:231], v[240:243], v[80:83]
    v_mfma_f32_16x16x32_bf16 v[96:99], v[228:231], v[244:247], v[96:99]
    v_mfma_f32_16x16x32_bf16 v[112:115], v[228:231], v[248:251], v[112:115]
    s_waitcnt lgkmcnt(0)
    s_waitcnt vmcnt(5)
    s_mov_b32 s98, 0
PC_chk_15:
    v_and_b32 v168, v152, v153
    v_and_b32 v169, v154, v155
    v_and_b32 v168, v168, v169
    v_and_b32 v168, 1, v168
    v_cmp_eq_u32 vcc, 0, v168
    s_nop 0
    s_and_b64 vcc, vcc, s[100:101]
    s_cbranch_scc0 PC_ok_14
    s_add_u32 s98, s98, 1
    s_cmp_ge_u32 s98, 100000
    s_cbranch_scc1 PC_ok_14
    s_sleep 2
    buffer_load_dword v152, v28, s[24:27], 0 offen offset:0 sc1
    buffer_load_dword v153, v28, s[24:27], 0 offen offset:128 sc1
    buffer_load_dword v154, v28, s[24:27], 0 offen offset:256 sc1
    buffer_load_dword v155, v28, s[24:27], 0 offen offset:384 sc1
    s_waitcnt vmcnt(0)
    s_branch PC_chk_15
PC_ok_14:
    s_barrier
    s_setprio 3
    v_mfma_f32_16x16x32_bf16 v[36:39], v[136:139], v[116:119], v[36:39]
    s_add_u32 m0, s37, 98304
    s_add_u32 s38, s55, 114688
    buffer_load_dwordx4 v7, s[12:15], s38 offen lds
    ds_read_b64_tr_b16 v[216:217], v12 offset:0
    v_mfma_f32_16x16x32_bf16 v[52:55], v[136:139], v[120:123], v[52:55]
    s_add_u32 m0, s37, 106496
    s_add_u32 s38, s55, 114688
    buffer_load_dwordx4 v7, s[16:19], s38 offen lds
    ds_read_b64_tr_b16 v[218:219], v12 offset:1024
    v_mfma_f32_16x16x32_bf16 v[68:71], v[136:139], v[124:127], v[68:71]
    ds_read_b128 v[232:235], v8 offset:40960
    v_add_f32 v152, v152, v153
    v_add_f32 v154, v154, v155
    v_mfma_f32_16x16x32_bf16 v[84:87], v[136:139], v[128:131], v[84:87]
    ds_read_b128 v[236:239], v8 offset:43008
    v_mfma_f32_16x16x32_bf16 v[100:103], v[136:139], v[132:135], v[100:103]
    ds_read_b128 v[240:243], v8 offset:45056
    v_add_f32 v152, v152, v154
    v_cvt_pk_bf16_f32 v154, v152, v152
    v_mfma_f32_16x16x32_bf16 v[40:43], v[140:143], v[116:119], v[40:43]
    ds_read_b128 v[244:247], v8 offset:47104
    v_mfma_f32_16x16x32_bf16 v[56:59], v[140:143], v[120:123], v[56:59]
    ds_read_b128 v[248:251], v8 offset:49152
    v_lshlrev_b32 v153, 16, v154
    v_sub_f32 v152, v152, v153
    v_mfma_f32_16x16x32_bf16 v[72:75], v[140:143], v[124:127], v[72:75]
    ds_read_b64_tr_b16 v[220:221], v12 offset:8192
    v_mfma_f32_16x16x32_bf16 v[88:91], v[140:143], v[128:131], v[88:91]
    ds_read_b64_tr_b16 v[222:223], v12 offset:9216
    v_cvt_pk_bf16_f32 v156, v152, v152
    v_lshlrev_b32 v153, 16, v156
    v_mfma_f32_16x16x32_bf16 v[104:107], v[140:143], v[132:135], v[104:107]
    s_setprio 2
    ds_read_b64_tr_b16 v[224:225], v13 offset:0
    v_mfma_f32_16x16x32_bf16 v[44:47], v[144:147], v[116:119], v[44:47]
    ds_read_b64_tr_b16 v[226:227], v13 offset:1024
    v_mfma_f32_16x16x32_bf16 v[60:63], v[144:147], v[120:123], v[60:63]
    ds_read_b64_tr_b16 v[228:229], v13 offset:8192
    v_sub_f32 v152, v152, v153
    v_cvt_pk_bf16_f32 v155, v152, v152
    v_mfma_f32_16x16x32_bf16 v[76:79], v[144:147], v[124:127], v[76:79]
    ds_read_b64_tr_b16 v[230:231], v13 offset:9216
    v_mfma_f32_16x16x32_bf16 v[92:95], v[144:147], v[128:131], v[92:95]
    v_and_b32 v154, 0xffff, v154
    v_or_b32 v154, v154, v153
    v_mfma_f32_16x16x32_bf16 v[108:111], v[144:147], v[132:135], v[108:111]
    v_mfma_f32_16x16x32_bf16 v[48:51], v[148:151], v[116:119], v[48:51]
    v_and_b32 v155, 0xffff, v155
    ds_write_b64 v29, v[154:155]
    v_mfma_f32_16x16x32_bf16 v[64:67], v[148:151], v[120:123], v[64:67]
    v_mfma_f32_16x16x32_bf16 v[80:83], v[148:151], v[124:127], v[80:83]
    s_add_u32 m0, s76, 0
    s_add_u32 s85, s75, 0
    s_and_b32 s85, s85, 15
    s_lshl_b32 s85, s85, 15
    buffer_load_dwordx4 v30, s[32:35], s85 offen lds
    v_mfma_f32_16x16x32_bf16 v[96:99], v[148:151], v[128:131], v[96:99]
    v_mfma_f32_16x16x32_bf16 v[112:115], v[148:151], v[132:135], v[112:115]
    s_waitcnt lgkmcnt(0)
    s_setprio 1
    v_mfma_f32_16x16x32_bf16 v[36:39], v[216:219], v[232:235], v[36:39]
    s_add_u32 m0, s76, 1024
    s_add_u32 s85, s85, s81
    buffer_load_dwordx4 v30, s[32:35], s85 offen lds
    ds_read_b64_tr_b16 v[136:137], v12 offset:16384
    v_mfma_f32_16x16x32_bf16 v[52:55], v[216:219], v[236:239], v[52:55]
    s_add_u32 m0, s76, 16384
    s_add_u32 s85, s75, 1
    s_and_b32 s85, s85, 15
    s_lshl_b32 s85, s85, 15
    buffer_load_dwordx4 v30, s[32:35], s85 offen lds
    ds_read_b64_tr_b16 v[138:139], v12 offset:17408
    v_mfma_f32_16x16x32_bf16 v[68:71], v[216:219], v[240:243], v[68:71]
    s_add_u32 m0, s76, 17408
    s_add_u32 s85, s85, s81
    buffer_load_dwordx4 v30, s[32:35], s85 offen lds
    ds_read_b128 v[116:119], v9 offset:40960
    v_mfma_f32_16x16x32_bf16 v[84:87], v[216:219], v[244:247], v[84:87]
    ds_read_b128 v[120:123], v9 offset:43008
    v_lshrrev_b32 v26, 4, v1
    v_bfe_u32 v27, v1, 2, 2
    s_lshl_b32 s6, s77, 14
    s_lshl_b32 s7, s75, 10
    v_mfma_f32_16x16x32_bf16 v[100:103], v[216:219], v[248:251], v[100:103]
    ds_read_b128 v[124:127], v9 offset:45056
    v_and_b32 v28, 1, v26
    v_lshlrev_b32 v28, 1, v28
    s_add_u32 s40, s7, 0
    s_and_b32 s40, s40, 0x3c00
    s_or_b32 s40, s40, s6
    s_add_u32 s41, s7, 1024
    s_and_b32 s41, s41, 0x3c00
    s_or_b32 s41, s41, s6
    v_mfma_f32_16x16x32_bf16 v[40:43], v[220:223], v[232:235], v[40:43]
    ds_read_b128 v[128:131], v9 offset:47104
    v_lshrrev_b32 v29, 1, v27
    v_or_b32 v28, v28, v29
    s_add_u32 s42, s7, 2048
    s_and_b32 s42, s42, 0x3c00
    s_or_b32 s42, s42, s6
    s_add_u32 s43, s7, 3072
    s_and_b32 s43, s43, 0x3c00
    s_or_b32 s43, s43, s6
    v_mfma_f32_16x16x32_bf16 v[56:59], v[220:223], v[236:239], v[56:59]
    ds_read_b128 v[132:135], v9 offset:49152
    v_lshlrev_b32 v28, 5, v28
    v_and_b32 v29, 3, v1
    s_add_u32 s44, s7, 4096
    s_and_b32 s44, s44, 0x3c00
    s_or_b32 s44, s44, s6
    s_add_u32 s45, s7, 5120
    s_and_b32 s45, s45, 0x3c00
    s_or_b32 s45, s45, s6
    v_mfma_f32_16x16x32_bf16 v[72:75], v[220:223], v[240:243], v[72:75]
    ds_read_b64_tr_b16 v[140:141], v12 offset:24576
    v_lshl_add_u32 v28, v29, 3, v28
    v_lshl_add_u32 v29, v26, 2, v27
    s_add_u32 s46, s7, 6144
    s_and_b32 s46, s46, 0x3c00
    s_or_b32 s46, s46, s6
    s_add_u32 s47, s7, 7168
    s_and_b32 s47, s47, 0x3c00
    s_or_b32 s47, s47, s6
    v_mfma_f32_16x16x32_bf16 v[88:91], v[220:223], v[244:247], v[88:91]
    ds_read_b64_tr_b16 v[142:143], v12 offset:25600
    v_lshl_add_u32 v28, v29, 7, v28
    s_lshl_b32 s86, s77, 12
    v_add_u32 v20, s86, v28
    v_mfma_f32_16x16x32_bf16 v[104:107], v[220:223], v[248:251], v[104:107]
    s_setprio 0
    ds_read_b64_tr_b16 v[144:145], v13 offset:16384
    v_xor_b32 v21, 32, v20
    v_xor_b32 v22, 64, v20
    s_add_u32 s48, s7, 8192
    s_and_b32 s48, s48, 0x3c00
    s_or_b32 s48, s48, s6
    s_add_u32 s49, s7, 9216
    s_and_b32 s49, s49, 0x3c00
    s_or_b32 s49, s49, s6
    v_mfma_f32_16x16x32_bf16 v[44:47], v[224:227], v[232:235], v[44:47]
    ds_read_b64_tr_b16 v[146:147], v13 offset:17408
    v_xor_b32 v23, 0x60, v20
    v_and_b32 v28, 0x3ff, v35
    s_add_u32 s50, s7, 10240
    s_and_b32 s50, s50, 0x3c00
    s_or_b32 s50, s50, s6
    s_add_u32 s51, s7, 11264
    s_and_b32 s51, s51, 0x3c00
    s_or_b32 s51, s51, s6
    v_mfma_f32_16x16x32_bf16 v[60:63], v[224:227], v[236:239], v[60:63]
    ds_read_b64_tr_b16 v[148:149], v13 offset:24576
    s_lshl_b32 s86, s77, 16
    s_lshl_b32 s87, s78, 14
    s_add_u32 s86, s86, s87
    s_add_u32 s86, s86, 1572864
    v_lshrrev_b32 v29, 3, v1
    v_lshl_add_u32 v28, v29, 10, v28
    v_mfma_f32_16x16x32_bf16 v[76:79], v[224:227], v[240:243], v[76:79]
    ds_read_b64_tr_b16 v[150:151], v13 offset:25600
    v_add_u32 v31, s86, v28
    s_lshl_b32 s86, s79, 2
    s_lshl_b32 s87, s78, 1
    s_add_u32 s86, s86, s87
    s_mul_i32 s87, s86, 74752
    v_mfma_f32_16x16x32_bf16 v[92:95], v[224:227], v[244:247], v[92:95]
    v_lshl_add_u32 v4, v1, 4, s87
    v_add_u32 v5, 74752, v4
    s_add_u32 s52, s7, 12288
    s_and_b32 s52, s52, 0x3c00
    s_or_b32 s52, s52, s6
    s_add_u32 s53, s7, 13312
    s_and_b32 s53, s53, 0x3c00
    s_or_b32 s53, s53, s6
    v_mfma_f32_16x16x32_bf16 v[108:111], v[224:227], v[248:251], v[108:111]
    v_lshrrev_b32 v26, 1, v1
    v_add_u32 v26, s75, v26
    v_and_b32 v26, 15, v26
    s_add_u32 s54, s7, 14336
    s_and_b32 s54, s54, 0x3c00
    s_or_b32 s54, s54, s6
    s_add_u32 s55, s7, 15360
    s_and_b32 s55, s55, 0x3c00
    s_or_b32 s55, s55, s6
    v_mfma_f32_16x16x32_bf16 v[48:51], v[228:231], v[232:235], v[48:51]
    v_and_b32 v27, 1, v1
    v_add_u32 v27, s86, v27
    s_lshl_b32 s6, s77, 11
    s_add_u32 s59, s6, 65536
    s_add_u32 s60, s6, 66560
    v_mfma_f32_16x16x32_bf16 v[64:67], v[228:231], v[236:239], v[64:67]
    v_add_u32 v28, 2, v27
    v_mul_u32_u24 v28, 6554, v28
    v_lshrrev_b32 v28, 16, v28
    s_mov_b32 s16, s90
    s_mov_b32 s17, s91
    s_mov_b32 s18, 2097152
    s_mov_b32 s19, 0x20000
    v_mfma_f32_16x16x32_bf16 v[80:83], v[228:231], v[240:243], v[80:83]
    v_mul_u32_u24 v27, 5958, v27
    v_lshrrev_b32 v27, 16, v27
    s_mov_b32 s12, s88
    s_mov_b32 s13, s89
    s_mov_b32 s14, 1835008
    s_mov_b32 s15, 0x20000
    v_mfma_f32_16x16x32_bf16 v[96:99], v[228:231], v[244:247], v[96:99]
    v_add_u32 v28, -1, v28
    v_max_i32 v27, v27, v28
    v_mfma_f32_16x16x32_bf16 v[112:115], v[228:231], v[248:251], v[112:115]
    s_waitcnt lgkmcnt(0)
    s_waitcnt vmcnt(4)
    s_barrier
    s_setprio 1
    s_add_u32 m0, s76, 32768
    s_add_u32 s85, s75, 2
    s_and_b32 s85, s85, 15
    s_lshl_b32 s85, s85, 15
    buffer_load_dwordx4 v30, s[32:35], s85 offen lds
    s_add_u32 m0, s76, 30720
    s_nop 0
    buffer_load_dwordx4 v35, s[32:35], s85 offen lds
    s_add_u32 m0, s76, 33792
    s_add_u32 s85, s85, s81
    buffer_load_dwordx4 v30, s[32:35], s85 offen lds
    s_add_u32 m0, s76, 31744
    s_nop 0
    buffer_load_dwordx4 v35, s[32:35], s85 offen lds
    s_add_u32 m0, s76, 49152
    s_add_u32 s85, s75, 3
    s_and_b32 s85, s85, 15
    s_lshl_b32 s85, s85, 15
    buffer_load_dwordx4 v30, s[32:35], s85 offen lds
    s_add_u32 m0, s76, 47104
    s_nop 0
    buffer_load_dwordx4 v35, s[32:35], s85 offen lds
    s_add_u32 m0, s76, 50176
    s_add_u32 s85, s85, s81
    buffer_load_dwordx4 v30, s[32:35], s85 offen lds
    s_add_u32 m0, s76, 48128
    s_nop 0
    buffer_load_dwordx4 v35, s[32:35], s85 offen lds
    s_add_u32 m0, s76, 65536
    s_add_u32 s85, s75, 4
    s_and_b32 s85, s85, 15
    s_lshl_b32 s85, s85, 15
    buffer_load_dwordx4 v30, s[32:35], s85 offen lds
    s_add_u32 m0, s76, 63488
    s_nop 0
    buffer_load_dwordx4 v35, s[32:35], s85 offen lds
    s_add_u32 m0, s76, 66560
    s_add_u32 s85, s85, s81
    buffer_load_dwordx4 v30, s[32:35], s85 offen lds
    s_add_u32 m0, s76, 64512
    s_nop 0
    buffer_load_dwordx4 v35, s[32:35], s85 offen lds
    s_add_u32 m0, s76, 81920
    s_add_u32 s85, s75, 5
    s_and_b32 s85, s85, 15
    s_lshl_b32 s85, s85, 15
    buffer_load_dwordx4 v30, s[32:35], s85 offen lds
    s_add_u32 m0, s76, 79872
    s_nop 0
    buffer_load_dwordx4 v35, s[32:35], s85 offen lds
    s_add_u32 m0, s76, 82944
    s_add_u32 s85, s85, s81
    buffer_load_dwordx4 v30, s[32:35], s85 offen lds
    s_add_u32 m0, s76, 80896
    s_nop 0
    buffer_load_dwordx4 v35, s[32:35], s85 offen lds
    v_mfma_f32_16x16x32_bf16 v[36:39], v[136:139], v[116:119], v[36:39]
    ds_read_b64_tr_b16 v[216:217], v12 offset:49152
    v_mul_u32_u24 v27, 14, v27
    v_lshrrev_b32 v28, 2, v26
    s_lshl_b32 s99, s77, 2
    s_sub_u32 s99, s99, 4
    v_mfma_f32_16x16x32_bf16 v[52:55], v[136:139], v[120:123], v[52:55]
    ds_read_b64_tr_b16 v[218:219], v12 offset:50176
    v_add3_u32 v28, v28, s99, v27
    s_mul_i32 s86, s79, 21846
    s_lshr_b32 s86, s86, 16
    s_lshl_b32 s86, s86, 3
    s_add_u32 s86, s86, 168
    v_lshrrev_b32 v26, 1, v26
    v_mfma_f32_16x16x32_bf16 v[68:71], v[136:139], v[124:127], v[68:71]
    ds_read_b128 v[232:235], v252 offset:0
    v_add_u32 v26, s86, v26
    s_cmp_eq_u32 s77, 0
    s_cselect_b64 s[100:101], -1, 0
    v_cndmask_b32 v28, v28, v26, s[100:101]
    v_mfma_f32_16x16x32_bf16 v[84:87], v[136:139], v[128:131], v[84:87]
    ds_read_b128 v[236:239], v252 offset:2048
    s_lshr_b32 s99, s77, 1
    s_add_u32 s99, s99, 12
    v_add_u32 v27, s99, v27
    s_mov_b32 s100, 0
    s_mov_b32 s101, -1
    v_cndmask_b32 v28, v28, v27, s[100:101]
    v_mfma_f32_16x16x32_bf16 v[100:103], v[136:139], v[132:135], v[100:103]
    ds_read_b128 v[240:243], v252 offset:4096
    v_mfma_f32_16x16x32_bf16 v[40:43], v[140:143], v[116:119], v[40:43]
    ds_read_b128 v[244:247], v252 offset:6144
    v_lshlrev_b32 v6, 7, v28
    v_lshrrev_b32 v26, 3, v0
    v_mfma_f32_16x16x32_bf16 v[56:59], v[140:143], v[120:123], v[56:59]
    ds_read_b128 v[248:251], v252 offset:8192
    v_and_b32 v29, 7, v0
    v_lshlrev_b32 v26, 10, v26
    v_mfma_f32_16x16x32_bf16 v[72:75], v[140:143], v[124:127], v[72:75]
    ds_read_b64_tr_b16 v[220:221], v12 offset:57344
    s_lshl_b32 s86, s79, 16
    s_lshl_b32 s87, s80, 7
    s_add_u32 s86, s86, s87
    v_lshl_add_u32 v26, v29, 4, v26
    v_add_u32 v7, s86, v26
    v_mfma_f32_16x16x32_bf16 v[88:91], v[140:143], v[128:131], v[88:91]
    ds_read_b64_tr_b16 v[222:223], v12 offset:58368
    ds_read_b64 v[168:169], v14 offset:0
    v_mfma_f32_16x16x32_bf16 v[104:107], v[140:143], v[132:135], v[104:107]
    ds_read_b64_tr_b16 v[224:225], v13 offset:49152
    v_mfma_f32_16x16x32_bf16 v[44:47], v[144:147], v[116:119], v[44:47]
    ds_read_b64_tr_b16 v[226:227], v13 offset:50176
    ds_read_b64 v[170:171], v14 offset:128
    v_mfma_f32_16x16x32_bf16 v[60:63], v[144:147], v[120:123], v[60:63]
    ds_read_b64_tr_b16 v[228:229], v13 offset:57344
    ds_read_b64 v[172:173], v14 offset:256
    v_mfma_f32_16x16x32_bf16 v[76:79], v[144:147], v[124:127], v[76:79]
    ds_read_b64_tr_b16 v[230:231], v13 offset:58368
    ds_read_b64 v[174:175], v14 offset:384
    v_mfma_f32_16x16x32_bf16 v[92:95], v[144:147], v[128:131], v[92:95]
    ds_read_b64 v[176:177], v14 offset:512
    v_mfma_f32_16x16x32_bf16 v[108:111], v[144:147], v[132:135], v[108:111]
    v_mfma_f32_16x16x32_bf16 v[48:51], v[148:151], v[116:119], v[48:51]
    ds_read_b64 v[180:181], v15 offset:0
    v_mfma_f32_16x16x32_bf16 v[64:67], v[148:151], v[120:123], v[64:67]
    ds_read_b64 v[182:183], v15 offset:128
    v_mfma_f32_16x16x32_bf16 v[80:83], v[148:151], v[124:127], v[80:83]
    ds_read_b64 v[184:185], v15 offset:256
    v_mfma_f32_16x16x32_bf16 v[96:99], v[148:151], v[128:131], v[96:99]
    ds_read_b64 v[186:187], v15 offset:384
    v_mfma_f32_16x16x32_bf16 v[112:115], v[148:151], v[132:135], v[112:115]
    s_waitcnt lgkmcnt(0)
    v_mfma_f32_16x16x32_bf16 v[36:39], v[216:219], v[232:235], v[36:39]
    ds_read_b64_tr_b16 v[136:137], v12 offset:32768
    v_cmp_gt_u32 vcc, 16, v1
    v_mov_b32 v164, 0xffff
    s_nop 0
    v_cndmask_b32 v165, 0, v164, vcc
    v_mfma_f32_16x16x32_bf16 v[40:43], v[220:223], v[232:235], v[40:43]
    ds_read_b64_tr_b16 v[138:139], v12 offset:33792
    v_and_b32 v153, v168, v165
    v_lshl_or_b32 v152, v153, 16, v153
    v_mfma_f32_16x16x32_bf16 v[44:47], v[224:227], v[232:235], v[44:47]
    ds_read_b128 v[116:119], v253 offset:0
    v_and_b32 v168, 0xffff0000, v168
    v_mul_f32 v169, s57, v169
    v_mfma_f32_16x16x32_bf16 v[48:51], v[228:231], v[232:235], v[48:51]
    ds_read_b128 v[120:123], v253 offset:2048
    v_and_b32 v155, v170, v165
    v_lshl_or_b32 v154, v155, 16, v155
    v_mfma_f32_16x16x32_bf16 v[52:55], v[216:219], v[236:239], v[52:55]
    ds_read_b128 v[124:127], v253 offset:4096
    v_and_b32 v170, 0xffff0000, v170
    v_mul_f32 v171, s57, v171
    v_mfma_f32_16x16x32_bf16 v[56:59], v[220:223], v[236:239], v[56:59]
    ds_read_b128 v[128:131], v253 offset:6144
    v_and_b32 v157, v172, v165
    v_lshl_or_b32 v156, v157, 16, v157
    v_and_b32 v172, 0xffff0000, v172
    v_mul_f32 v173, s57, v173
    v_mfma_f32_16x16x32_bf16 v[60:63], v[224:227], v[236:239], v[60:63]
    ds_read_b128 v[132:135], v253 offset:8192
    v_and_b32 v159, v174, v165
    v_lshl_or_b32 v158, v159, 16, v159
    v_mfma_f32_16x16x32_bf16 v[64:67], v[228:231], v[236:239], v[64:67]
    ds_read_b64_tr_b16 v[140:141], v12 offset:40960
    v_and_b32 v174, 0xffff0000, v174
    v_mul_f32 v175, s57, v175
    v_mfma_f32_16x16x32_bf16 v[68:71], v[216:219], v[240:243], v[68:71]
    ds_read_b64_tr_b16 v[142:143], v12 offset:41984
    v_and_b32 v161, v176, v165
    v_lshl_or_b32 v160, v161, 16, v161
    v_mfma_f32_16x16x32_bf16 v[72:75], v[220:223], v[240:243], v[72:75]
    ds_read_b64_tr_b16 v[144:145], v13 offset:32768
    v_and_b32 v176, 0xffff0000, v176
    v_mul_f32 v177, s57, v177
    v_mfma_f32_16x16x32_bf16 v[76:79], v[224:227], v[240:243], v[76:79]
    ds_read_b64_tr_b16 v[146:147], v13 offset:33792
    v_mfma_f32_16x16x32_bf16 v[80:83], v[228:231], v[240:243], v[80:83]
    ds_read_b64_tr_b16 v[148:149], v13 offset:40960
    v_mfma_f32_16x16x16_bf16 v[36:39], v[180:181], v[152:153], v[36:39]
    ds_read_b64_tr_b16 v[150:151], v13 offset:41984
    v_mfma_f32_16x16x16_bf16 v[44:47], v[184:185], v[152:153], v[44:47]
    v_mfma_f32_16x16x16_bf16 v[40:43], v[182:183], v[152:153], v[40:43]
    v_mfma_f32_16x16x16_bf16 v[48:51], v[186:187], v[152:153], v[48:51]
    v_mfma_f32_16x16x16_bf16 v[52:55], v[180:181], v[154:155], v[52:55]
    v_mfma_f32_16x16x16_bf16 v[60:63], v[184:185], v[154:155], v[60:63]
    v_mfma_f32_16x16x16_bf16 v[56:59], v[182:183], v[154:155], v[56:59]
    v_mfma_f32_16x16x16_bf16 v[64:67], v[186:187], v[154:155], v[64:67]
    s_lshl_b32 s86, s36, 2
    s_add_u32 s86, s86, 161024
    v_mov_b32 v254, s86
    s_waitcnt vmcnt(0) lgkmcnt(0)
    ds_write_b32 v254, v25
    v_mfma_f32_16x16x32_bf16 v[36:39], v[136:139], v[116:119], v[36:39]
    v_mfma_f32_16x16x32_bf16 v[44:47], v[144:147], v[116:119], v[44:47]
    v_mfma_f32_16x16x32_bf16 v[40:43], v[140:143], v[116:119], v[40:43]
    v_mfma_f32_16x16x32_bf16 v[48:51], v[148:151], v[116:119], v[48:51]
    v_mfma_f32_16x16x32_bf16 v[84:87], v[216:219], v[244:247], v[84:87]
    v_mfma_f32_16x16x32_bf16 v[88:91], v[220:223], v[244:247], v[88:91]
    v_mfma_f32_16x16x32_bf16 v[92:95], v[224:227], v[244:247], v[92:95]
    v_mfma_f32_16x16x32_bf16 v[96:99], v[228:231], v[244:247], v[96:99]
    v_mfma_f32_16x16x32_bf16 v[52:55], v[136:139], v[120:123], v[52:55]
    v_mfma_f32_16x16x32_bf16 v[60:63], v[144:147], v[120:123], v[60:63]
    v_mfma_f32_16x16x32_bf16 v[56:59], v[140:143], v[120:123], v[56:59]
    v_mfma_f32_16x16x32_bf16 v[64:67], v[148:151], v[120:123], v[64:67]
    v_mfma_f32_16x16x32_bf16 v[100:103], v[216:219], v[248:251], v[100:103]
    v_mfma_f32_16x16x32_bf16 v[104:107], v[220:223], v[248:251], v[104:107]
    v_mfma_f32_16x16x32_bf16 v[108:111], v[224:227], v[248:251], v[108:111]
    v_mfma_f32_16x16x32_bf16 v[112:115], v[228:231], v[248:251], v[112:115]
    s_setprio 1
    v_mul_f32 v36, v36, v169
    v_mul_f32 v37, v37, v169
    v_mul_f32 v38, v38, v169
    v_mul_f32 v39, v39, v169
    v_mul_f32 v44, v44, v169
    v_mul_f32 v45, v45, v169
    v_mul_f32 v46, v46, v169
    v_mul_f32 v47, v47, v169
    s_add_u32 s85, s75, 6
    s_and_b32 s85, s85, 15
    s_lshl_b32 s85, s85, 15
    buffer_load_dwordx4 v[220:223], v30, s[32:35], s85 offen
    v_exp_f32 v36, v36
    v_exp_f32 v37, v37
    v_mfma_f32_16x16x16_bf16 v[68:71], v[180:181], v[156:157], v[68:71]
    v_exp_f32 v38, v38
    v_exp_f32 v39, v39
    v_mfma_f32_16x16x16_bf16 v[76:79], v[184:185], v[156:157], v[76:79]
    v_exp_f32 v44, v44
    v_exp_f32 v45, v45
    v_mfma_f32_16x16x16_bf16 v[72:75], v[182:183], v[156:157], v[72:75]
    v_exp_f32 v46, v46
    v_exp_f32 v47, v47
    v_mfma_f32_16x16x16_bf16 v[80:83], v[186:187], v[156:157], v[80:83]
    s_add_u32 s85, s85, s81
    buffer_load_dwordx4 v[224:227], v30, s[32:35], s85 offen
    v_fma_f32 v36, v36, v168, v168
    v_fma_f32 v37, v37, v168, v168
    v_fma_f32 v38, v38, v168, v168
    v_fma_f32 v39, v39, v168, v168
    v_fma_f32 v44, v44, v168, v168
    v_fma_f32 v45, v45, v168, v168
    v_fma_f32 v46, v46, v168, v168
    v_fma_f32 v47, v47, v168, v168
    s_add_u32 s85, s75, 7
    s_and_b32 s85, s85, 15
    s_lshl_b32 s85, s85, 15
    buffer_load_dwordx4 v[228:231], v30, s[32:35], s85 offen
    v_rcp_f32 v36, v36
    v_rcp_f32 v37, v37
    v_mfma_f32_16x16x32_bf16 v[68:71], v[136:139], v[124:127], v[68:71]
    v_rcp_f32 v38, v38
    v_rcp_f32 v39, v39
    v_mfma_f32_16x16x32_bf16 v[76:79], v[144:147], v[124:127], v[76:79]
    v_rcp_f32 v44, v44
    v_rcp_f32 v45, v45
    v_mfma_f32_16x16x32_bf16 v[72:75], v[140:143], v[124:127], v[72:75]
    v_rcp_f32 v46, v46
    v_rcp_f32 v47, v47
    v_mfma_f32_16x16x32_bf16 v[80:83], v[148:151], v[124:127], v[80:83]
    s_add_u32 s85, s85, s81
    buffer_load_dwordx4 v[232:235], v30, s[32:35], s85 offen
    v_mul_f32 v40, v40, v36
    v_mul_f32 v41, v41, v37
    v_mul_f32 v42, v42, v38
    v_mul_f32 v43, v43, v39
    v_mul_f32 v48, v48, v44
    v_mul_f32 v49, v49, v45
    v_mul_f32 v50, v50, v46
    v_mul_f32 v51, v51, v47
    s_add_u32 s85, s75, 8
    s_and_b32 s85, s85, 15
    s_lshl_b32 s85, s85, 15
    buffer_load_dwordx4 v[236:239], v30, s[32:35], s85 offen
    v_cvt_pk_bf16_f32 v16, v40, v41
    v_cvt_pk_bf16_f32 v17, v42, v43
    v_cvt_pk_bf16_f32 v18, v48, v49
    v_cvt_pk_bf16_f32 v19, v50, v51
    s_add_u32 s38, s56, 0
    buffer_store_dwordx4 v[16:19], v3, s[20:23], s38 offen sc1
    v_mul_f32 v52, v52, v171
    v_mul_f32 v53, v53, v171
    v_mul_f32 v54, v54, v171
    v_mul_f32 v55, v55, v171
    v_mul_f32 v60, v60, v171
    v_mul_f32 v61, v61, v171
    v_mul_f32 v62, v62, v171
    v_mul_f32 v63, v63, v171
    s_add_u32 s85, s85, s81
    buffer_load_dwordx4 v[240:243], v30, s[32:35], s85 offen
    v_exp_f32 v52, v52
    v_exp_f32 v53, v53
    v_mfma_f32_16x16x16_bf16 v[84:87], v[180:181], v[158:159], v[84:87]
    v_exp_f32 v54, v54
    v_exp_f32 v55, v55
    v_mfma_f32_16x16x16_bf16 v[92:95], v[184:185], v[158:159], v[92:95]
    v_exp_f32 v60, v60
    v_exp_f32 v61, v61
    v_mfma_f32_16x16x16_bf16 v[88:91], v[182:183], v[158:159], v[88:91]
    v_exp_f32 v62, v62
    v_exp_f32 v63, v63
    v_mfma_f32_16x16x16_bf16 v[96:99], v[186:187], v[158:159], v[96:99]
    s_add_u32 s85, s75, 9
    s_and_b32 s85, s85, 15
    s_lshl_b32 s85, s85, 15
    buffer_load_dwordx4 v[244:247], v30, s[32:35], s85 offen
    v_fma_f32 v52, v52, v170, v170
    v_fma_f32 v53, v53, v170, v170
    v_fma_f32 v54, v54, v170, v170
    v_fma_f32 v55, v55, v170, v170
    v_fma_f32 v60, v60, v170, v170
    v_fma_f32 v61, v61, v170, v170
    v_fma_f32 v62, v62, v170, v170
    v_fma_f32 v63, v63, v170, v170
    s_add_u32 s85, s85, s81
    buffer_load_dwordx4 v[248:251], v30, s[32:35], s85 offen
    v_rcp_f32 v52, v52
    v_rcp_f32 v53, v53
    v_mfma_f32_16x16x32_bf16 v[84:87], v[136:139], v[128:131], v[84:87]
    v_rcp_f32 v54, v54
    v_rcp_f32 v55, v55
    v_mfma_f32_16x16x32_bf16 v[92:95], v[144:147], v[128:131], v[92:95]
    v_rcp_f32 v60, v60
    v_rcp_f32 v61, v61
    v_mfma_f32_16x16x32_bf16 v[88:91], v[140:143], v[128:131], v[88:91]
    v_rcp_f32 v62, v62
    v_rcp_f32 v63, v63
    v_mfma_f32_16x16x32_bf16 v[96:99], v[148:151], v[128:131], v[96:99]
    v_mul_f32 v56, v56, v52
    v_mul_f32 v57, v57, v53
    v_mul_f32 v58, v58, v54
    v_mul_f32 v59, v59, v55
    v_mul_f32 v64, v64, v60
    v_mul_f32 v65, v65, v61
    v_mul_f32 v66, v66, v62
    v_mul_f32 v67, v67, v63
    v_cvt_pk_bf16_f32 v188, v56, v57
    v_cvt_pk_bf16_f32 v189, v58, v59
    v_cvt_pk_bf16_f32 v190, v64, v65
    v_cvt_pk_bf16_f32 v191, v66, v67
    s_add_u32 s38, s56, 74752
    buffer_store_dwordx4 v[188:191], v3, s[20:23], s38 offen sc1
    v_mul_f32 v68, v68, v173
    v_mul_f32 v69, v69, v173
    v_mul_f32 v70, v70, v173
    v_mul_f32 v71, v71, v173
    v_mul_f32 v76, v76, v173
    v_mul_f32 v77, v77, v173
    v_mul_f32 v78, v78, v173
    v_mul_f32 v79, v79, v173
    v_exp_f32 v68, v68
    v_exp_f32 v69, v69
    v_mfma_f32_16x16x16_bf16 v[100:103], v[180:181], v[160:161], v[100:103]
    v_exp_f32 v70, v70
    v_exp_f32 v71, v71
    v_mfma_f32_16x16x16_bf16 v[108:111], v[184:185], v[160:161], v[108:111]
    v_exp_f32 v76, v76
    v_exp_f32 v77, v77
    v_mfma_f32_16x16x16_bf16 v[104:107], v[182:183], v[160:161], v[104:107]
    v_exp_f32 v78, v78
    v_exp_f32 v79, v79
    v_mfma_f32_16x16x16_bf16 v[112:115], v[186:187], v[160:161], v[112:115]
    v_fma_f32 v68, v68, v172, v172
    v_fma_f32 v69, v69, v172, v172
    v_fma_f32 v70, v70, v172, v172
    v_fma_f32 v71, v71, v172, v172
    v_fma_f32 v76, v76, v172, v172
    v_fma_f32 v77, v77, v172, v172
    v_fma_f32 v78, v78, v172, v172
    v_fma_f32 v79, v79, v172, v172
    v_rcp_f32 v68, v68
    v_rcp_f32 v69, v69
    v_mfma_f32_16x16x32_bf16 v[100:103], v[136:139], v[132:135], v[100:103]
    v_rcp_f32 v70, v70
    v_rcp_f32 v71, v71
    v_mfma_f32_16x16x32_bf16 v[108:111], v[144:147], v[132:135], v[108:111]
    v_rcp_f32 v76, v76
    v_rcp_f32 v77, v77
    v_mfma_f32_16x16x32_bf16 v[104:107], v[140:143], v[132:135], v[104:107]
    v_rcp_f32 v78, v78
    v_rcp_f32 v79, v79
    v_mfma_f32_16x16x32_bf16 v[112:115], v[148:151], v[132:135], v[112:115]
    v_mul_f32 v72, v72, v68
    v_mul_f32 v73, v73, v69
    v_mul_f32 v74, v74, v70
    v_mul_f32 v75, v75, v71
    v_mul_f32 v80, v80, v76
    v_mul_f32 v81, v81, v77
    v_mul_f32 v82, v82, v78
    v_mul_f32 v83, v83, v79
    v_cvt_pk_bf16_f32 v16, v72, v73
    v_cvt_pk_bf16_f32 v17, v74, v75
    v_cvt_pk_bf16_f32 v18, v80, v81
    v_cvt_pk_bf16_f32 v19, v82, v83
    s_add_u32 s38, s56, 149504
    buffer_store_dwordx4 v[16:19], v3, s[20:23], s38 offen sc1
    v_mul_f32 v84, v84, v175
    v_mul_f32 v85, v85, v175
    v_mul_f32 v86, v86, v175
    v_mul_f32 v87, v87, v175
    v_mul_f32 v92, v92, v175
    v_mul_f32 v93, v93, v175
    v_mul_f32 v94, v94, v175
    v_mul_f32 v95, v95, v175
    v_exp_f32 v84, v84
    v_exp_f32 v85, v85
    v_exp_f32 v86, v86
    v_exp_f32 v87, v87
    v_exp_f32 v92, v92
    v_exp_f32 v93, v93
    v_exp_f32 v94, v94
    v_exp_f32 v95, v95
    v_fma_f32 v84, v84, v174, v174
    v_fma_f32 v85, v85, v174, v174
    v_fma_f32 v86, v86, v174, v174
    v_fma_f32 v87, v87, v174, v174
    v_fma_f32 v92, v92, v174, v174
    v_fma_f32 v93, v93, v174, v174
    v_fma_f32 v94, v94, v174, v174
    v_fma_f32 v95, v95, v174, v174
    v_rcp_f32 v84, v84
    v_rcp_f32 v85, v85
    v_rcp_f32 v86, v86
    v_rcp_f32 v87, v87
    v_rcp_f32 v92, v92
    v_rcp_f32 v93, v93
    v_rcp_f32 v94, v94
    v_rcp_f32 v95, v95
    v_mul_f32 v88, v88, v84
    v_mul_f32 v89, v89, v85
    v_mul_f32 v90, v90, v86
    v_mul_f32 v91, v91, v87
    v_mul_f32 v96, v96, v92
    v_mul_f32 v97, v97, v93
    v_mul_f32 v98, v98, v94
    v_mul_f32 v99, v99, v95
    v_cvt_pk_bf16_f32 v188, v88, v89
    v_cvt_pk_bf16_f32 v189, v90, v91
    v_cvt_pk_bf16_f32 v190, v96, v97
    v_cvt_pk_bf16_f32 v191, v98, v99
    s_add_u32 s38, s56, 224256
    buffer_store_dwordx4 v[188:191], v3, s[20:23], s38 offen sc1
    v_mul_f32 v100, v100, v177
    v_mul_f32 v101, v101, v177
    v_mul_f32 v102, v102, v177
    v_mul_f32 v103, v103, v177
    v_mul_f32 v108, v108, v177
    v_mul_f32 v109, v109, v177
    v_mul_f32 v110, v110, v177
    v_mul_f32 v111, v111, v177
    v_exp_f32 v100, v100
    v_exp_f32 v101, v101
    v_exp_f32 v102, v102
    v_exp_f32 v103, v103
    v_exp_f32 v108, v108
    v_exp_f32 v109, v109
    v_exp_f32 v110, v110
    v_exp_f32 v111, v111
    v_fma_f32 v100, v100, v176, v176
    v_fma_f32 v101, v101, v176, v176
    v_fma_f32 v102, v102, v176, v176
    v_fma_f32 v103, v103, v176, v176
    v_fma_f32 v108, v108, v176, v176
    v_fma_f32 v109, v109, v176, v176
    v_fma_f32 v110, v110, v176, v176
    v_fma_f32 v111, v111, v176, v176
    v_rcp_f32 v100, v100
    v_rcp_f32 v101, v101
    v_rcp_f32 v102, v102
    v_rcp_f32 v103, v103
    v_rcp_f32 v108, v108
    v_rcp_f32 v109, v109
    v_rcp_f32 v110, v110
    v_rcp_f32 v111, v111
    v_mul_f32 v104, v104, v100
    v_mul_f32 v105, v105, v101
    v_mul_f32 v106, v106, v102
    v_mul_f32 v107, v107, v103
    v_mul_f32 v112, v112, v108
    v_mul_f32 v113, v113, v109
    v_mul_f32 v114, v114, v110
    v_mul_f32 v115, v115, v111
    v_cvt_pk_bf16_f32 v16, v104, v105
    v_cvt_pk_bf16_f32 v17, v106, v107
    v_cvt_pk_bf16_f32 v18, v112, v113
    v_cvt_pk_bf16_f32 v19, v114, v115
    s_add_u32 s38, s56, 299008
    buffer_store_dwordx4 v[16:19], v3, s[20:23], s38 offen sc1
    s_branch P2_start
K_glu5o:
    s_waitcnt vmcnt(4)
    s_cmp_lg_u32 s36, 0
    s_cbranch_scc1 AR_16
    s_bfe_u32 s96, s2, 0x10003
    s_lshl_b32 s96, s96, 7
    v_mov_b32 v254, 1
    v_mov_b32 v2, 0
    s_mov_b64 exec, 1
    buffer_atomic_add v254, v2, s[28:31], s96 offen sc1
    s_mov_b64 exec, -1
AR_16:
    s_barrier
    ds_read_b64_tr_b16 v[216:217], v12 offset:32768
    ds_read_b64_tr_b16 v[218:219], v12 offset:33792
    ds_read_b128 v[232:235], v8 offset:40960
    ds_read_b128 v[236:239], v8 offset:43008
    ds_read_b128 v[240:243], v8 offset:45056
    ds_read_b128 v[244:247], v8 offset:47104
    ds_read_b128 v[248:251], v8 offset:49152
    ds_read_b64_tr_b16 v[220:221], v12 offset:40960
    ds_read_b64_tr_b16 v[222:223], v12 offset:41984
    ds_read_b64_tr_b16 v[224:225], v13 offset:32768
    ds_read_b64_tr_b16 v[226:227], v13 offset:33792
    ds_read_b64_tr_b16 v[228:229], v13 offset:40960
    ds_read_b64_tr_b16 v[230:231], v13 offset:41984
    v_mov_b32 v16, 0x3f803f80
    v_mov_b32 v17, 0x3f803f80
    v_mov_b32 v18, 0x3f803f80
    v_mov_b32 v19, 0x3f803f80
    s_waitcnt lgkmcnt(0)
    s_setprio 1
    v_mfma_f32_16x16x32_bf16 v[36:39], v[216:219], v[232:235], 0
    s_add_u32 m0, s37, 73728
    s_add_u32 s38, s49, 0
    buffer_load_dwordx4 v7, s[16:19], s38 offen lds
    ds_read_b64_tr_b16 v[136:137], v10 offset:24576
    v_mfma_f32_16x16x32_bf16 v[52:55], v[216:219], v[236:239], 0
    s_add_u32 m0, s37, 81920
    s_add_u32 s38, s49, 114688
    buffer_load_dwordx4 v7, s[12:15], s38 offen lds
    ds_read_b64_tr_b16 v[138:139], v10 offset:25600
    v_mfma_f32_16x16x32_bf16 v[68:71], v[216:219], v[240:243], 0
    s_add_u32 m0, s37, 90112
    s_add_u32 s38, s49, 114688
    buffer_load_dwordx4 v7, s[16:19], s38 offen lds
    ds_read_b128 v[116:119], v9 offset:40960
    v_mfma_f32_16x16x32_bf16 v[84:87], v[216:219], v[244:247], 0
    ds_read_b128 v[120:123], v9 offset:43008
    v_mov_b32 v254, 0x80000000
    v_cmp_eq_u32 vcc, 0, v1
    v_mfma_f32_16x16x32_bf16 v[100:103], v[216:219], v[248:251], 0
    ds_read_b128 v[124:127], v9 offset:45056
    v_mfma_f32_16x16x32_bf16 v[40:43], v[220:223], v[232:235], 0
    ds_read_b128 v[128:131], v9 offset:47104
    v_mov_b32 v25, 1
    v_cndmask_b32 v24, v254, 0, vcc
    v_mfma_f32_16x16x32_bf16 v[56:59], v[220:223], v[236:239], 0
    ds_read_b128 v[132:135], v9 offset:49152
    v_mfma_f32_16x16x32_bf16 v[72:75], v[220:223], v[240:243], 0
    ds_read_b64_tr_b16 v[140:141], v10 offset:32768
    v_and_b32 v2, 15, v1
    v_cmp_eq_u32 vcc, 0, v2
    v_mfma_f32_16x16x32_bf16 v[88:91], v[220:223], v[244:247], 0
    ds_read_b64_tr_b16 v[142:143], v10 offset:33792
    v_mfma_f32_16x16x32_bf16 v[104:107], v[220:223], v[248:251], 0
    s_setprio 0
    ds_read_b64_tr_b16 v[144:145], v11 offset:24576
    v_and_b32 v26, 48, v1
    v_cndmask_b32 v23, v254, v26, vcc
    v_mfma_f32_16x16x32_bf16 v[44:47], v[224:227], v[232:235], 0
    ds_read_b64_tr_b16 v[146:147], v11 offset:25600
    v_mfma_f32_16x16x32_bf16 v[60:63], v[224:227], v[236:239], 0
    ds_read_b64_tr_b16 v[148:149], v11 offset:32768
    s_lshl_b32 s98, s36, 2
    s_add_u32 s98, s98, 161024
    v_mov_b32 v2, s98
    v_mov_b32 v26, 0
    ds_write_b32 v2, v26
    ds_write_b32 v2, v26 offset:32
    v_mfma_f32_16x16x32_bf16 v[76:79], v[224:227], v[240:243], 0
    ds_read_b64_tr_b16 v[150:151], v11 offset:33792
    v_mfma_f32_16x16x32_bf16 v[92:95], v[224:227], v[244:247], 0
    s_lshl_b32 s56, s4, 2
    s_add_u32 s56, s56, s77
    s_lshl_b32 s98, s77, 10
    s_add_u32 s64, s64, s98
    s_lshl_b32 s98, s78, 9
    s_add_u32 s64, s64, s98
    s_cmp_eq_u32 s36, 0
    s_cselect_b32 s67, s67, 1073741824
    v_add_u32 v252, 131072, v8
    v_add_u32 v253, 131072, v9
    v_mfma_f32_16x16x32_bf16 v[108:111], v[224:227], v[248:251], 0
    v_mfma_f32_16x16x32_bf16 v[48:51], v[228:231], v[232:235], 0
    s_add_u32 m0, s37, 0
    s_nop 0
    buffer_load_dwordx4 v4, s[8:11], s42 offen lds
    v_mfma_f32_16x16x32_bf16 v[64:67], v[228:231], v[236:239], 0
    v_mfma_f32_16x16x32_bf16 v[80:83], v[228:231], v[240:243], 0
    s_add_u32 m0, s37, 8192
    s_nop 0
    buffer_load_dwordx4 v5, s[8:11], s42 offen lds
    v_mfma_f32_16x16x32_bf16 v[96:99], v[228:231], v[244:247], 0
    v_mfma_f32_16x16x32_bf16 v[112:115], v[228:231], v[248:251], 0
    s_waitcnt lgkmcnt(0)
    s_cmp_ge_u32 s5, 8
    s_cbranch_scc0 SK_17
    v_mfma_f32_16x16x32_bf16 v[184:187], v[216:219], v[16:19], 0
    v_mfma_f32_16x16x32_bf16 v[188:191], v[220:223], v[16:19], 0
    v_mfma_f32_16x16x32_bf16 v[184:187], v[136:139], v[16:19], v[184:187]
    v_mfma_f32_16x16x32_bf16 v[188:191], v[140:143], v[16:19], v[188:191]
SK_17:
    s_barrier
    s_setprio 3
    v_mfma_f32_16x16x32_bf16 v[36:39], v[136:139], v[116:119], v[36:39]
    s_add_u32 m0, s37, 16384
    s_nop 0
    buffer_load_dwordx4 v6, s[8:11], s42 offen lds
    v_mfma_f32_16x16x32_bf16 v[52:55], v[136:139], v[120:123], v[52:55]
    s_add_u32 m0, s37, 114688
    s_add_u32 s38, s50, 0
    buffer_load_dwordx4 v7, s[12:15], s38 offen lds
    v_mfma_f32_16x16x32_bf16 v[68:71], v[136:139], v[124:127], v[68:71]
    s_add_u32 m0, s37, 122880
    s_add_u32 s38, s50, 0
    buffer_load_dwordx4 v7, s[16:19], s38 offen lds
    v_mfma_f32_16x16x32_bf16 v[84:87], v[136:139], v[128:131], v[84:87]
    s_add_u32 m0, s37, 98304
    s_add_u32 s38, s50, 114688
    buffer_load_dwordx4 v7, s[12:15], s38 offen lds
    v_mfma_f32_16x16x32_bf16 v[100:103], v[136:139], v[132:135], v[100:103]
    s_add_u32 m0, s37, 106496
    s_add_u32 s38, s50, 114688
    buffer_load_dwordx4 v7, s[16:19], s38 offen lds
    v_mfma_f32_16x16x32_bf16 v[40:43], v[140:143], v[116:119], v[40:43]
    s_lshl_b32 s98, s56, 10
    s_add_u32 s98, s98, 100352
    v_lshrrev_b32 v254, 5, v1
    v_lshlrev_b32 v254, 9, v254
    v_mfma_f32_16x16x32_bf16 v[56:59], v[140:143], v[120:123], v[56:59]
    v_and_b32 v2, 31, v1
    v_lshl_add_u32 v254, v2, 2, v254
    v_mfma_f32_16x16x32_bf16 v[72:75], v[140:143], v[124:127], v[72:75]
    s_mov_b32 s97, s3
    s_lshl_b32 s99, s77, 2
    s_add_u32 s99, s99, s97
    s_lshl_b32 s99, s99, 9
    s_add_u32 s99, s99, 32768
    v_add_u32 v254, s98, v254
    v_lshrrev_b32 v2, 4, v1
    v_mfma_f32_16x16x32_bf16 v[88:91], v[140:143], v[128:131], v[88:91]
    v_lshlrev_b32 v2, 9, v2
    v_and_b32 v26, 15, v1
    v_mfma_f32_16x16x32_bf16 v[104:107], v[140:143], v[132:135], v[104:107]
    s_setprio 2
    v_lshl_add_u32 v2, v26, 3, v2
    v_add_u32 v2, s99, v2
    v_mfma_f32_16x16x32_bf16 v[44:47], v[144:147], v[116:119], v[44:47]
    s_cmp_ge_u32 s36, 4
    s_cselect_b64 vcc, -1, 0
    v_cndmask_b32 v28, v2, v254, vcc
    v_subrev_u32 v254, 176, v0
    v_mfma_f32_16x16x32_bf16 v[60:63], v[144:147], v[120:123], v[60:63]
    v_cmp_lt_u32 vcc, 79, v254
    v_lshlrev_b32 v3, 4, v1
    s_mov_b64 s[100:101], vcc
    s_mov_b32 s96, s74
    s_add_u32 s96, s96, s97
    s_mul_i32 s96, s96, 73
    s_add_u32 s56, s56, s96
    s_add_u32 s56, s56, 16
    s_lshl_b32 s56, s56, 10
    v_mfma_f32_16x16x32_bf16 v[76:79], v[144:147], v[124:127], v[76:79]
    s_mov_b32 s68, 0x22222222
    s_mov_b32 s69, 0x22222222
    s_mov_b32 s70, 0x44444444
    s_mov_b32 s71, 0x44444444
    s_mov_b32 s72, 0x88888888
    s_mov_b32 s73, 0x88888888
    v_mov_b32 v254, 0x80000000
    v_cmp_gt_u32 vcc, 2, v1
    v_mfma_f32_16x16x32_bf16 v[92:95], v[144:147], v[128:131], v[92:95]
    s_add_u32 s20, s94, 1048576
    s_addc_u32 s21, s95, 0
    s_mov_b32 s22, 9568256
    s_mov_b32 s23, 0x20000
    v_lshlrev_b32 v2, 7, v1
    v_cndmask_b32 v27, v254, v2, vcc
    v_mfma_f32_16x16x32_bf16 v[108:111], v[144:147], v[132:135], v[108:111]
    s_mov_b32 s57, 0xbfb8aa3b
    s_and_b32 s96, s2, 7
    s_lshr_b32 s97, s2, 3
    s_and_b32 s98, s97, 3
    s_lshl_b32 s79, s96, 2
    s_add_u32 s79, s79, s98
    s_lshr_b32 s80, s97, 2
    v_lshlrev_b32 v29, 3, v0
    v_add_u32 v29, 155648, v29
    v_mfma_f32_16x16x32_bf16 v[48:51], v[148:151], v[116:119], v[48:51]
    s_lshl_b32 s75, s80, 1
    s_lshl_b32 s98, s98, 2
    s_add_u32 s75, s75, s98
    v_bfe_u32 v254, v1, 1, 2
    v_lshrrev_b32 v2, 4, v1
    v_mfma_f32_16x16x32_bf16 v[64:67], v[148:151], v[120:123], v[64:67]
    v_xor_b32 v254, v254, v2
    v_lshlrev_b32 v254, 5, v254
    v_mfma_f32_16x16x32_bf16 v[80:83], v[148:151], v[124:127], v[80:83]
    s_add_u32 m0, s37, 24576
    s_add_u32 s38, s51, 0
    buffer_load_dwordx4 v7, s[12:15], s38 offen lds
    v_mfma_f32_16x16x32_bf16 v[96:99], v[148:151], v[128:131], v[96:99]
    s_add_u32 m0, s37, 32768
    s_add_u32 s38, s51, 0
    buffer_load_dwordx4 v7, s[16:19], s38 offen lds
    v_mfma_f32_16x16x32_bf16 v[112:115], v[148:151], v[132:135], v[112:115]
    s_waitcnt vmcnt(9)
    s_barrier
    ds_read_b64_tr_b16 v[216:217], v12 offset:0
    ds_read_b64_tr_b16 v[218:219], v12 offset:1024
    ds_read_b128 v[232:235], v252 offset:0
    ds_read_b128 v[236:239], v252 offset:2048
    ds_read_b128 v[240:243], v252 offset:4096
    ds_read_b128 v[244:247], v252 offset:6144
    ds_read_b128 v[248:251], v252 offset:8192
    ds_read_b64_tr_b16 v[220:221], v12 offset:8192
    ds_read_b64_tr_b16 v[222:223], v12 offset:9216
    ds_read_b64_tr_b16 v[224:225], v13 offset:0
    ds_read_b64_tr_b16 v[226:227], v13 offset:1024
    ds_read_b64_tr_b16 v[228:229], v13 offset:8192
    ds_read_b64_tr_b16 v[230:231], v13 offset:9216
    s_waitcnt lgkmcnt(0)
    s_setprio 1
    v_mfma_f32_16x16x32_bf16 v[36:39], v[216:219], v[232:235], v[36:39]
    ds_read_b64_tr_b16 v[136:137], v12 offset:16384
    v_mfma_f32_16x16x32_bf16 v[52:55], v[216:219], v[236:239], v[52:55]
    ds_read_b64_tr_b16 v[138:139], v12 offset:17408
    s_add_u32 m0, s37, 40960
    s_nop 0
    buffer_load_dwordx4 v4, s[8:11], s43 offen lds
    v_mfma_f32_16x16x32_bf16 v[68:71], v[216:219], v[240:243], v[68:71]
    ds_read_b128 v[116:119], v253 offset:0
    s_add_u32 m0, s37, 49152
    s_nop 0
    buffer_load_dwordx4 v5, s[8:11], s43 offen lds
    v_mfma_f32_16x16x32_bf16 v[84:87], v[216:219], v[244:247], v[84:87]
    ds_read_b128 v[120:123], v253 offset:2048
    v_mfma_f32_16x16x32_bf16 v[100:103], v[216:219], v[248:251], v[100:103]
    ds_read_b128 v[124:127], v253 offset:4096
    s_add_u32 m0, s37, 57344
    s_nop 0
    buffer_load_dwordx4 v6, s[8:11], s43 offen lds
    v_mfma_f32_16x16x32_bf16 v[40:43], v[220:223], v[232:235], v[40:43]
    ds_read_b128 v[128:131], v253 offset:6144
    s_sub_u32 s98, s77, 1
    s_lshl_b32 s98, s98, 19
    s_add_u32 s98, s88, s98
    s_addc_u32 s99, s89, 0
    s_cmp_eq_u32 s77, 0
    s_cselect_b32 s32, s82, s98
    s_cselect_b32 s33, s83, s99
    s_mov_b32 s34, 0x80000
    s_mov_b32 s35, 0x20000
    v_and_b32 v2, 1, v1
    v_lshl_add_u32 v254, v2, 4, v254
    v_mfma_f32_16x16x32_bf16 v[56:59], v[220:223], v[236:239], v[56:59]
    ds_read_b128 v[132:135], v253 offset:8192
    v_mfma_f32_16x16x32_bf16 v[72:75], v[220:223], v[240:243], v[72:75]
    ds_read_b64_tr_b16 v[140:141], v12 offset:24576
    s_lshl_b32 s76, s77, 12
    s_lshl_b32 s98, s78, 11
    s_add_u32 s76, s76, s98
    v_lshrrev_b32 v2, 3, v1
    v_and_b32 v26, 4, v2
    v_mfma_f32_16x16x32_bf16 v[88:91], v[220:223], v[244:247], v[88:91]
    ds_read_b64_tr_b16 v[142:143], v12 offset:25600
    s_cmp_eq_u32 s77, 0
    s_cselect_b64 vcc, -1, 0
    s_cselect_b32 s81, 2, 1
    s_cselect_b32 s99, 12, 14
    s_lshl_b32 s81, s81, 13
    v_add_u32 v26, v26, v2
    v_cndmask_b32 v2, v2, v26, vcc
    v_mfma_f32_16x16x32_bf16 v[104:107], v[220:223], v[248:251], v[104:107]
    s_setprio 0
    ds_read_b64_tr_b16 v[144:145], v13 offset:16384
    v_mfma_f32_16x16x32_bf16 v[44:47], v[224:227], v[232:235], v[44:47]
    ds_read_b64_tr_b16 v[146:147], v13 offset:17408
    s_lshl_b32 s98, s80, 7
    s_lshl_b32 s99, s78, s99
    v_lshl_add_u32 v254, v2, 10, v254
    v_add_u32 v35, s98, v254
    v_mfma_f32_16x16x32_bf16 v[60:63], v[224:227], v[236:239], v[60:63]
    ds_read_b64_tr_b16 v[148:149], v13 offset:24576
    v_mfma_f32_16x16x32_bf16 v[76:79], v[224:227], v[240:243], v[76:79]
    ds_read_b64_tr_b16 v[150:151], v13 offset:25600
    v_add_u32 v30, s99, v35
    s_lshl_b32 s98, s2, 3
    s_add_u32 s98, s98, s36
    s_mul_i32 s99, s98, 896
    s_lshl_b32 s98, s98, 8
    v_min_u32 v254, 6, v1
    v_mfma_f32_16x16x32_bf16 v[92:95], v[224:227], v[244:247], v[92:95]
    v_lshl_add_u32 v31, v254, 7, s99
    v_min_u32 v2, 1, v1
    v_mfma_f32_16x16x32_bf16 v[108:111], v[224:227], v[248:251], v[108:111]
    v_mfma_f32_16x16x32_bf16 v[48:51], v[228:231], v[232:235], v[48:51]
    v_lshl_add_u32 v32, v2, 7, s98
    v_and_b32 v2, 15, v1
    v_mfma_f32_16x16x32_bf16 v[64:67], v[228:231], v[236:239], v[64:67]
    s_lshl_b32 s98, s74, 7
    s_add_u32 s98, s98, 155648
    v_lshl_add_u32 v14, v2, 3, s98
    v_mfma_f32_16x16x32_bf16 v[80:83], v[228:231], v[240:243], v[80:83]
    v_mfma_f32_16x16x32_bf16 v[96:99], v[228:231], v[244:247], v[96:99]
    s_lshl_b32 s98, s77, 9
    s_add_u32 s98, s98, 157696
    v_lshl_add_u32 v15, v2, 3, s98
    v_mfma_f32_16x16x32_bf16 v[112:115], v[228:231], v[248:251], v[112:115]
    s_waitcnt lgkmcnt(0)
    s_cmp_ge_u32 s5, 8
    s_cbranch_scc0 SK_18
    v_mfma_f32_16x16x32_bf16 v[184:187], v[216:219], v[16:19], v[184:187]
    v_mfma_f32_16x16x32_bf16 v[188:191], v[220:223], v[16:19], v[188:191]
    v_mfma_f32_16x16x32_bf16 v[184:187], v[136:139], v[16:19], v[184:187]
    v_mfma_f32_16x16x32_bf16 v[188:191], v[140:143], v[16:19], v[188:191]
SK_18:
    s_waitcnt vmcnt(5)
    s_barrier
    s_setprio 3
    v_mfma_f32_16x16x32_bf16 v[36:39], v[136:139], v[116:119], v[36:39]
    s_add_u32 m0, s37, 65536
    s_add_u32 s38, s51, 114688
    buffer_load_dwordx4 v7, s[12:15], s38 offen lds
    ds_read_b64_tr_b16 v[216:217], v12 offset:49152
    v_mfma_f32_16x16x32_bf16 v[52:55], v[136:139], v[120:123], v[52:55]
    s_add_u32 m0, s37, 73728
    s_add_u32 s38, s51, 114688
    buffer_load_dwordx4 v7, s[16:19], s38 offen lds
    ds_read_b64_tr_b16 v[218:219], v12 offset:50176
    v_mfma_f32_16x16x32_bf16 v[68:71], v[136:139], v[124:127], v[68:71]
    ds_read_b128 v[232:235], v8 offset:0
    v_mfma_f32_16x16x32_bf16 v[84:87], v[136:139], v[128:131], v[84:87]
    ds_read_b128 v[236:239], v8 offset:2048
    v_mfma_f32_16x16x32_bf16 v[100:103], v[136:139], v[132:135], v[100:103]
    ds_read_b128 v[240:243], v8 offset:4096
    v_mfma_f32_16x16x32_bf16 v[40:43], v[140:143], v[116:119], v[40:43]
    ds_read_b128 v[244:247], v8 offset:6144
    v_mfma_f32_16x16x32_bf16 v[56:59], v[140:143], v[120:123], v[56:59]
    ds_read_b128 v[248:251], v8 offset:8192
    s_cmp_ge_u32 s5, 8
    s_cbranch_scc0 SK_19
    v_or_b32 v184, 1, v184
    v_or_b32 v185, 1, v185
    v_or_b32 v186, 1, v186
    v_or_b32 v187, 1, v187
    buffer_store_dwordx4 v[184:187], v23, s[24:27], s64 offen offset:0 sc1
    v_or_b32 v188, 1, v188
    v_or_b32 v189, 1, v189
    v_or_b32 v190, 1, v190
    v_or_b32 v191, 1, v191
    buffer_store_dwordx4 v[188:191], v23, s[24:27], s64 offen offset:64 sc1
SK_19:
    v_mfma_f32_16x16x32_bf16 v[72:75], v[140:143], v[124:127], v[72:75]
    ds_read_b64_tr_b16 v[220:221], v12 offset:57344
    v_mfma_f32_16x16x32_bf16 v[88:91], v[140:143], v[128:131], v[88:91]
    ds_read_b64_tr_b16 v[222:223], v12 offset:58368
    v_mfma_f32_16x16x32_bf16 v[104:107], v[140:143], v[132:135], v[104:107]
    s_setprio 2
    ds_read_b64_tr_b16 v[224:225], v13 offset:49152
    v_mfma_f32_16x16x32_bf16 v[44:47], v[144:147], v[116:119], v[44:47]
    ds_read_b64_tr_b16 v[226:227], v13 offset:50176
    s_add_u32 m0, s37, 81920
    s_add_u32 s38, s52, 0
    buffer_load_dwordx4 v7, s[12:15], s38 offen lds
    v_mfma_f32_16x16x32_bf16 v[60:63], v[144:147], v[120:123], v[60:63]
    ds_read_b64_tr_b16 v[228:229], v13 offset:57344
    v_mfma_f32_16x16x32_bf16 v[76:79], v[144:147], v[124:127], v[76:79]
    ds_read_b64_tr_b16 v[230:231], v13 offset:58368
    v_mfma_f32_16x16x32_bf16 v[92:95], v[144:147], v[128:131], v[92:95]
    v_mfma_f32_16x16x32_bf16 v[108:111], v[144:147], v[132:135], v[108:111]
    v_mfma_f32_16x16x32_bf16 v[48:51], v[148:151], v[116:119], v[48:51]
    s_add_u32 m0, s37, 90112
    s_add_u32 s38, s52, 0
    buffer_load_dwordx4 v7, s[16:19], s38 offen lds
    v_mfma_f32_16x16x32_bf16 v[64:67], v[148:151], v[120:123], v[64:67]
    v_mfma_f32_16x16x32_bf16 v[80:83], v[148:151], v[124:127], v[80:83]
    v_mfma_f32_16x16x32_bf16 v[96:99], v[148:151], v[128:131], v[96:99]
    v_mfma_f32_16x16x32_bf16 v[112:115], v[148:151], v[132:135], v[112:115]
    s_waitcnt lgkmcnt(0)
    s_setprio 1
    v_mfma_f32_16x16x32_bf16 v[36:39], v[216:219], v[232:235], v[36:39]
    s_cmp_eq_u32 s36, 0
    s_cbranch_scc0 SK_20
    buffer_load_dword v26, v27, s[28:31], 0 offen sc1
SK_20:
    ds_read_b64_tr_b16 v[136:137], v12 offset:32768
    v_mfma_f32_16x16x32_bf16 v[52:55], v[216:219], v[236:239], v[52:55]
    ds_read_b64_tr_b16 v[138:139], v12 offset:33792
    s_add_u32 m0, s37, 131072
    s_nop 0
    buffer_load_dwordx4 v4, s[8:11], s44 offen lds
    v_mfma_f32_16x16x32_bf16 v[68:71], v[216:219], v[240:243], v[68:71]
    ds_read_b128 v[116:119], v9 offset:0
    v_mfma_f32_16x16x32_bf16 v[84:87], v[216:219], v[244:247], v[84:87]
    ds_read_b128 v[120:123], v9 offset:2048
    v_mfma_f32_16x16x32_bf16 v[100:103], v[216:219], v[248:251], v[100:103]
    ds_read_b128 v[124:127], v9 offset:4096
    v_mfma_f32_16x16x32_bf16 v[40:43], v[220:223], v[232:235], v[40:43]
    ds_read_b128 v[128:131], v9 offset:6144
    s_add_u32 m0, s37, 139264
    s_nop 0
    buffer_load_dwordx4 v5, s[8:11], s44 offen lds
    v_mfma_f32_16x16x32_bf16 v[56:59], v[220:223], v[236:239], v[56:59]
    ds_read_b128 v[132:135], v9 offset:8192
    v_mfma_f32_16x16x32_bf16 v[72:75], v[220:223], v[240:243], v[72:75]
    ds_read_b64_tr_b16 v[140:141], v12 offset:40960
    v_mfma_f32_16x16x32_bf16 v[88:91], v[220:223], v[244:247], v[88:91]
    ds_read_b64_tr_b16 v[142:143], v12 offset:41984
    v_mfma_f32_16x16x32_bf16 v[104:107], v[220:223], v[248:251], v[104:107]
    s_setprio 0
    ds_read_b64_tr_b16 v[144:145], v13 offset:32768
    v_mfma_f32_16x16x32_bf16 v[44:47], v[224:227], v[232:235], v[44:47]
    ds_read_b64_tr_b16 v[146:147], v13 offset:33792
    s_add_u32 m0, s37, 147456
    s_nop 0
    buffer_load_dwordx4 v6, s[8:11], s44 offen lds
    v_mfma_f32_16x16x32_bf16 v[60:63], v[224:227], v[236:239], v[60:63]
    ds_read_b64_tr_b16 v[148:149], v13 offset:40960
    v_mfma_f32_16x16x32_bf16 v[76:79], v[224:227], v[240:243], v[76:79]
    ds_read_b64_tr_b16 v[150:151], v13 offset:41984
    v_mfma_f32_16x16x32_bf16 v[92:95], v[224:227], v[244:247], v[92:95]
    v_mfma_f32_16x16x32_bf16 v[108:111], v[224:227], v[248:251], v[108:111]
    v_mfma_f32_16x16x32_bf16 v[48:51], v[228:231], v[232:235], v[48:51]
    v_mfma_f32_16x16x32_bf16 v[64:67], v[228:231], v[236:239], v[64:67]
    v_mfma_f32_16x16x32_bf16 v[80:83], v[228:231], v[240:243], v[80:83]
    v_mfma_f32_16x16x32_bf16 v[96:99], v[228:231], v[244:247], v[96:99]
    v_mfma_f32_16x16x32_bf16 v[112:115], v[228:231], v[248:251], v[112:115]
    s_waitcnt lgkmcnt(0)
    s_waitcnt vmcnt(5)
    s_barrier
    s_setprio 3
    v_mfma_f32_16x16x32_bf16 v[36:39], v[136:139], v[116:119], v[36:39]
    s_add_u32 m0, s37, 114688
    s_add_u32 s38, s52, 114688
    buffer_load_dwordx4 v7, s[12:15], s38 offen lds
    ds_read_b64_tr_b16 v[216:217], v10 offset:24576
    v_mfma_f32_16x16x32_bf16 v[52:55], v[136:139], v[120:123], v[52:55]
    s_add_u32 m0, s37, 122880
    s_add_u32 s38, s52, 114688
    buffer_load_dwordx4 v7, s[16:19], s38 offen lds
    ds_read_b64_tr_b16 v[218:219], v10 offset:25600
    v_mfma_f32_16x16x32_bf16 v[68:71], v[136:139], v[124:127], v[68:71]
    ds_read_b128 v[232:235], v8 offset:40960
    s_add_u32 m0, s37, 98304
    s_add_u32 s38, s53, 0
    buffer_load_dwordx4 v7, s[12:15], s38 offen lds
    v_mfma_f32_16x16x32_bf16 v[84:87], v[136:139], v[128:131], v[84:87]
    ds_read_b128 v[236:239], v8 offset:43008
    v_mfma_f32_16x16x32_bf16 v[100:103], v[136:139], v[132:135], v[100:103]
    ds_read_b128 v[240:243], v8 offset:45056
    v_mfma_f32_16x16x32_bf16 v[40:43], v[140:143], v[116:119], v[40:43]
    ds_read_b128 v[244:247], v8 offset:47104
    v_mfma_f32_16x16x32_bf16 v[56:59], v[140:143], v[120:123], v[56:59]
    ds_read_b128 v[248:251], v8 offset:49152
    v_mfma_f32_16x16x32_bf16 v[72:75], v[140:143], v[124:127], v[72:75]
    ds_read_b64_tr_b16 v[220:221], v10 offset:32768
    v_mfma_f32_16x16x32_bf16 v[88:91], v[140:143], v[128:131], v[88:91]
    ds_read_b64_tr_b16 v[222:223], v10 offset:33792
    v_mfma_f32_16x16x32_bf16 v[104:107], v[140:143], v[132:135], v[104:107]
    s_setprio 2
    ds_read_b64_tr_b16 v[224:225], v11 offset:24576
    v_mfma_f32_16x16x32_bf16 v[44:47], v[144:147], v[116:119], v[44:47]
    global_load_dword v33, v31, s[88:89]
    global_load_dword v34, v32, s[82:83]
    ds_read_b64_tr_b16 v[226:227], v11 offset:25600
    v_mfma_f32_16x16x32_bf16 v[60:63], v[144:147], v[120:123], v[60:63]
    ds_read_b64_tr_b16 v[228:229], v11 offset:32768
    s_add_u32 m0, s37, 106496
    s_add_u32 s38, s53, 0
    buffer_load_dwordx4 v7, s[16:19], s38 offen lds
    v_mfma_f32_16x16x32_bf16 v[76:79], v[144:147], v[124:127], v[76:79]
    ds_read_b64_tr_b16 v[230:231], v11 offset:33792
    v_mfma_f32_16x16x32_bf16 v[92:95], v[144:147], v[128:131], v[92:95]
    v_mfma_f32_16x16x32_bf16 v[108:111], v[144:147], v[132:135], v[108:111]
    v_mfma_f32_16x16x32_bf16 v[48:51], v[148:151], v[116:119], v[48:51]
    v_mfma_f32_16x16x32_bf16 v[64:67], v[148:151], v[120:123], v[64:67]
    v_mfma_f32_16x16x32_bf16 v[80:83], v[148:151], v[124:127], v[80:83]
    v_mfma_f32_16x16x32_bf16 v[96:99], v[148:151], v[128:131], v[96:99]
    v_mfma_f32_16x16x32_bf16 v[112:115], v[148:151], v[132:135], v[112:115]
    s_waitcnt lgkmcnt(0)
    s_setprio 1
    v_mfma_f32_16x16x32_bf16 v[36:39], v[216:219], v[232:235], v[36:39]
    ds_read_b64_tr_b16 v[136:137], v12 offset:0
    v_mfma_f32_16x16x32_bf16 v[52:55], v[216:219], v[236:239], v[52:55]
    ds_read_b64_tr_b16 v[138:139], v12 offset:1024
    s_add_u32 m0, s37, 0
    s_nop 0
    buffer_load_dwordx4 v4, s[8:11], s45 offen lds
    v_mfma_f32_16x16x32_bf16 v[68:71], v[216:219], v[240:243], v[68:71]
    ds_read_b128 v[116:119], v9 offset:40960
    v_mfma_f32_16x16x32_bf16 v[84:87], v[216:219], v[244:247], v[84:87]
    ds_read_b128 v[120:123], v9 offset:43008
    v_mfma_f32_16x16x32_bf16 v[100:103], v[216:219], v[248:251], v[100:103]
    ds_read_b128 v[124:127], v9 offset:45056
    v_mfma_f32_16x16x32_bf16 v[40:43], v[220:223], v[232:235], v[40:43]
    ds_read_b128 v[128:131], v9 offset:47104
    s_add_u32 m0, s37, 8192
    s_nop 0
    buffer_load_dwordx4 v5, s[8:11], s45 offen lds
    v_mfma_f32_16x16x32_bf16 v[56:59], v[220:223], v[236:239], v[56:59]
    ds_read_b128 v[132:135], v9 offset:49152
    v_mfma_f32_16x16x32_bf16 v[72:75], v[220:223], v[240:243], v[72:75]
    ds_read_b64_tr_b16 v[140:141], v12 offset:8192
    v_mfma_f32_16x16x32_bf16 v[88:91], v[220:223], v[244:247], v[88:91]
    ds_read_b64_tr_b16 v[142:143], v12 offset:9216
    v_mfma_f32_16x16x32_bf16 v[104:107], v[220:223], v[248:251], v[104:107]
    s_setprio 0
    ds_read_b64_tr_b16 v[144:145], v13 offset:0
    v_mfma_f32_16x16x32_bf16 v[44:47], v[224:227], v[232:235], v[44:47]
    ds_read_b64_tr_b16 v[146:147], v13 offset:1024
    s_add_u32 m0, s37, 16384
    s_nop 0
    buffer_load_dwordx4 v6, s[8:11], s45 offen lds
    v_mfma_f32_16x16x32_bf16 v[60:63], v[224:227], v[236:239], v[60:63]
    ds_read_b64_tr_b16 v[148:149], v13 offset:8192
    v_mfma_f32_16x16x32_bf16 v[76:79], v[224:227], v[240:243], v[76:79]
    ds_read_b64_tr_b16 v[150:151], v13 offset:9216
    v_mfma_f32_16x16x32_bf16 v[92:95], v[224:227], v[244:247], v[92:95]
    v_mfma_f32_16x16x32_bf16 v[108:111], v[224:227], v[248:251], v[108:111]
    v_mfma_f32_16x16x32_bf16 v[48:51], v[228:231], v[232:235], v[48:51]
    v_mfma_f32_16x16x32_bf16 v[64:67], v[228:231], v[236:239], v[64:67]
    v_mfma_f32_16x16x32_bf16 v[80:83], v[228:231], v[240:243], v[80:83]
    v_mfma_f32_16x16x32_bf16 v[96:99], v[228:231], v[244:247], v[96:99]
    v_mfma_f32_16x16x32_bf16 v[112:115], v[228:231], v[248:251], v[112:115]
    s_waitcnt lgkmcnt(0)
    s_waitcnt vmcnt(7)
    s_cmp_eq_u32 s36, 0
    s_cbranch_scc0 PA_ok_21
    s_waitcnt vmcnt(12)
    v_readlane_b32 s96, v26, 0
    v_readlane_b32 s97, v26, 1
    s_nop 0
    s_add_u32 s96, s96, s97
    s_cmp_ge_u32 s96, 256
    s_cbranch_scc1 PA_ok_21
    s_mov_b32 s98, 0
PA_spin_22:
    s_sleep 2
    buffer_load_dword v26, v27, s[28:31], 0 offen sc1
    s_waitcnt vmcnt(0)
    v_readlane_b32 s96, v26, 0
    v_readlane_b32 s97, v26, 1
    s_nop 0
    s_add_u32 s96, s96, s97
    s_add_u32 s98, s98, 1
    s_cmp_ge_u32 s98, 100000
    s_cbranch_scc1 PA_ok_21
    s_cmp_lt_u32 s96, 256
    s_cbranch_scc1 PA_spin_22
PA_ok_21:
    s_barrier
    s_setprio 3
    v_mfma_f32_16x16x32_bf16 v[36:39], v[136:139], v[116:119], v[36:39]
    s_add_u32 m0, s37, 24576
    s_add_u32 s38, s53, 114688
    buffer_load_dwordx4 v7, s[12:15], s38 offen lds
    ds_read_b64_tr_b16 v[216:217], v12 offset:16384
    v_mfma_f32_16x16x32_bf16 v[52:55], v[136:139], v[120:123], v[52:55]
    s_add_u32 m0, s37, 32768
    s_add_u32 s38, s53, 114688
    buffer_load_dwordx4 v7, s[16:19], s38 offen lds
    ds_read_b64_tr_b16 v[218:219], v12 offset:17408
    v_mfma_f32_16x16x32_bf16 v[68:71], v[136:139], v[124:127], v[68:71]
    ds_read_b128 v[232:235], v252 offset:0
    v_mfma_f32_16x16x32_bf16 v[84:87], v[136:139], v[128:131], v[84:87]
    ds_read_b128 v[236:239], v252 offset:2048
    v_mfma_f32_16x16x32_bf16 v[100:103], v[136:139], v[132:135], v[100:103]
    ds_read_b128 v[240:243], v252 offset:4096
    buffer_load_dwordx2 v[152:153], v28, s[24:27], 0 offen offset:0 sc1
    v_mfma_f32_16x16x32_bf16 v[40:43], v[140:143], v[116:119], v[40:43]
    ds_read_b128 v[244:247], v252 offset:6144
    v_mfma_f32_16x16x32_bf16 v[56:59], v[140:143], v[120:123], v[56:59]
    ds_read_b128 v[248:251], v252 offset:8192
    v_mfma_f32_16x16x32_bf16 v[72:75], v[140:143], v[124:127], v[72:75]
    ds_read_b64_tr_b16 v[220:221], v12 offset:24576
    v_mfma_f32_16x16x32_bf16 v[88:91], v[140:143], v[128:131], v[88:91]
    ds_read_b64_tr_b16 v[222:223], v12 offset:25600
    buffer_load_dwordx2 v[154:155], v28, s[24:27], 0 offen offset:128 sc1
    v_mfma_f32_16x16x32_bf16 v[104:107], v[140:143], v[132:135], v[104:107]
    s_setprio 2
    ds_read_b64_tr_b16 v[224:225], v13 offset:16384
    v_mfma_f32_16x16x32_bf16 v[44:47], v[144:147], v[116:119], v[44:47]
    ds_read_b64_tr_b16 v[226:227], v13 offset:17408
    v_mfma_f32_16x16x32_bf16 v[60:63], v[144:147], v[120:123], v[60:63]
    ds_read_b64_tr_b16 v[228:229], v13 offset:24576
    v_mfma_f32_16x16x32_bf16 v[76:79], v[144:147], v[124:127], v[76:79]
    ds_read_b64_tr_b16 v[230:231], v13 offset:25600
    s_add_u32 m0, s37, 65536
    s_add_u32 s38, s54, 0
    buffer_load_dwordx4 v7, s[12:15], s38 offen lds
    v_mfma_f32_16x16x32_bf16 v[92:95], v[144:147], v[128:131], v[92:95]
    v_mfma_f32_16x16x32_bf16 v[108:111], v[144:147], v[132:135], v[108:111]
    v_mfma_f32_16x16x32_bf16 v[48:51], v[148:151], v[116:119], v[48:51]
    v_mfma_f32_16x16x32_bf16 v[64:67], v[148:151], v[120:123], v[64:67]
    s_add_u32 m0, s37, 73728
    s_add_u32 s38, s54, 0
    buffer_load_dwordx4 v7, s[16:19], s38 offen lds
    v_mfma_f32_16x16x32_bf16 v[80:83], v[148:151], v[124:127], v[80:83]
    v_mfma_f32_16x16x32_bf16 v[96:99], v[148:151], v[128:131], v[96:99]
    v_mfma_f32_16x16x32_bf16 v[112:115], v[148:151], v[132:135], v[112:115]
    s_waitcnt lgkmcnt(0)
    s_setprio 1
    v_mfma_f32_16x16x32_bf16 v[36:39], v[216:219], v[232:235], v[36:39]
    buffer_load_dwordx2 v[156:157], v28, s[24:27], 0 offen offset:256 sc1
    ds_read_b64_tr_b16 v[136:137], v12 offset:49152
    v_mfma_f32_16x16x32_bf16 v[52:55], v[216:219], v[236:239], v[52:55]
    ds_read_b64_tr_b16 v[138:139], v12 offset:50176
    s_add_u32 m0, s37, 40960
    s_nop 0
    buffer_load_dwordx4 v4, s[8:11], s46 offen lds
    v_mfma_f32_16x16x32_bf16 v[68:71], v[216:219], v[240:243], v[68:71]
    ds_read_b128 v[116:119], v253 offset:0
    v_mfma_f32_16x16x32_bf16 v[84:87], v[216:219], v[244:247], v[84:87]
    ds_read_b128 v[120:123], v253 offset:2048
    v_mfma_f32_16x16x32_bf16 v[100:103], v[216:219], v[248:251], v[100:103]
    ds_read_b128 v[124:127], v253 offset:4096
    v_mfma_f32_16x16x32_bf16 v[40:43], v[220:223], v[232:235], v[40:43]
    ds_read_b128 v[128:131], v253 offset:6144
    s_add_u32 m0, s37, 49152
    s_nop 0
    buffer_load_dwordx4 v5, s[8:11], s46 offen lds
    v_mfma_f32_16x16x32_bf16 v[56:59], v[220:223], v[236:239], v[56:59]
    ds_read_b128 v[132:135], v253 offset:8192
    v_mfma_f32_16x16x32_bf16 v[72:75], v[220:223], v[240:243], v[72:75]
    ds_read_b64_tr_b16 v[140:141], v12 offset:57344
    v_mfma_f32_16x16x32_bf16 v[88:91], v[220:223], v[244:247], v[88:91]
    ds_read_b64_tr_b16 v[142:143], v12 offset:58368
    v_mfma_f32_16x16x32_bf16 v[104:107], v[220:223], v[248:251], v[104:107]
    s_setprio 0
    ds_read_b64_tr_b16 v[144:145], v13 offset:49152
    v_mfma_f32_16x16x32_bf16 v[44:47], v[224:227], v[232:235], v[44:47]
    ds_read_b64_tr_b16 v[146:147], v13 offset:50176
    s_add_u32 m0, s37, 57344
    s_nop 0
    buffer_load_dwordx4 v6, s[8:11], s46 offen lds
    v_mfma_f32_16x16x32_bf16 v[60:63], v[224:227], v[236:239], v[60:63]
    ds_read_b64_tr_b16 v[148:149], v13 offset:57344
    v_mfma_f32_16x16x32_bf16 v[76:79], v[224:227], v[240:243], v[76:79]
    ds_read_b64_tr_b16 v[150:151], v13 offset:58368
    v_mfma_f32_16x16x32_bf16 v[92:95], v[224:227], v[244:247], v[92:95]
    v_mfma_f32_16x16x32_bf16 v[108:111], v[224:227], v[248:251], v[108:111]
    buffer_load_dwordx2 v[158:159], v28, s[24:27], 0 offen offset:384 sc1
    v_mfma_f32_16x16x32_bf16 v[48:51], v[228:231], v[232:235], v[48:51]
    v_mfma_f32_16x16x32_bf16 v[64:67], v[228:231], v[236:239], v[64:67]
    v_mfma_f32_16x16x32_bf16 v[80:83], v[228:231], v[240:243], v[80:83]
    v_mfma_f32_16x16x32_bf16 v[96:99], v[228:231], v[244:247], v[96:99]
    v_mfma_f32_16x16x32_bf16 v[112:115], v[228:231], v[248:251], v[112:115]
    s_waitcnt lgkmcnt(0)
    s_waitcnt vmcnt(9)
    s_barrier
    s_setprio 3
    v_mfma_f32_16x16x32_bf16 v[36:39], v[136:139], v[116:119], v[36:39]
    s_add_u32 m0, s37, 81920
    s_add_u32 s38, s54, 114688
    buffer_load_dwordx4 v7, s[12:15], s38 offen lds
    ds_read_b64_tr_b16 v[216:217], v12 offset:32768
    v_mfma_f32_16x16x32_bf16 v[52:55], v[136:139], v[120:123], v[52:55]
    s_add_u32 m0, s37, 90112
    s_add_u32 s38, s54, 114688
    buffer_load_dwordx4 v7, s[16:19], s38 offen lds
    ds_read_b64_tr_b16 v[218:219], v12 offset:33792
    v_mfma_f32_16x16x32_bf16 v[68:71], v[136:139], v[124:127], v[68:71]
    ds_read_b128 v[232:235], v8 offset:0
    s_add_u32 m0, s37, 114688
    s_add_u32 s38, s55, 0
    buffer_load_dwordx4 v7, s[12:15], s38 offen lds
    v_mfma_f32_16x16x32_bf16 v[84:87], v[136:139], v[128:131], v[84:87]
    ds_read_b128 v[236:239], v8 offset:2048
    v_mfma_f32_16x16x32_bf16 v[100:103], v[136:139], v[132:135], v[100:103]
    ds_read_b128 v[240:243], v8 offset:4096
    v_mfma_f32_16x16x32_bf16 v[40:43], v[140:143], v[116:119], v[40:43]
    ds_read_b128 v[244:247], v8 offset:6144
    v_mfma_f32_16x16x32_bf16 v[56:59], v[140:143], v[120:123], v[56:59]
    ds_read_b128 v[248:251], v8 offset:8192
    v_mfma_f32_16x16x32_bf16 v[72:75], v[140:143], v[124:127], v[72:75]
    ds_read_b64_tr_b16 v[220:221], v12 offset:40960
    v_mfma_f32_16x16x32_bf16 v[88:91], v[140:143], v[128:131], v[88:91]
    ds_read_b64_tr_b16 v[222:223], v12 offset:41984
    v_mfma_f32_16x16x32_bf16 v[104:107], v[140:143], v[132:135], v[104:107]
    s_setprio 2
    ds_read_b64_tr_b16 v[224:225], v13 offset:32768
    v_mfma_f32_16x16x32_bf16 v[44:47], v[144:147], v[116:119], v[44:47]
    ds_read_b64_tr_b16 v[226:227], v13 offset:33792
    v_mfma_f32_16x16x32_bf16 v[60:63], v[144:147], v[120:123], v[60:63]
    ds_read_b64_tr_b16 v[228:229], v13 offset:40960
    s_add_u32 m0, s37, 122880
    s_add_u32 s38, s55, 0
    buffer_load_dwordx4 v7, s[16:19], s38 offen lds
    v_mfma_f32_16x16x32_bf16 v[76:79], v[144:147], v[124:127], v[76:79]
    ds_read_b64_tr_b16 v[230:231], v13 offset:41984
    v_mfma_f32_16x16x32_bf16 v[92:95], v[144:147], v[128:131], v[92:95]
    v_mfma_f32_16x16x32_bf16 v[108:111], v[144:147], v[132:135], v[108:111]
    v_mfma_f32_16x16x32_bf16 v[48:51], v[148:151], v[116:119], v[48:51]
    v_mfma_f32_16x16x32_bf16 v[64:67], v[148:151], v[120:123], v[64:67]
    v_mfma_f32_16x16x32_bf16 v[80:83], v[148:151], v[124:127], v[80:83]
    v_mfma_f32_16x16x32_bf16 v[96:99], v[148:151], v[128:131], v[96:99]
    v_mfma_f32_16x16x32_bf16 v[112:115], v[148:151], v[132:135], v[112:115]
    s_waitcnt lgkmcnt(0)
    s_setprio 1
    v_mfma_f32_16x16x32_bf16 v[36:39], v[216:219], v[232:235], v[36:39]
    ds_read_b64_tr_b16 v[136:137], v10 offset:24576
    v_mfma_f32_16x16x32_bf16 v[52:55], v[216:219], v[236:239], v[52:55]
    ds_read_b64_tr_b16 v[138:139], v10 offset:25600
    s_add_u32 m0, s37, 131072
    s_nop 0
    buffer_load_dwordx4 v4, s[8:11], s47 offen lds
    v_mfma_f32_16x16x32_bf16 v[68:71], v[216:219], v[240:243], v[68:71]
    ds_read_b128 v[116:119], v9 offset:0
    v_mfma_f32_16x16x32_bf16 v[84:87], v[216:219], v[244:247], v[84:87]
    ds_read_b128 v[120:123], v9 offset:2048
    v_mfma_f32_16x16x32_bf16 v[100:103], v[216:219], v[248:251], v[100:103]
    ds_read_b128 v[124:127], v9 offset:4096
    v_mfma_f32_16x16x32_bf16 v[40:43], v[220:223], v[232:235], v[40:43]
    ds_read_b128 v[128:131], v9 offset:6144
    s_add_u32 m0, s37, 139264
    s_nop 0
    buffer_load_dwordx4 v5, s[8:11], s47 offen lds
    v_mfma_f32_16x16x32_bf16 v[56:59], v[220:223], v[236:239], v[56:59]
    ds_read_b128 v[132:135], v9 offset:8192
    v_mfma_f32_16x16x32_bf16 v[72:75], v[220:223], v[240:243], v[72:75]
    ds_read_b64_tr_b16 v[140:141], v10 offset:32768
    v_mfma_f32_16x16x32_bf16 v[88:91], v[220:223], v[244:247], v[88:91]
    ds_read_b64_tr_b16 v[142:143], v10 offset:33792
    v_mfma_f32_16x16x32_bf16 v[104:107], v[220:223], v[248:251], v[104:107]
    s_setprio 0
    ds_read_b64_tr_b16 v[144:145], v11 offset:24576
    v_mfma_f32_16x16x32_bf16 v[44:47], v[224:227], v[232:235], v[44:47]
    ds_read_b64_tr_b16 v[146:147], v11 offset:25600
    s_add_u32 m0, s37, 147456
    s_nop 0
    buffer_load_dwordx4 v6, s[8:11], s47 offen lds
    v_mfma_f32_16x16x32_bf16 v[60:63], v[224:227], v[236:239], v[60:63]
    ds_read_b64_tr_b16 v[148:149], v11 offset:32768
    v_mfma_f32_16x16x32_bf16 v[76:79], v[224:227], v[240:243], v[76:79]
    ds_read_b64_tr_b16 v[150:151], v11 offset:33792
    v_mfma_f32_16x16x32_bf16 v[92:95], v[224:227], v[244:247], v[92:95]
    v_mfma_f32_16x16x32_bf16 v[108:111], v[224:227], v[248:251], v[108:111]
    v_mfma_f32_16x16x32_bf16 v[48:51], v[228:231], v[232:235], v[48:51]
    v_mfma_f32_16x16x32_bf16 v[64:67], v[228:231], v[236:239], v[64:67]
    v_mfma_f32_16x16x32_bf16 v[80:83], v[228:231], v[240:243], v[80:83]
    v_mfma_f32_16x16x32_bf16 v[96:99], v[228:231], v[244:247], v[96:99]
    v_mfma_f32_16x16x32_bf16 v[112:115], v[228:231], v[248:251], v[112:115]
    s_waitcnt lgkmcnt(0)
    s_waitcnt vmcnt(5)
    s_mov_b32 s98, 0
PC_chk_24:
    v_and_b32 v168, v152, v153
    v_and_b32 v169, v154, v155
    v_and_b32 v168, v168, v169
    v_and_b32 v169, v156, v157
    v_and_b32 v168, v168, v169
    v_and_b32 v169, v158, v159
    v_and_b32 v168, v168, v169
    v_and_b32 v168, 1, v168
    v_cmp_eq_u32 vcc, 0, v168
    s_nop 0
    s_and_b64 vcc, vcc, s[100:101]
    s_cbranch_scc0 PC_ok_23
    s_add_u32 s98, s98, 1
    s_cmp_ge_u32 s98, 100000
    s_cbranch_scc1 PC_ok_23
    s_sleep 2
    buffer_load_dwordx2 v[152:153], v28, s[24:27], 0 offen offset:0 sc1
    buffer_load_dwordx2 v[154:155], v28, s[24:27], 0 offen offset:128 sc1
    buffer_load_dwordx2 v[156:157], v28, s[24:27], 0 offen offset:256 sc1
    buffer_load_dwordx2 v[158:159], v28, s[24:27], 0 offen offset:384 sc1
    s_waitcnt vmcnt(0)
    s_branch PC_chk_24
PC_ok_23:
    s_barrier
    s_setprio 3
    v_mfma_f32_16x16x32_bf16 v[36:39], v[136:139], v[116:119], v[36:39]
    s_add_u32 m0, s37, 98304
    s_add_u32 s38, s55, 114688
    buffer_load_dwordx4 v7, s[12:15], s38 offen lds
    ds_read_b64_tr_b16 v[216:217], v12 offset:0
    v_mfma_f32_16x16x32_bf16 v[52:55], v[136:139], v[120:123], v[52:55]
    s_add_u32 m0, s37, 106496
    s_add_u32 s38, s55, 114688
    buffer_load_dwordx4 v7, s[16:19], s38 offen lds
    ds_read_b64_tr_b16 v[218:219], v12 offset:1024
    v_mfma_f32_16x16x32_bf16 v[68:71], v[136:139], v[124:127], v[68:71]
    ds_read_b128 v[232:235], v8 offset:40960
    v_add_f32 v152, v152, v154
    v_add_f32 v153, v153, v155
    v_mfma_f32_16x16x32_bf16 v[84:87], v[136:139], v[128:131], v[84:87]
    ds_read_b128 v[236:239], v8 offset:43008
    v_add_f32 v152, v152, v156
    v_add_f32 v153, v153, v157
    v_mfma_f32_16x16x32_bf16 v[100:103], v[136:139], v[132:135], v[100:103]
    ds_read_b128 v[240:243], v8 offset:45056
    v_add_f32 v152, v152, v158
    v_add_f32 v153, v153, v159
    v_mfma_f32_16x16x32_bf16 v[40:43], v[140:143], v[116:119], v[40:43]
    ds_read_b128 v[244:247], v8 offset:47104
    v_mul_f32 v152, 0xbb000000, v152
    v_mul_f32 v153, 0x3b000000, v153
    v_mfma_f32_16x16x32_bf16 v[56:59], v[140:143], v[120:123], v[56:59]
    ds_read_b128 v[248:251], v8 offset:49152
    v_mfma_f32_16x16x32_bf16 v[72:75], v[140:143], v[124:127], v[72:75]
    ds_read_b64_tr_b16 v[220:221], v12 offset:8192
    v_fma_f32 v153, -v152, v152, v153
    v_max_f32 v153, 0, v153
    v_mfma_f32_16x16x32_bf16 v[88:91], v[140:143], v[128:131], v[88:91]
    ds_read_b64_tr_b16 v[222:223], v12 offset:9216
    v_cvt_pk_bf16_f32 v153, v153, v153
    v_lshlrev_b32 v153, 16, v153
    v_mfma_f32_16x16x32_bf16 v[104:107], v[140:143], v[132:135], v[104:107]
    s_setprio 2
    ds_read_b64_tr_b16 v[224:225], v13 offset:0
    v_add_f32 v153, 0x3727c5ac, v153
    v_cvt_pk_bf16_f32 v152, v152, v152
    v_mfma_f32_16x16x32_bf16 v[44:47], v[144:147], v[116:119], v[44:47]
    ds_read_b64_tr_b16 v[226:227], v13 offset:1024
    v_mfma_f32_16x16x32_bf16 v[60:63], v[144:147], v[120:123], v[60:63]
    ds_read_b64_tr_b16 v[228:229], v13 offset:8192
    v_cvt_pk_bf16_f32 v153, v153, v153
    v_lshlrev_b32 v153, 16, v153
    v_mfma_f32_16x16x32_bf16 v[76:79], v[144:147], v[124:127], v[76:79]
    ds_read_b64_tr_b16 v[230:231], v13 offset:9216
    v_sqrt_f32 v153, v153
    v_mfma_f32_16x16x32_bf16 v[92:95], v[144:147], v[128:131], v[92:95]
    v_cvt_pk_bf16_f32 v153, v153, v153
    v_lshlrev_b32 v153, 16, v153
    v_mfma_f32_16x16x32_bf16 v[108:111], v[144:147], v[132:135], v[108:111]
    v_and_b32 v152, 0xffff, v152
    v_or_b32 v152, v152, v153
    v_mfma_f32_16x16x32_bf16 v[48:51], v[148:151], v[116:119], v[48:51]
    v_mfma_f32_16x16x32_bf16 v[64:67], v[148:151], v[120:123], v[64:67]
    v_rcp_f32 v153, v153
    v_mfma_f32_16x16x32_bf16 v[80:83], v[148:151], v[124:127], v[80:83]
    ds_write_b64 v29, v[152:153]
    v_mfma_f32_16x16x32_bf16 v[96:99], v[148:151], v[128:131], v[96:99]
    s_add_u32 m0, s76, 0
    s_add_u32 s85, s75, 0
    s_and_b32 s85, s85, 15
    s_lshl_b32 s85, s85, 15
    buffer_load_dwordx4 v30, s[32:35], s85 offen lds
    v_mfma_f32_16x16x32_bf16 v[112:115], v[148:151], v[132:135], v[112:115]
    s_waitcnt lgkmcnt(0)
    s_setprio 1
    v_mfma_f32_16x16x32_bf16 v[36:39], v[216:219], v[232:235], v[36:39]
    s_add_u32 m0, s76, 1024
    s_add_u32 s85, s85, s81
    buffer_load_dwordx4 v30, s[32:35], s85 offen lds
    ds_read_b64_tr_b16 v[136:137], v12 offset:16384
    v_mfma_f32_16x16x32_bf16 v[52:55], v[216:219], v[236:239], v[52:55]
    s_add_u32 m0, s76, 16384
    s_add_u32 s85, s75, 1
    s_and_b32 s85, s85, 15
    s_lshl_b32 s85, s85, 15
    buffer_load_dwordx4 v30, s[32:35], s85 offen lds
    ds_read_b64_tr_b16 v[138:139], v12 offset:17408
    v_mfma_f32_16x16x32_bf16 v[68:71], v[216:219], v[240:243], v[68:71]
    s_add_u32 m0, s76, 17408
    s_add_u32 s85, s85, s81
    buffer_load_dwordx4 v30, s[32:35], s85 offen lds
    ds_read_b128 v[116:119], v9 offset:40960
    v_mfma_f32_16x16x32_bf16 v[84:87], v[216:219], v[244:247], v[84:87]
    ds_read_b128 v[120:123], v9 offset:43008
    v_lshrrev_b32 v26, 4, v1
    v_bfe_u32 v27, v1, 2, 2
    s_lshl_b32 s6, s77, 14
    s_lshl_b32 s7, s75, 10
    v_mfma_f32_16x16x32_bf16 v[100:103], v[216:219], v[248:251], v[100:103]
    ds_read_b128 v[124:127], v9 offset:45056
    v_and_b32 v28, 1, v26
    v_lshlrev_b32 v28, 1, v28
    s_add_u32 s40, s7, 0
    s_and_b32 s40, s40, 0x3c00
    s_or_b32 s40, s40, s6
    s_add_u32 s41, s7, 1024
    s_and_b32 s41, s41, 0x3c00
    s_or_b32 s41, s41, s6
    v_mfma_f32_16x16x32_bf16 v[40:43], v[220:223], v[232:235], v[40:43]
    ds_read_b128 v[128:131], v9 offset:47104
    v_lshrrev_b32 v29, 1, v27
    v_or_b32 v28, v28, v29
    s_add_u32 s42, s7, 2048
    s_and_b32 s42, s42, 0x3c00
    s_or_b32 s42, s42, s6
    s_add_u32 s43, s7, 3072
    s_and_b32 s43, s43, 0x3c00
    s_or_b32 s43, s43, s6
    v_mfma_f32_16x16x32_bf16 v[56:59], v[220:223], v[236:239], v[56:59]
    ds_read_b128 v[132:135], v9 offset:49152
    v_lshlrev_b32 v28, 5, v28
    v_and_b32 v29, 3, v1
    s_add_u32 s44, s7, 4096
    s_and_b32 s44, s44, 0x3c00
    s_or_b32 s44, s44, s6
    s_add_u32 s45, s7, 5120
    s_and_b32 s45, s45, 0x3c00
    s_or_b32 s45, s45, s6
    v_mfma_f32_16x16x32_bf16 v[72:75], v[220:223], v[240:243], v[72:75]
    ds_read_b64_tr_b16 v[140:141], v12 offset:24576
    v_lshl_add_u32 v28, v29, 3, v28
    v_lshl_add_u32 v29, v26, 2, v27
    s_add_u32 s46, s7, 6144
    s_and_b32 s46, s46, 0x3c00
    s_or_b32 s46, s46, s6
    s_add_u32 s47, s7, 7168
    s_and_b32 s47, s47, 0x3c00
    s_or_b32 s47, s47, s6
    v_mfma_f32_16x16x32_bf16 v[88:91], v[220:223], v[244:247], v[88:91]
    ds_read_b64_tr_b16 v[142:143], v12 offset:25600
    v_lshl_add_u32 v28, v29, 7, v28
    s_lshl_b32 s86, s77, 12
    v_add_u32 v20, s86, v28
    v_mfma_f32_16x16x32_bf16 v[104:107], v[220:223], v[248:251], v[104:107]
    s_setprio 0
    ds_read_b64_tr_b16 v[144:145], v13 offset:16384
    v_xor_b32 v21, 32, v20
    v_xor_b32 v22, 64, v20
    s_add_u32 s48, s7, 8192
    s_and_b32 s48, s48, 0x3c00
    s_or_b32 s48, s48, s6
    s_add_u32 s49, s7, 9216
    s_and_b32 s49, s49, 0x3c00
    s_or_b32 s49, s49, s6
    v_mfma_f32_16x16x32_bf16 v[44:47], v[224:227], v[232:235], v[44:47]
    ds_read_b64_tr_b16 v[146:147], v13 offset:17408
    v_xor_b32 v23, 0x60, v20
    v_and_b32 v28, 0x3ff, v35
    s_add_u32 s50, s7, 10240
    s_and_b32 s50, s50, 0x3c00
    s_or_b32 s50, s50, s6
    s_add_u32 s51, s7, 11264
    s_and_b32 s51, s51, 0x3c00
    s_or_b32 s51, s51, s6
    v_mfma_f32_16x16x32_bf16 v[60:63], v[224:227], v[236:239], v[60:63]
    ds_read_b64_tr_b16 v[148:149], v13 offset:24576
    s_lshl_b32 s86, s77, 16
    s_lshl_b32 s87, s78, 14
    s_add_u32 s86, s86, s87
    s_add_u32 s86, s86, 1572864
    v_lshrrev_b32 v29, 3, v1
    v_lshl_add_u32 v28, v29, 10, v28
    v_mfma_f32_16x16x32_bf16 v[76:79], v[224:227], v[240:243], v[76:79]
    ds_read_b64_tr_b16 v[150:151], v13 offset:25600
    v_add_u32 v31, s86, v28
    s_lshl_b32 s86, s79, 2
    s_lshl_b32 s87, s78, 1
    s_add_u32 s86, s86, s87
    s_mul_i32 s87, s86, 74752
    v_mfma_f32_16x16x32_bf16 v[92:95], v[224:227], v[244:247], v[92:95]
    v_lshl_add_u32 v4, v1, 4, s87
    v_add_u32 v5, 74752, v4
    s_add_u32 s52, s7, 12288
    s_and_b32 s52, s52, 0x3c00
    s_or_b32 s52, s52, s6
    s_add_u32 s53, s7, 13312
    s_and_b32 s53, s53, 0x3c00
    s_or_b32 s53, s53, s6
    v_mfma_f32_16x16x32_bf16 v[108:111], v[224:227], v[248:251], v[108:111]
    v_lshrrev_b32 v26, 1, v1
    v_add_u32 v26, s75, v26
    v_and_b32 v26, 15, v26
    s_add_u32 s54, s7, 14336
    s_and_b32 s54, s54, 0x3c00
    s_or_b32 s54, s54, s6
    s_add_u32 s55, s7, 15360
    s_and_b32 s55, s55, 0x3c00
    s_or_b32 s55, s55, s6
    v_mfma_f32_16x16x32_bf16 v[48:51], v[228:231], v[232:235], v[48:51]
    v_and_b32 v27, 1, v1
    v_add_u32 v27, s86, v27
    s_lshl_b32 s6, s77, 11
    s_add_u32 s59, s6, 65536
    s_add_u32 s60, s6, 66560
    v_mfma_f32_16x16x32_bf16 v[64:67], v[228:231], v[236:239], v[64:67]
    v_add_u32 v28, 2, v27
    v_mul_u32_u24 v28, 6554, v28
    v_lshrrev_b32 v28, 16, v28
    s_mov_b32 s16, s90
    s_mov_b32 s17, s91
    s_mov_b32 s18, 2097152
    s_mov_b32 s19, 0x20000
    v_mfma_f32_16x16x32_bf16 v[80:83], v[228:231], v[240:243], v[80:83]
    v_mul_u32_u24 v27, 5958, v27
    v_lshrrev_b32 v27, 16, v27
    s_mov_b32 s12, s88
    s_mov_b32 s13, s89
    s_mov_b32 s14, 1835008
    s_mov_b32 s15, 0x20000
    v_mfma_f32_16x16x32_bf16 v[96:99], v[228:231], v[244:247], v[96:99]
    v_add_u32 v28, -1, v28
    v_max_i32 v27, v27, v28
    v_mfma_f32_16x16x32_bf16 v[112:115], v[228:231], v[248:251], v[112:115]
    s_waitcnt lgkmcnt(0)
    s_waitcnt vmcnt(4)
    s_barrier
    s_setprio 2
    v_mfma_f32_16x16x32_bf16 v[36:39], v[136:139], v[116:119], v[36:39]
    ds_read_b64_tr_b16 v[216:217], v12 offset:49152
    v_mul_u32_u24 v27, 14, v27
    v_lshrrev_b32 v28, 2, v26
    s_lshl_b32 s99, s77, 2
    s_sub_u32 s99, s99, 4
    v_mfma_f32_16x16x32_bf16 v[52:55], v[136:139], v[120:123], v[52:55]
    ds_read_b64_tr_b16 v[218:219], v12 offset:50176
    v_add3_u32 v28, v28, s99, v27
    s_mul_i32 s86, s79, 21846
    s_lshr_b32 s86, s86, 16
    s_lshl_b32 s86, s86, 3
    s_add_u32 s86, s86, 168
    v_lshrrev_b32 v26, 1, v26
    v_mfma_f32_16x16x32_bf16 v[68:71], v[136:139], v[124:127], v[68:71]
    ds_read_b128 v[232:235], v252 offset:0
    v_add_u32 v26, s86, v26
    s_cmp_eq_u32 s77, 0
    s_cselect_b64 s[100:101], -1, 0
    v_cndmask_b32 v28, v28, v26, s[100:101]
    v_mfma_f32_16x16x32_bf16 v[84:87], v[136:139], v[128:131], v[84:87]
    ds_read_b128 v[236:239], v252 offset:2048
    s_lshr_b32 s99, s77, 1
    s_add_u32 s99, s99, 12
    v_add_u32 v27, s99, v27
    s_mov_b32 s100, 0
    s_mov_b32 s101, -1
    v_cndmask_b32 v28, v28, v27, s[100:101]
    v_mfma_f32_16x16x32_bf16 v[100:103], v[136:139], v[132:135], v[100:103]
    ds_read_b128 v[240:243], v252 offset:4096
    v_mfma_f32_16x16x32_bf16 v[40:43], v[140:143], v[116:119], v[40:43]
    ds_read_b128 v[244:247], v252 offset:6144
    v_lshlrev_b32 v6, 7, v28
    v_lshrrev_b32 v26, 3, v0
    v_mfma_f32_16x16x32_bf16 v[56:59], v[140:143], v[120:123], v[56:59]
    ds_read_b128 v[248:251], v252 offset:8192
    v_and_b32 v29, 7, v0
    v_lshlrev_b32 v26, 10, v26
    v_mfma_f32_16x16x32_bf16 v[72:75], v[140:143], v[124:127], v[72:75]
    ds_read_b64_tr_b16 v[220:221], v12 offset:57344
    s_lshl_b32 s86, s79, 16
    s_lshl_b32 s87, s80, 7
    s_add_u32 s86, s86, s87
    v_lshl_add_u32 v26, v29, 4, v26
    v_add_u32 v7, s86, v26
    v_mfma_f32_16x16x32_bf16 v[88:91], v[140:143], v[128:131], v[88:91]
    ds_read_b64_tr_b16 v[222:223], v12 offset:58368
    ds_read_b64 v[168:169], v14 offset:0
    v_mfma_f32_16x16x32_bf16 v[104:107], v[140:143], v[132:135], v[104:107]
    ds_read_b64_tr_b16 v[224:225], v13 offset:49152
    v_mfma_f32_16x16x32_bf16 v[44:47], v[144:147], v[116:119], v[44:47]
    ds_read_b64_tr_b16 v[226:227], v13 offset:50176
    ds_read_b64 v[170:171], v14 offset:128
    v_mfma_f32_16x16x32_bf16 v[60:63], v[144:147], v[120:123], v[60:63]
    ds_read_b64_tr_b16 v[228:229], v13 offset:57344
    ds_read_b64 v[172:173], v14 offset:256
    v_mfma_f32_16x16x32_bf16 v[76:79], v[144:147], v[124:127], v[76:79]
    ds_read_b64_tr_b16 v[230:231], v13 offset:58368
    ds_read_b64 v[174:175], v14 offset:384
    v_mfma_f32_16x16x32_bf16 v[92:95], v[144:147], v[128:131], v[92:95]
    ds_read_b64 v[176:177], v14 offset:512
    v_mfma_f32_16x16x32_bf16 v[108:111], v[144:147], v[132:135], v[108:111]
    v_mfma_f32_16x16x32_bf16 v[48:51], v[148:151], v[116:119], v[48:51]
    ds_read_b64 v[180:181], v15 offset:0
    v_mfma_f32_16x16x32_bf16 v[64:67], v[148:151], v[120:123], v[64:67]
    ds_read_b64 v[182:183], v15 offset:128
    v_mfma_f32_16x16x32_bf16 v[80:83], v[148:151], v[124:127], v[80:83]
    ds_read_b64 v[184:185], v15 offset:256
    v_mfma_f32_16x16x32_bf16 v[96:99], v[148:151], v[128:131], v[96:99]
    ds_read_b64 v[186:187], v15 offset:384
    v_mfma_f32_16x16x32_bf16 v[112:115], v[148:151], v[132:135], v[112:115]
    s_waitcnt lgkmcnt(0)
    v_mfma_f32_16x16x32_bf16 v[36:39], v[216:219], v[232:235], v[36:39]
    ds_read_b64_tr_b16 v[136:137], v12 offset:32768
    v_cmp_gt_u32 vcc, 16, v1
    v_mov_b32 v164, 0xffff
    s_nop 0
    v_cndmask_b32 v165, 0, v164, vcc
    v_mfma_f32_16x16x32_bf16 v[40:43], v[220:223], v[232:235], v[40:43]
    ds_read_b64_tr_b16 v[138:139], v12 offset:33792
    v_and_b32 v153, v168, v165
    v_lshl_or_b32 v152, v153, 16, v153
    v_mfma_f32_16x16x32_bf16 v[44:47], v[224:227], v[232:235], v[44:47]
    ds_read_b128 v[116:119], v253 offset:0
    v_and_b32 v168, 0xffff0000, v168
    v_mul_f32 v169, s57, v169
    v_mfma_f32_16x16x32_bf16 v[48:51], v[228:231], v[232:235], v[48:51]
    ds_read_b128 v[120:123], v253 offset:2048
    v_and_b32 v155, v170, v165
    v_lshl_or_b32 v154, v155, 16, v155
    v_mfma_f32_16x16x32_bf16 v[52:55], v[216:219], v[236:239], v[52:55]
    ds_read_b128 v[124:127], v253 offset:4096
    v_and_b32 v170, 0xffff0000, v170
    v_mul_f32 v171, s57, v171
    v_mfma_f32_16x16x32_bf16 v[56:59], v[220:223], v[236:239], v[56:59]
    ds_read_b128 v[128:131], v253 offset:6144
    v_and_b32 v157, v172, v165
    v_lshl_or_b32 v156, v157, 16, v157
    v_and_b32 v172, 0xffff0000, v172
    v_mul_f32 v173, s57, v173
    v_mfma_f32_16x16x32_bf16 v[60:63], v[224:227], v[236:239], v[60:63]
    ds_read_b128 v[132:135], v253 offset:8192
    v_and_b32 v159, v174, v165
    v_lshl_or_b32 v158, v159, 16, v159
    v_mfma_f32_16x16x32_bf16 v[64:67], v[228:231], v[236:239], v[64:67]
    ds_read_b64_tr_b16 v[140:141], v12 offset:40960
    v_and_b32 v174, 0xffff0000, v174
    v_mul_f32 v175, s57, v175
    v_mfma_f32_16x16x32_bf16 v[68:71], v[216:219], v[240:243], v[68:71]
    ds_read_b64_tr_b16 v[142:143], v12 offset:41984
    v_and_b32 v161, v176, v165
    v_lshl_or_b32 v160, v161, 16, v161
    v_mfma_f32_16x16x32_bf16 v[72:75], v[220:223], v[240:243], v[72:75]
    ds_read_b64_tr_b16 v[144:145], v13 offset:32768
    v_and_b32 v176, 0xffff0000, v176
    v_mul_f32 v177, s57, v177
    v_mfma_f32_16x16x32_bf16 v[76:79], v[224:227], v[240:243], v[76:79]
    ds_read_b64_tr_b16 v[146:147], v13 offset:33792
    v_mfma_f32_16x16x32_bf16 v[80:83], v[228:231], v[240:243], v[80:83]
    ds_read_b64_tr_b16 v[148:149], v13 offset:40960
    v_mfma_f32_16x16x16_bf16 v[36:39], v[180:181], v[152:153], v[36:39]
    ds_read_b64_tr_b16 v[150:151], v13 offset:41984
    v_mfma_f32_16x16x16_bf16 v[44:47], v[184:185], v[152:153], v[44:47]
    v_mfma_f32_16x16x16_bf16 v[40:43], v[182:183], v[152:153], v[40:43]
    v_mfma_f32_16x16x16_bf16 v[48:51], v[186:187], v[152:153], v[48:51]
    v_mfma_f32_16x16x16_bf16 v[52:55], v[180:181], v[154:155], v[52:55]
    v_mfma_f32_16x16x16_bf16 v[60:63], v[184:185], v[154:155], v[60:63]
    v_mfma_f32_16x16x16_bf16 v[56:59], v[182:183], v[154:155], v[56:59]
    v_mfma_f32_16x16x16_bf16 v[64:67], v[186:187], v[154:155], v[64:67]
    s_lshl_b32 s86, s36, 2
    s_add_u32 s86, s86, 161024
    v_mov_b32 v254, s86
    s_waitcnt vmcnt(0) lgkmcnt(0)
    ds_write_b32 v254, v25
    v_mfma_f32_16x16x32_bf16 v[36:39], v[136:139], v[116:119], v[36:39]
    v_mfma_f32_16x16x32_bf16 v[44:47], v[144:147], v[116:119], v[44:47]
    v_mfma_f32_16x16x32_bf16 v[40:43], v[140:143], v[116:119], v[40:43]
    v_mfma_f32_16x16x32_bf16 v[48:51], v[148:151], v[116:119], v[48:51]
    v_mfma_f32_16x16x32_bf16 v[84:87], v[216:219], v[244:247], v[84:87]
    v_mfma_f32_16x16x32_bf16 v[88:91], v[220:223], v[244:247], v[88:91]
    v_mfma_f32_16x16x32_bf16 v[92:95], v[224:227], v[244:247], v[92:95]
    v_mfma_f32_16x16x32_bf16 v[96:99], v[228:231], v[244:247], v[96:99]
    v_mfma_f32_16x16x32_bf16 v[52:55], v[136:139], v[120:123], v[52:55]
    v_mfma_f32_16x16x32_bf16 v[60:63], v[144:147], v[120:123], v[60:63]
    v_mfma_f32_16x16x32_bf16 v[56:59], v[140:143], v[120:123], v[56:59]
    v_mfma_f32_16x16x32_bf16 v[64:67], v[148:151], v[120:123], v[64:67]
    v_mfma_f32_16x16x32_bf16 v[100:103], v[216:219], v[248:251], v[100:103]
    v_mfma_f32_16x16x32_bf16 v[104:107], v[220:223], v[248:251], v[104:107]
    v_mfma_f32_16x16x32_bf16 v[108:111], v[224:227], v[248:251], v[108:111]
    v_mfma_f32_16x16x32_bf16 v[112:115], v[228:231], v[248:251], v[112:115]
    s_setprio 0
    v_mul_f32 v36, v36, v169
    v_mul_f32 v37, v37, v169
    v_mul_f32 v38, v38, v169
    v_mul_f32 v39, v39, v169
    v_mul_f32 v44, v44, v169
    v_mul_f32 v45, v45, v169
    v_mul_f32 v46, v46, v169
    v_mul_f32 v47, v47, v169
    s_add_u32 s85, s75, 6
    s_and_b32 s85, s85, 15
    s_lshl_b32 s85, s85, 15
    buffer_load_dwordx4 v[220:223], v30, s[32:35], s85 offen
    v_exp_f32 v36, v36
    v_exp_f32 v37, v37
    v_mfma_f32_16x16x16_bf16 v[68:71], v[180:181], v[156:157], v[68:71]
    v_exp_f32 v38, v38
    v_exp_f32 v39, v39
    v_mfma_f32_16x16x16_bf16 v[76:79], v[184:185], v[156:157], v[76:79]
    v_exp_f32 v44, v44
    v_exp_f32 v45, v45
    v_mfma_f32_16x16x16_bf16 v[72:75], v[182:183], v[156:157], v[72:75]
    v_exp_f32 v46, v46
    v_exp_f32 v47, v47
    v_mfma_f32_16x16x16_bf16 v[80:83], v[186:187], v[156:157], v[80:83]
    s_add_u32 s85, s85, s81
    buffer_load_dwordx4 v[224:227], v30, s[32:35], s85 offen
    v_fma_f32 v36, v36, v168, v168
    v_fma_f32 v37, v37, v168, v168
    v_fma_f32 v38, v38, v168, v168
    v_fma_f32 v39, v39, v168, v168
    v_fma_f32 v44, v44, v168, v168
    v_fma_f32 v45, v45, v168, v168
    v_fma_f32 v46, v46, v168, v168
    v_fma_f32 v47, v47, v168, v168
    s_add_u32 s85, s75, 7
    s_and_b32 s85, s85, 15
    s_lshl_b32 s85, s85, 15
    buffer_load_dwordx4 v[228:231], v30, s[32:35], s85 offen
    v_rcp_f32 v36, v36
    v_rcp_f32 v37, v37
    v_mfma_f32_16x16x32_bf16 v[68:71], v[136:139], v[124:127], v[68:71]
    v_rcp_f32 v38, v38
    v_rcp_f32 v39, v39
    v_mfma_f32_16x16x32_bf16 v[76:79], v[144:147], v[124:127], v[76:79]
    v_rcp_f32 v44, v44
    v_rcp_f32 v45, v45
    v_mfma_f32_16x16x32_bf16 v[72:75], v[140:143], v[124:127], v[72:75]
    v_rcp_f32 v46, v46
    v_rcp_f32 v47, v47
    v_mfma_f32_16x16x32_bf16 v[80:83], v[148:151], v[124:127], v[80:83]
    s_add_u32 s85, s85, s81
    buffer_load_dwordx4 v[232:235], v30, s[32:35], s85 offen
    v_mul_f32 v40, v40, v36
    v_mul_f32 v41, v41, v37
    v_mul_f32 v42, v42, v38
    v_mul_f32 v43, v43, v39
    v_mul_f32 v48, v48, v44
    v_mul_f32 v49, v49, v45
    v_mul_f32 v50, v50, v46
    v_mul_f32 v51, v51, v47
    s_add_u32 s85, s75, 8
    s_and_b32 s85, s85, 15
    s_lshl_b32 s85, s85, 15
    buffer_load_dwordx4 v[236:239], v30, s[32:35], s85 offen
    v_cvt_pk_bf16_f32 v16, v40, v41
    v_cvt_pk_bf16_f32 v17, v42, v43
    v_cvt_pk_bf16_f32 v18, v48, v49
    v_cvt_pk_bf16_f32 v19, v50, v51
    s_add_u32 s38, s56, 0
    buffer_store_dwordx4 v[16:19], v3, s[20:23], s38 offen sc1
    v_mul_f32 v52, v52, v171
    v_mul_f32 v53, v53, v171
    v_mul_f32 v54, v54, v171
    v_mul_f32 v55, v55, v171
    v_mul_f32 v60, v60, v171
    v_mul_f32 v61, v61, v171
    v_mul_f32 v62, v62, v171
    v_mul_f32 v63, v63, v171
    s_add_u32 s85, s85, s81
    buffer_load_dwordx4 v[240:243], v30, s[32:35], s85 offen
    v_exp_f32 v52, v52
    v_exp_f32 v53, v53
    v_mfma_f32_16x16x16_bf16 v[84:87], v[180:181], v[158:159], v[84:87]
    v_exp_f32 v54, v54
    v_exp_f32 v55, v55
    v_mfma_f32_16x16x16_bf16 v[92:95], v[184:185], v[158:159], v[92:95]
    v_exp_f32 v60, v60
    v_exp_f32 v61, v61
    v_mfma_f32_16x16x16_bf16 v[88:91], v[182:183], v[158:159], v[88:91]
    v_exp_f32 v62, v62
    v_exp_f32 v63, v63
    v_mfma_f32_16x16x16_bf16 v[96:99], v[186:187], v[158:159], v[96:99]
    s_add_u32 s85, s75, 9
    s_and_b32 s85, s85, 15
    s_lshl_b32 s85, s85, 15
    buffer_load_dwordx4 v[244:247], v30, s[32:35], s85 offen
    v_fma_f32 v52, v52, v170, v170
    v_fma_f32 v53, v53, v170, v170
    v_fma_f32 v54, v54, v170, v170
    v_fma_f32 v55, v55, v170, v170
    v_fma_f32 v60, v60, v170, v170
    v_fma_f32 v61, v61, v170, v170
    v_fma_f32 v62, v62, v170, v170
    v_fma_f32 v63, v63, v170, v170
    s_add_u32 s85, s85, s81
    buffer_load_dwordx4 v[248:251], v30, s[32:35], s85 offen
    v_rcp_f32 v52, v52
    v_rcp_f32 v53, v53
    v_mfma_f32_16x16x32_bf16 v[84:87], v[136:139], v[128:131], v[84:87]
    v_rcp_f32 v54, v54
    v_rcp_f32 v55, v55
    v_mfma_f32_16x16x32_bf16 v[92:95], v[144:147], v[128:131], v[92:95]
    v_rcp_f32 v60, v60
    v_rcp_f32 v61, v61
    v_mfma_f32_16x16x32_bf16 v[88:91], v[140:143], v[128:131], v[88:91]
    v_rcp_f32 v62, v62
    v_rcp_f32 v63, v63
    v_mfma_f32_16x16x32_bf16 v[96:99], v[148:151], v[128:131], v[96:99]
    v_mul_f32 v56, v56, v52
    v_mul_f32 v57, v57, v53
    v_mul_f32 v58, v58, v54
    v_mul_f32 v59, v59, v55
    v_mul_f32 v64, v64, v60
    v_mul_f32 v65, v65, v61
    v_mul_f32 v66, v66, v62
    v_mul_f32 v67, v67, v63
    v_cvt_pk_bf16_f32 v188, v56, v57
    v_cvt_pk_bf16_f32 v189, v58, v59
    v_cvt_pk_bf16_f32 v190, v64, v65
    v_cvt_pk_bf16_f32 v191, v66, v67
    s_add_u32 s38, s56, 74752
    buffer_store_dwordx4 v[188:191], v3, s[20:23], s38 offen sc1
    v_mul_f32 v68, v68, v173
    v_mul_f32 v69, v69, v173
    v_mul_f32 v70, v70, v173
    v_mul_f32 v71, v71, v173
    v_mul_f32 v76, v76, v173
    v_mul_f32 v77, v77, v173
    v_mul_f32 v78, v78, v173
    v_mul_f32 v79, v79, v173
    v_exp_f32 v68, v68
    v_exp_f32 v69, v69
    v_mfma_f32_16x16x16_bf16 v[100:103], v[180:181], v[160:161], v[100:103]
    v_exp_f32 v70, v70
    v_exp_f32 v71, v71
    v_mfma_f32_16x16x16_bf16 v[108:111], v[184:185], v[160:161], v[108:111]
    v_exp_f32 v76, v76
    v_exp_f32 v77, v77
    v_mfma_f32_16x16x16_bf16 v[104:107], v[182:183], v[160:161], v[104:107]
    v_exp_f32 v78, v78
    v_exp_f32 v79, v79
    v_mfma_f32_16x16x16_bf16 v[112:115], v[186:187], v[160:161], v[112:115]
    v_fma_f32 v68, v68, v172, v172
    v_fma_f32 v69, v69, v172, v172
    v_fma_f32 v70, v70, v172, v172
    v_fma_f32 v71, v71, v172, v172
    v_fma_f32 v76, v76, v172, v172
    v_fma_f32 v77, v77, v172, v172
    v_fma_f32 v78, v78, v172, v172
    v_fma_f32 v79, v79, v172, v172
    v_rcp_f32 v68, v68
    v_rcp_f32 v69, v69
    v_mfma_f32_16x16x32_bf16 v[100:103], v[136:139], v[132:135], v[100:103]
    v_rcp_f32 v70, v70
    v_rcp_f32 v71, v71
    v_mfma_f32_16x16x32_bf16 v[108:111], v[144:147], v[132:135], v[108:111]
    v_rcp_f32 v76, v76
    v_rcp_f32 v77, v77
    v_mfma_f32_16x16x32_bf16 v[104:107], v[140:143], v[132:135], v[104:107]
    v_rcp_f32 v78, v78
    v_rcp_f32 v79, v79
    v_mfma_f32_16x16x32_bf16 v[112:115], v[148:151], v[132:135], v[112:115]
    v_mul_f32 v72, v72, v68
    v_mul_f32 v73, v73, v69
    v_mul_f32 v74, v74, v70
    v_mul_f32 v75, v75, v71
    v_mul_f32 v80, v80, v76
    v_mul_f32 v81, v81, v77
    v_mul_f32 v82, v82, v78
    v_mul_f32 v83, v83, v79
    v_cvt_pk_bf16_f32 v16, v72, v73
    v_cvt_pk_bf16_f32 v17, v74, v75
    v_cvt_pk_bf16_f32 v18, v80, v81
    v_cvt_pk_bf16_f32 v19, v82, v83
    s_add_u32 s38, s56, 149504
    buffer_store_dwordx4 v[16:19], v3, s[20:23], s38 offen sc1
    v_mul_f32 v84, v84, v175
    v_mul_f32 v85, v85, v175
    v_mul_f32 v86, v86, v175
    v_mul_f32 v87, v87, v175
    v_mul_f32 v92, v92, v175
    v_mul_f32 v93, v93, v175
    v_mul_f32 v94, v94, v175
    v_mul_f32 v95, v95, v175
    v_exp_f32 v84, v84
    v_exp_f32 v85, v85
    v_exp_f32 v86, v86
    v_exp_f32 v87, v87
    v_exp_f32 v92, v92
    v_exp_f32 v93, v93
    v_exp_f32 v94, v94
    v_exp_f32 v95, v95
    v_fma_f32 v84, v84, v174, v174
    v_fma_f32 v85, v85, v174, v174
    v_fma_f32 v86, v86, v174, v174
    v_fma_f32 v87, v87, v174, v174
    v_fma_f32 v92, v92, v174, v174
    v_fma_f32 v93, v93, v174, v174
    v_fma_f32 v94, v94, v174, v174
    v_fma_f32 v95, v95, v174, v174
    v_rcp_f32 v84, v84
    v_rcp_f32 v85, v85
    v_rcp_f32 v86, v86
    v_rcp_f32 v87, v87
    v_rcp_f32 v92, v92
    v_rcp_f32 v93, v93
    v_rcp_f32 v94, v94
    v_rcp_f32 v95, v95
    v_mul_f32 v88, v88, v84
    v_mul_f32 v89, v89, v85
    v_mul_f32 v90, v90, v86
    v_mul_f32 v91, v91, v87
    v_mul_f32 v96, v96, v92
    v_mul_f32 v97, v97, v93
    v_mul_f32 v98, v98, v94
    v_mul_f32 v99, v99, v95
    v_cvt_pk_bf16_f32 v188, v88, v89
    v_cvt_pk_bf16_f32 v189, v90, v91
    v_cvt_pk_bf16_f32 v190, v96, v97
    v_cvt_pk_bf16_f32 v191, v98, v99
    s_add_u32 s38, s56, 224256
    buffer_store_dwordx4 v[188:191], v3, s[20:23], s38 offen sc1
    v_mul_f32 v100, v100, v177
    v_mul_f32 v101, v101, v177
    v_mul_f32 v102, v102, v177
    v_mul_f32 v103, v103, v177
    v_mul_f32 v108, v108, v177
    v_mul_f32 v109, v109, v177
    v_mul_f32 v110, v110, v177
    v_mul_f32 v111, v111, v177
    v_exp_f32 v100, v100
    v_exp_f32 v101, v101
    v_exp_f32 v102, v102
    v_exp_f32 v103, v103
    v_exp_f32 v108, v108
    v_exp_f32 v109, v109
    v_exp_f32 v110, v110
    v_exp_f32 v111, v111
    v_fma_f32 v100, v100, v176, v176
    v_fma_f32 v101, v101, v176, v176
    v_fma_f32 v102, v102, v176, v176
    v_fma_f32 v103, v103, v176, v176
    v_fma_f32 v108, v108, v176, v176
    v_fma_f32 v109, v109, v176, v176
    v_fma_f32 v110, v110, v176, v176
    v_fma_f32 v111, v111, v176, v176
    v_rcp_f32 v100, v100
    v_rcp_f32 v101, v101
    v_rcp_f32 v102, v102
    v_rcp_f32 v103, v103
    v_rcp_f32 v108, v108
    v_rcp_f32 v109, v109
    v_rcp_f32 v110, v110
    v_rcp_f32 v111, v111
    v_mul_f32 v104, v104, v100
    v_mul_f32 v105, v105, v101
    v_mul_f32 v106, v106, v102
    v_mul_f32 v107, v107, v103
    v_mul_f32 v112, v112, v108
    v_mul_f32 v113, v113, v109
    v_mul_f32 v114, v114, v110
    v_mul_f32 v115, v115, v111
    v_cvt_pk_bf16_f32 v16, v104, v105
    v_cvt_pk_bf16_f32 v17, v106, v107
    v_cvt_pk_bf16_f32 v18, v112, v113
    v_cvt_pk_bf16_f32 v19, v114, v115
    s_add_u32 s38, s56, 299008
    buffer_store_dwordx4 v[16:19], v3, s[20:23], s38 offen sc1
    s_branch P2_start
K_qkvm:
    s_waitcnt vmcnt(4)
    s_cmp_lg_u32 s36, 0
    s_cbranch_scc1 AR_25
    s_bfe_u32 s96, s2, 0x10003
    s_lshl_b32 s96, s96, 7
    v_mov_b32 v254, 1
    v_mov_b32 v2, 0
    s_mov_b64 exec, 1
    buffer_atomic_add v254, v2, s[28:31], s96 offen sc1
    s_mov_b64 exec, -1
AR_25:
    s_barrier
    ds_read_b64_tr_b16 v[216:217], v10 offset:8192
    ds_read_b64_tr_b16 v[218:219], v10 offset:8704
    ds_read_b128 v[224:227], v8 offset:51200
    ds_read_b128 v[228:231], v8 offset:53248
    ds_read_b128 v[232:235], v8 offset:55296
    ds_read_b128 v[236:239], v8 offset:57344
    ds_read_b128 v[240:243], v8 offset:59392
    ds_read_b128 v[244:247], v8 offset:61440
    ds_read_b128 v[248:251], v8 offset:63488
    ds_read_b64_tr_b16 v[212:213], v10 offset:0
    ds_read_b64_tr_b16 v[214:215], v10 offset:512
    ds_read_b64_tr_b16 v[220:221], v10 offset:16384
    ds_read_b64_tr_b16 v[222:223], v10 offset:16896
    v_mov_b32 v156, 0x3f803f80
    v_mov_b32 v157, 0x3f803f80
    v_mov_b32 v158, 0x3f803f80
    v_mov_b32 v159, 0x3f803f80
    s_waitcnt lgkmcnt(0)
    s_setprio 1
    v_mfma_f32_16x16x32_bf16 v[60:63], v[216:219], v[224:227], 0
    s_add_u32 m0, s37, 129024
    s_add_u32 s38, s49, 0
    buffer_load_dwordx4 v7, s[12:15], s38 offen lds
    ds_read_b64_tr_b16 v[148:149], v10 offset:12288
    v_mfma_f32_16x16x32_bf16 v[64:67], v[216:219], v[228:231], 0
    s_add_u32 m0, s37, 137216
    s_add_u32 s38, s49, 1024
    buffer_load_dwordx4 v7, s[12:15], s38 offen lds
    ds_read_b64_tr_b16 v[150:151], v10 offset:12800
    v_mfma_f32_16x16x32_bf16 v[68:71], v[216:219], v[232:235], 0
    s_add_u32 m0, s37, 145408
    s_add_u32 s38, s49, 2048
    buffer_load_dwordx4 v7, s[12:15], s38 offen lds
    ds_read_b128 v[116:119], v9 offset:51200
    v_mfma_f32_16x16x32_bf16 v[72:75], v[216:219], v[236:239], 0
    ds_read_b128 v[120:123], v9 offset:53248
    v_mov_b32 v254, 0x80000000
    v_cmp_eq_u32 vcc, 0, v1
    v_mfma_f32_16x16x32_bf16 v[76:79], v[216:219], v[240:243], 0
    ds_read_b128 v[124:127], v9 offset:55296
    v_mov_b32 v25, 1
    v_cndmask_b32 v24, v254, 0, vcc
    v_mfma_f32_16x16x32_bf16 v[80:83], v[216:219], v[244:247], 0
    ds_read_b128 v[128:131], v9 offset:57344
    v_and_b32 v2, 15, v1
    v_cmp_eq_u32 vcc, 0, v2
    v_mfma_f32_16x16x32_bf16 v[84:87], v[216:219], v[248:251], 0
    ds_read_b128 v[132:135], v9 offset:59392
    v_and_b32 v26, 48, v1
    v_cndmask_b32 v23, v254, v26, vcc
    v_mfma_f32_16x16x32_bf16 v[36:39], v[212:215], v[228:231], 0
    ds_read_b128 v[136:139], v9 offset:61440
    v_mfma_f32_16x16x32_bf16 v[40:43], v[212:215], v[232:235], 0
    ds_read_b128 v[140:143], v9 offset:63488
    s_lshl_b32 s98, s36, 2
    s_add_u32 s98, s98, 161024
    v_mov_b32 v2, s98
    v_mov_b32 v26, 0
    ds_write_b32 v2, v26
    ds_write_b32 v2, v26 offset:32
    v_mfma_f32_16x16x32_bf16 v[44:47], v[212:215], v[236:239], 0
    s_setprio 0
    ds_read_b64_tr_b16 v[144:145], v10 offset:4096
    s_lshl_b32 s56, s4, 2
    s_add_u32 s56, s56, s77
    s_lshl_b32 s98, s77, 10
    s_add_u32 s64, s64, s98
    s_cmp_lt_u32 s36, 4
    s_cselect_b32 s64, s64, 1073741824
    s_cmp_eq_u32 s36, 0
    s_cselect_b32 s67, s67, 1073741824
    v_bfe_u32 v2, v1, 2, 2
    v_lshrrev_b32 v26, 4, v1
    v_mfma_f32_16x16x32_bf16 v[48:51], v[212:215], v[240:243], 0
    ds_read_b64_tr_b16 v[146:147], v10 offset:4608
    s_lshl_b32 s98, s36, 9
    s_add_u32 s62, s62, s98
    v_cmp_eq_u32 vcc, v2, v26
    v_and_b32 v2, 15, v1
    v_mfma_f32_16x16x32_bf16 v[52:55], v[212:215], v[244:247], 0
    ds_read_b64_tr_b16 v[152:153], v10 offset:20480
    v_mfma_f32_16x16x32_bf16 v[56:59], v[212:215], v[248:251], 0
    ds_read_b64_tr_b16 v[154:155], v10 offset:20992
    v_lshlrev_b32 v2, 3, v2
    v_cndmask_b32 v22, v254, v2, vcc
    v_mfma_f32_16x16x32_bf16 v[88:91], v[224:227], v[220:223], 0
    s_lshr_b32 s98, s4, 2
    s_sub_u32 s98, s98, s78
    s_mul_i32 s98, s98, 6
    s_add_u32 s98, s98, s36
    s_add_u32 s98, s98, 1
    s_lshl_b32 s98, s98, 11
    s_add_u32 s98, s98, 51200
    v_add_u32 v20, s98, v8
    v_add_u32 v21, s98, v9
    v_mfma_f32_16x16x32_bf16 v[92:95], v[228:231], v[220:223], 0
    v_add_u32 v18, 102400, v8
    v_add_u32 v19, 102400, v9
    v_mfma_f32_16x16x32_bf16 v[96:99], v[232:235], v[220:223], 0
    v_mfma_f32_16x16x32_bf16 v[100:103], v[236:239], v[220:223], 0
    v_add_u32 v11, 51200, v10
    v_subrev_u32 v12, 51200, v10
    v_mfma_f32_16x16x32_bf16 v[104:107], v[240:243], v[220:223], 0
    s_add_u32 m0, s37, 0
    s_nop 0
    buffer_load_dwordx4 v4, s[8:11], s42 offen lds
    v_mfma_f32_16x16x32_bf16 v[108:111], v[244:247], v[220:223], 0
    s_add_u32 m0, s37, 8192
    s_nop 0
    buffer_load_dwordx4 v5, s[8:11], s42 offen lds
    v_mfma_f32_16x16x32_bf16 v[112:115], v[248:251], v[220:223], 0
    s_waitcnt lgkmcnt(0)
    s_cmp_lt_u32 s36, 6
    s_cbranch_scc0 SK_26
    ds_read_b128 v[172:175], v20 offset:0
    ds_read_b128 v[176:179], v21 offset:0
SK_26:
    s_cmp_lt_u32 s64, 1073741824
    s_cbranch_scc0 SK_27
    v_mfma_f32_16x16x32_bf16 v[160:163], v[212:215], v[156:159], 0
    v_mfma_f32_16x16x32_bf16 v[164:167], v[216:219], v[156:159], 0
    v_mfma_f32_16x16x32_bf16 v[168:171], v[220:223], v[156:159], 0
    v_mfma_f32_16x16x32_bf16 v[160:163], v[144:147], v[156:159], v[160:163]
    v_mfma_f32_16x16x32_bf16 v[164:167], v[148:151], v[156:159], v[164:167]
    v_mfma_f32_16x16x32_bf16 v[168:171], v[152:155], v[156:159], v[168:171]
SK_27:
    s_cmp_lt_u32 s36, 6
    s_cbranch_scc0 SK_28
    s_waitcnt lgkmcnt(0)
    v_mfma_f32_16x16x32_bf16 v[180:183], v[156:159], v[172:175], 0
    v_mfma_f32_16x16x32_bf16 v[184:187], v[172:175], v[172:175], 0
    v_mfma_f32_16x16x32_bf16 v[180:183], v[156:159], v[176:179], v[180:183]
    v_mfma_f32_16x16x32_bf16 v[184:187], v[176:179], v[176:179], v[184:187]
SK_28:
    s_barrier
    s_setprio 3
    v_mfma_f32_16x16x32_bf16 v[60:63], v[148:151], v[116:119], v[60:63]
    s_add_u32 m0, s37, 16384
    s_nop 0
    buffer_load_dwordx4 v6, s[8:11], s42 offen lds
    v_mfma_f32_16x16x32_bf16 v[64:67], v[148:151], v[120:123], v[64:67]
    s_mov_b32 m0, s61
    s_nop 0
    buffer_load_dwordx4 v16, s[8:11], s42 offen lds
    v_mfma_f32_16x16x32_bf16 v[68:71], v[148:151], v[124:127], v[68:71]
    s_add_u32 m0, s37, 26624
    s_add_u32 s38, s50, 0
    buffer_load_dwordx4 v7, s[12:15], s38 offen lds
    v_mfma_f32_16x16x32_bf16 v[72:75], v[148:151], v[128:131], v[72:75]
    s_add_u32 m0, s37, 34816
    s_add_u32 s38, s50, 1024
    buffer_load_dwordx4 v7, s[12:15], s38 offen lds
    v_mfma_f32_16x16x32_bf16 v[76:79], v[148:151], v[132:135], v[76:79]
    s_add_u32 m0, s37, 43008
    s_add_u32 s38, s50, 2048
    buffer_load_dwordx4 v7, s[12:15], s38 offen lds
    v_mfma_f32_16x16x32_bf16 v[80:83], v[148:151], v[136:139], v[80:83]
    s_lshl_b32 s98, s56, 10
    s_add_u32 s98, s98, 157696
    v_min_u32 v254, 47, v1
    v_lshl_add_u32 v28, v254, 2, s98
    v_mfma_f32_16x16x32_bf16 v[84:87], v[148:151], v[140:143], v[84:87]
    s_mul_i32 s97, s5, 12
    s_sub_u32 s97, s97, 1
    s_lshl_b32 s99, s77, 2
    s_add_u32 s99, s99, s97
    v_lshrrev_b32 v26, 4, v1
    v_add_u32 v254, s99, v26
    v_mfma_f32_16x16x32_bf16 v[36:39], v[144:147], v[120:123], v[36:39]
    v_cmp_gt_u32 vcc, 132, v254
    v_lshlrev_b32 v254, 9, v254
    s_mov_b64 s[100:101], vcc
    v_mfma_f32_16x16x32_bf16 v[40:43], v[144:147], v[124:127], v[40:43]
    v_and_b32 v2, 15, v1
    v_lshl_add_u32 v254, v2, 3, v254
    v_mfma_f32_16x16x32_bf16 v[44:47], v[144:147], v[128:131], v[44:47]
    s_setprio 2
    v_add_u32 v254, 32768, v254
    v_mov_b32 v3, 0x80000000
    v_mfma_f32_16x16x32_bf16 v[48:51], v[144:147], v[132:135], v[48:51]
    v_cndmask_b32 v254, v3, v254, s[100:101]
    v_cmp_gt_u32 vcc, 208, v0
    s_nop 0
    s_and_b64 s[100:101], s[100:101], vcc
    v_mfma_f32_16x16x32_bf16 v[52:55], v[144:147], v[136:139], v[52:55]
    s_cmp_ge_u32 s36, 4
    s_cselect_b64 vcc, -1, 0
    s_or_b64 s[100:101], s[100:101], vcc
    v_cndmask_b32 v28, v254, v28, vcc
    s_mul_i32 s98, s78, 384
    s_add_u32 s98, s98, 159744
    v_lshl_add_u32 v17, v26, 4, s98
    v_mfma_f32_16x16x32_bf16 v[56:59], v[144:147], v[140:143], v[56:59]
    v_and_b32 v254, 1, v26
    v_mul_u32_u24 v254, 74752, v254
    v_mfma_f32_16x16x32_bf16 v[88:91], v[116:119], v[152:155], v[88:91]
    v_lshrrev_b32 v26, 1, v26
    v_lshl_add_u32 v254, v26, 8, v254
    v_mfma_f32_16x16x32_bf16 v[92:95], v[120:123], v[152:155], v[92:95]
    s_and_b32 s98, s56, 1
    s_lshl_b32 s98, s98, 9
    v_lshl_add_u32 v254, v2, 4, v254
    v_add_u32 v3, s98, v254
    s_mov_b32 s96, s74
    s_add_u32 s96, s96, s97
    s_mul_i32 s96, s96, 73
    s_lshr_b32 s56, s56, 1
    s_add_u32 s56, s56, s96
    s_lshl_b32 s56, s56, 10
    v_mfma_f32_16x16x32_bf16 v[96:99], v[124:127], v[152:155], v[96:99]
    s_mov_b32 s68, 0x22222222
    s_mov_b32 s69, 0x22222222
    s_mov_b32 s70, 0x44444444
    s_mov_b32 s71, 0x44444444
    s_mov_b32 s72, 0x88888888
    s_mov_b32 s73, 0x88888888
    v_mov_b32 v254, 0x80000000
    v_cmp_gt_u32 vcc, 2, v1
    v_mfma_f32_16x16x32_bf16 v[100:103], v[128:131], v[152:155], v[100:103]
    s_add_u32 s20, s94, 1048576
    s_addc_u32 s21, s95, 0
    s_mov_b32 s22, 9568256
    s_mov_b32 s23, 0x20000
    v_lshlrev_b32 v2, 7, v1
    v_cndmask_b32 v27, v254, v2, vcc
    v_mfma_f32_16x16x32_bf16 v[104:107], v[132:135], v[152:155], v[104:107]
    s_add_u32 m0, s37, 77824
    s_add_u32 s38, s51, 0
    buffer_load_dwordx4 v7, s[12:15], s38 offen lds
    v_mfma_f32_16x16x32_bf16 v[108:111], v[136:139], v[152:155], v[108:111]
    s_add_u32 m0, s37, 86016
    s_add_u32 s38, s51, 1024
    buffer_load_dwordx4 v7, s[12:15], s38 offen lds
    v_mfma_f32_16x16x32_bf16 v[112:115], v[140:143], v[152:155], v[112:115]
    s_add_u32 m0, s37, 94208
    s_add_u32 s38, s51, 2048
    buffer_load_dwordx4 v7, s[12:15], s38 offen lds
    s_waitcnt vmcnt(10)
    s_barrier
    ds_read_b64_tr_b16 v[216:217], v11 offset:8192
    ds_read_b64_tr_b16 v[218:219], v11 offset:8704
    ds_read_b128 v[224:227], v18 offset:0
    ds_read_b128 v[228:231], v18 offset:2048
    ds_read_b128 v[232:235], v18 offset:4096
    ds_read_b128 v[236:239], v18 offset:6144
    ds_read_b128 v[240:243], v18 offset:8192
    ds_read_b128 v[244:247], v18 offset:10240
    ds_read_b128 v[248:251], v18 offset:12288
    ds_read_b64_tr_b16 v[212:213], v11 offset:0
    ds_read_b64_tr_b16 v[214:215], v11 offset:512
    ds_read_b64_tr_b16 v[220:221], v11 offset:16384
    ds_read_b64_tr_b16 v[222:223], v11 offset:16896
    s_waitcnt lgkmcnt(0)
    s_setprio 1
    v_mfma_f32_16x16x32_bf16 v[60:63], v[216:219], v[224:227], v[60:63]
    ds_read_b64_tr_b16 v[148:149], v11 offset:12288
    v_mfma_f32_16x16x32_bf16 v[64:67], v[216:219], v[228:231], v[64:67]
    ds_read_b64_tr_b16 v[150:151], v11 offset:12800
    s_add_u32 m0, s37, 51200
    s_nop 0
    buffer_load_dwordx4 v4, s[8:11], s43 offen lds
    v_mfma_f32_16x16x32_bf16 v[68:71], v[216:219], v[232:235], v[68:71]
    ds_read_b128 v[116:119], v19 offset:0
    s_add_u32 m0, s37, 59392
    s_nop 0
    buffer_load_dwordx4 v5, s[8:11], s43 offen lds
    v_mfma_f32_16x16x32_bf16 v[72:75], v[216:219], v[236:239], v[72:75]
    ds_read_b128 v[120:123], v19 offset:2048
    s_add_u32 m0, s37, 67584
    s_nop 0
    buffer_load_dwordx4 v6, s[8:11], s43 offen lds
    v_mfma_f32_16x16x32_bf16 v[76:79], v[216:219], v[240:243], v[76:79]
    ds_read_b128 v[124:127], v19 offset:4096
    s_mov_b32 m0, s59
    s_nop 0
    buffer_load_dwordx4 v16, s[8:11], s43 offen lds
    v_mfma_f32_16x16x32_bf16 v[80:83], v[216:219], v[244:247], v[80:83]
    ds_read_b128 v[128:131], v19 offset:6144
    s_mov_b32 s57, 0xbfb8aa3b
    s_and_b32 s96, s2, 7
    s_lshr_b32 s97, s2, 3
    s_and_b32 s98, s97, 3
    s_lshl_b32 s79, s96, 2
    s_add_u32 s79, s79, s98
    s_lshr_b32 s80, s97, 2
    v_lshlrev_b32 v29, 3, v0
    v_add_u32 v29, 155648, v29
    v_mfma_f32_16x16x32_bf16 v[84:87], v[216:219], v[248:251], v[84:87]
    ds_read_b128 v[132:135], v19 offset:8192
    s_lshl_b32 s75, s80, 1
    s_lshl_b32 s98, s98, 2
    s_add_u32 s75, s75, s98
    v_bfe_u32 v254, v1, 1, 2
    v_lshrrev_b32 v2, 4, v1
    v_mfma_f32_16x16x32_bf16 v[36:39], v[212:215], v[228:231], v[36:39]
    ds_read_b128 v[136:139], v19 offset:10240
    v_mfma_f32_16x16x32_bf16 v[40:43], v[212:215], v[232:235], v[40:43]
    ds_read_b128 v[140:143], v19 offset:12288
    v_xor_b32 v254, v254, v2
    v_lshlrev_b32 v254, 5, v254
    v_mfma_f32_16x16x32_bf16 v[44:47], v[212:215], v[236:239], v[44:47]
    s_setprio 0
    ds_read_b64_tr_b16 v[144:145], v11 offset:4096
    s_sub_u32 s98, s77, 1
    s_lshl_b32 s98, s98, 19
    s_add_u32 s98, s88, s98
    s_addc_u32 s99, s89, 0
    s_cmp_eq_u32 s77, 0
    s_cselect_b32 s32, s82, s98
    s_cselect_b32 s33, s83, s99
    s_mov_b32 s34, 0x80000
    s_mov_b32 s35, 0x20000
    v_and_b32 v2, 1, v1
    v_lshl_add_u32 v254, v2, 4, v254
    v_mfma_f32_16x16x32_bf16 v[48:51], v[212:215], v[240:243], v[48:51]
    ds_read_b64_tr_b16 v[146:147], v11 offset:4608
    s_lshl_b32 s76, s77, 12
    s_lshl_b32 s98, s78, 11
    s_add_u32 s76, s76, s98
    v_lshrrev_b32 v2, 3, v1
    v_and_b32 v26, 4, v2
    v_mfma_f32_16x16x32_bf16 v[52:55], v[212:215], v[244:247], v[52:55]
    ds_read_b64_tr_b16 v[152:153], v11 offset:20480
    s_cmp_eq_u32 s77, 0
    s_cselect_b64 vcc, -1, 0
    s_cselect_b32 s81, 2, 1
    s_cselect_b32 s99, 12, 14
    s_lshl_b32 s81, s81, 13
    v_add_u32 v26, v26, v2
    v_cndmask_b32 v2, v2, v26, vcc
    v_mfma_f32_16x16x32_bf16 v[56:59], v[212:215], v[248:251], v[56:59]
    ds_read_b64_tr_b16 v[154:155], v11 offset:20992
    s_lshl_b32 s98, s80, 7
    s_lshl_b32 s99, s78, s99
    v_lshl_add_u32 v254, v2, 10, v254
    v_add_u32 v35, s98, v254
    v_mfma_f32_16x16x32_bf16 v[88:91], v[224:227], v[220:223], v[88:91]
    v_mfma_f32_16x16x32_bf16 v[92:95], v[228:231], v[220:223], v[92:95]
    v_add_u32 v30, s99, v35
    s_lshl_b32 s98, s2, 3
    s_add_u32 s98, s98, s36
    s_mul_i32 s99, s98, 896
    s_lshl_b32 s98, s98, 8
    v_min_u32 v254, 6, v1
    v_mfma_f32_16x16x32_bf16 v[96:99], v[232:235], v[220:223], v[96:99]
    v_lshl_add_u32 v31, v254, 7, s99
    v_min_u32 v2, 1, v1
    v_mfma_f32_16x16x32_bf16 v[100:103], v[236:239], v[220:223], v[100:103]
    v_lshl_add_u32 v32, v2, 7, s98
    v_and_b32 v2, 15, v1
    v_mfma_f32_16x16x32_bf16 v[104:107], v[240:243], v[220:223], v[104:107]
    s_lshl_b32 s98, s74, 7
    s_add_u32 s98, s98, 155648
    v_lshl_add_u32 v14, v2, 3, s98
    v_mfma_f32_16x16x32_bf16 v[108:111], v[244:247], v[220:223], v[108:111]
    s_lshl_b32 s98, s77, 9
    s_add_u32 s98, s98, 157696
    v_lshl_add_u32 v15, v2, 3, s98
    v_mfma_f32_16x16x32_bf16 v[112:115], v[248:251], v[220:223], v[112:115]
    s_waitcnt lgkmcnt(0)
    s_cmp_lt_u32 s36, 6
    s_cbranch_scc0 SK_29
    ds_read_b128 v[172:175], v20 offset:51200
    ds_read_b128 v[176:179], v21 offset:51200
SK_29:
    s_cmp_lt_u32 s64, 1073741824
    s_cbranch_scc0 SK_30
    v_mfma_f32_16x16x32_bf16 v[160:163], v[212:215], v[156:159], v[160:163]
    v_mfma_f32_16x16x32_bf16 v[164:167], v[216:219], v[156:159], v[164:167]
    v_mfma_f32_16x16x32_bf16 v[168:171], v[220:223], v[156:159], v[168:171]
    v_mfma_f32_16x16x32_bf16 v[160:163], v[144:147], v[156:159], v[160:163]
    v_mfma_f32_16x16x32_bf16 v[164:167], v[148:151], v[156:159], v[164:167]
    v_mfma_f32_16x16x32_bf16 v[168:171], v[152:155], v[156:159], v[168:171]
SK_30:
    s_cmp_lt_u32 s36, 6
    s_cbranch_scc0 SK_31
    s_waitcnt lgkmcnt(0)
    v_mfma_f32_16x16x32_bf16 v[180:183], v[156:159], v[172:175], v[180:183]
    v_mfma_f32_16x16x32_bf16 v[184:187], v[172:175], v[172:175], v[184:187]
    v_mfma_f32_16x16x32_bf16 v[180:183], v[156:159], v[176:179], v[180:183]
    v_mfma_f32_16x16x32_bf16 v[184:187], v[176:179], v[176:179], v[184:187]
SK_31:
    s_waitcnt vmcnt(7)
    s_barrier
    s_setprio 3
    v_mfma_f32_16x16x32_bf16 v[60:63], v[148:151], v[116:119], v[60:63]
    ds_read_b64_tr_b16 v[216:217], v12 offset:8192
    v_mfma_f32_16x16x32_bf16 v[64:67], v[148:151], v[120:123], v[64:67]
    ds_read_b64_tr_b16 v[218:219], v12 offset:8704
    v_mfma_f32_16x16x32_bf16 v[68:71], v[148:151], v[124:127], v[68:71]
    ds_read_b128 v[224:227], v8 offset:0
    v_mfma_f32_16x16x32_bf16 v[72:75], v[148:151], v[128:131], v[72:75]
    ds_read_b128 v[228:231], v8 offset:2048
    v_mfma_f32_16x16x32_bf16 v[76:79], v[148:151], v[132:135], v[76:79]
    ds_read_b128 v[232:235], v8 offset:4096
    v_mfma_f32_16x16x32_bf16 v[80:83], v[148:151], v[136:139], v[80:83]
    ds_read_b128 v[236:239], v8 offset:6144
    v_mfma_f32_16x16x32_bf16 v[84:87], v[148:151], v[140:143], v[84:87]
    ds_read_b128 v[240:243], v8 offset:8192
    s_cmp_lt_u32 s36, 6
    s_cbranch_scc0 SK_32
    v_cndmask_b32 v184, v184, v185, s[68:69]
    v_cndmask_b32 v184, v184, v186, s[70:71]
    v_cndmask_b32 v184, v184, v187, s[72:73]
    v_or_b32 v180, 1, v180
    v_or_b32 v181, 1, v184
    buffer_store_dwordx2 v[180:181], v22, s[24:27], s62 offen sc1
SK_32:
    v_mfma_f32_16x16x32_bf16 v[36:39], v[144:147], v[120:123], v[36:39]
    ds_read_b128 v[244:247], v8 offset:10240
    v_mfma_f32_16x16x32_bf16 v[40:43], v[144:147], v[124:127], v[40:43]
    ds_read_b128 v[248:251], v8 offset:12288
    s_cmp_lt_u32 s64, 1073741824
    s_cbranch_scc0 SK_33
    v_or_b32 v160, 1, v160
    v_or_b32 v161, 1, v161
    v_or_b32 v162, 1, v162
    v_or_b32 v163, 1, v163
    buffer_store_dwordx4 v[160:163], v23, s[24:27], s64 offen offset:0 sc1
    v_or_b32 v164, 1, v164
    v_or_b32 v165, 1, v165
    v_or_b32 v166, 1, v166
    v_or_b32 v167, 1, v167
    buffer_store_dwordx4 v[164:167], v23, s[24:27], s64 offen offset:64 sc1
    v_or_b32 v168, 1, v168
    v_or_b32 v169, 1, v169
    v_or_b32 v170, 1, v170
    v_or_b32 v171, 1, v171
    buffer_store_dwordx4 v[168:171], v23, s[24:27], s64 offen offset:128 sc1
SK_33:
    v_mfma_f32_16x16x32_bf16 v[44:47], v[144:147], v[128:131], v[44:47]
    s_setprio 2
    ds_read_b64_tr_b16 v[212:213], v12 offset:0
    v_mfma_f32_16x16x32_bf16 v[48:51], v[144:147], v[132:135], v[48:51]
    ds_read_b64_tr_b16 v[214:215], v12 offset:512
    v_mfma_f32_16x16x32_bf16 v[52:55], v[144:147], v[136:139], v[52:55]
    ds_read_b64_tr_b16 v[220:221], v12 offset:16384
    s_add_u32 m0, s37, 129024
    s_add_u32 s38, s52, 0
    buffer_load_dwordx4 v7, s[12:15], s38 offen lds
    v_mfma_f32_16x16x32_bf16 v[56:59], v[144:147], v[140:143], v[56:59]
    ds_read_b64_tr_b16 v[222:223], v12 offset:16896
    v_mfma_f32_16x16x32_bf16 v[88:91], v[116:119], v[152:155], v[88:91]
    v_mfma_f32_16x16x32_bf16 v[92:95], v[120:123], v[152:155], v[92:95]
    s_add_u32 m0, s37, 137216
    s_add_u32 s38, s52, 1024
    buffer_load_dwordx4 v7, s[12:15], s38 offen lds
    v_mfma_f32_16x16x32_bf16 v[96:99], v[124:127], v[152:155], v[96:99]
    v_mfma_f32_16x16x32_bf16 v[100:103], v[128:131], v[152:155], v[100:103]
    v_mfma_f32_16x16x32_bf16 v[104:107], v[132:135], v[152:155], v[104:107]
    s_add_u32 m0, s37, 145408
    s_add_u32 s38, s52, 2048
    buffer_load_dwordx4 v7, s[12:15], s38 offen lds
    v_mfma_f32_16x16x32_bf16 v[108:111], v[136:139], v[152:155], v[108:111]
    v_mfma_f32_16x16x32_bf16 v[112:115], v[140:143], v[152:155], v[112:115]
    s_waitcnt lgkmcnt(0)
    s_setprio 1
    v_mfma_f32_16x16x32_bf16 v[60:63], v[216:219], v[224:227], v[60:63]
    s_cmp_eq_u32 s36, 0
    s_cbranch_scc0 SK_34
    buffer_load_dword v26, v27, s[28:31], 0 offen sc1
SK_34:
    ds_read_b64_tr_b16 v[148:149], v12 offset:12288
    v_mfma_f32_16x16x32_bf16 v[64:67], v[216:219], v[228:231], v[64:67]
    ds_read_b64_tr_b16 v[150:151], v12 offset:12800
    s_add_u32 m0, s37, 102400
    s_nop 0
    buffer_load_dwordx4 v4, s[8:11], s44 offen lds
    v_mfma_f32_16x16x32_bf16 v[68:71], v[216:219], v[232:235], v[68:71]
    ds_read_b128 v[116:119], v9 offset:0
    v_mfma_f32_16x16x32_bf16 v[72:75], v[216:219], v[236:239], v[72:75]
    ds_read_b128 v[120:123], v9 offset:2048
    v_mfma_f32_16x16x32_bf16 v[76:79], v[216:219], v[240:243], v[76:79]
    ds_read_b128 v[124:127], v9 offset:4096
    s_add_u32 m0, s37, 110592
    s_nop 0
    buffer_load_dwordx4 v5, s[8:11], s44 offen lds
    v_mfma_f32_16x16x32_bf16 v[80:83], v[216:219], v[244:247], v[80:83]
    ds_read_b128 v[128:131], v9 offset:6144
    v_mfma_f32_16x16x32_bf16 v[84:87], v[216:219], v[248:251], v[84:87]
    ds_read_b128 v[132:135], v9 offset:8192
    v_mfma_f32_16x16x32_bf16 v[36:39], v[212:215], v[228:231], v[36:39]
    ds_read_b128 v[136:139], v9 offset:10240
    v_mfma_f32_16x16x32_bf16 v[40:43], v[212:215], v[232:235], v[40:43]
    ds_read_b128 v[140:143], v9 offset:12288
    s_add_u32 m0, s37, 118784
    s_nop 0
    buffer_load_dwordx4 v6, s[8:11], s44 offen lds
    v_mfma_f32_16x16x32_bf16 v[44:47], v[212:215], v[236:239], v[44:47]
    s_setprio 0
    ds_read_b64_tr_b16 v[144:145], v12 offset:4096
    v_mfma_f32_16x16x32_bf16 v[48:51], v[212:215], v[240:243], v[48:51]
    ds_read_b64_tr_b16 v[146:147], v12 offset:4608
    v_mfma_f32_16x16x32_bf16 v[52:55], v[212:215], v[244:247], v[52:55]
    ds_read_b64_tr_b16 v[152:153], v12 offset:20480
    s_mov_b32 m0, s60
    s_nop 0
    buffer_load_dwordx4 v16, s[8:11], s44 offen lds
    v_mfma_f32_16x16x32_bf16 v[56:59], v[212:215], v[248:251], v[56:59]
    ds_read_b64_tr_b16 v[154:155], v12 offset:20992
    v_mfma_f32_16x16x32_bf16 v[88:91], v[224:227], v[220:223], v[88:91]
    v_mfma_f32_16x16x32_bf16 v[92:95], v[228:231], v[220:223], v[92:95]
    v_mfma_f32_16x16x32_bf16 v[96:99], v[232:235], v[220:223], v[96:99]
    v_mfma_f32_16x16x32_bf16 v[100:103], v[236:239], v[220:223], v[100:103]
    v_mfma_f32_16x16x32_bf16 v[104:107], v[240:243], v[220:223], v[104:107]
    v_mfma_f32_16x16x32_bf16 v[108:111], v[244:247], v[220:223], v[108:111]
    v_mfma_f32_16x16x32_bf16 v[112:115], v[248:251], v[220:223], v[112:115]
    s_waitcnt lgkmcnt(0)
    s_waitcnt vmcnt(7)
    s_barrier
    s_setprio 3
    v_mfma_f32_16x16x32_bf16 v[60:63], v[148:151], v[116:119], v[60:63]
    ds_read_b64_tr_b16 v[216:217], v10 offset:8192
    s_add_u32 m0, s37, 26624
    s_add_u32 s38, s53, 0
    buffer_load_dwordx4 v7, s[12:15], s38 offen lds
    v_mfma_f32_16x16x32_bf16 v[64:67], v[148:151], v[120:123], v[64:67]
    ds_read_b64_tr_b16 v[218:219], v10 offset:8704
    v_mfma_f32_16x16x32_bf16 v[68:71], v[148:151], v[124:127], v[68:71]
    ds_read_b128 v[224:227], v8 offset:51200
    v_mfma_f32_16x16x32_bf16 v[72:75], v[148:151], v[128:131], v[72:75]
    ds_read_b128 v[228:231], v8 offset:53248
    v_mfma_f32_16x16x32_bf16 v[76:79], v[148:151], v[132:135], v[76:79]
    ds_read_b128 v[232:235], v8 offset:55296
    v_mfma_f32_16x16x32_bf16 v[80:83], v[148:151], v[136:139], v[80:83]
    ds_read_b128 v[236:239], v8 offset:57344
    v_mfma_f32_16x16x32_bf16 v[84:87], v[148:151], v[140:143], v[84:87]
    ds_read_b128 v[240:243], v8 offset:59392
    s_add_u32 m0, s37, 34816
    s_add_u32 s38, s53, 1024
    buffer_load_dwordx4 v7, s[12:15], s38 offen lds
    v_mfma_f32_16x16x32_bf16 v[36:39], v[144:147], v[120:123], v[36:39]
    ds_read_b128 v[244:247], v8 offset:61440
    v_mfma_f32_16x16x32_bf16 v[40:43], v[144:147], v[124:127], v[40:43]
    ds_read_b128 v[248:251], v8 offset:63488
    v_mfma_f32_16x16x32_bf16 v[44:47], v[144:147], v[128:131], v[44:47]
    s_setprio 2
    ds_read_b64_tr_b16 v[212:213], v10 offset:0
    v_mfma_f32_16x16x32_bf16 v[48:51], v[144:147], v[132:135], v[48:51]
    global_load_dword v33, v31, s[88:89]
    global_load_dword v34, v32, s[82:83]
    ds_read_b64_tr_b16 v[214:215], v10 offset:512
    v_mfma_f32_16x16x32_bf16 v[52:55], v[144:147], v[136:139], v[52:55]
    ds_read_b64_tr_b16 v[220:221], v10 offset:16384
    v_mfma_f32_16x16x32_bf16 v[56:59], v[144:147], v[140:143], v[56:59]
    ds_read_b64_tr_b16 v[222:223], v10 offset:16896
    v_mfma_f32_16x16x32_bf16 v[88:91], v[116:119], v[152:155], v[88:91]
    s_add_u32 m0, s37, 43008
    s_add_u32 s38, s53, 2048
    buffer_load_dwordx4 v7, s[12:15], s38 offen lds
    v_mfma_f32_16x16x32_bf16 v[92:95], v[120:123], v[152:155], v[92:95]
    v_mfma_f32_16x16x32_bf16 v[96:99], v[124:127], v[152:155], v[96:99]
    v_mfma_f32_16x16x32_bf16 v[100:103], v[128:131], v[152:155], v[100:103]
    v_mfma_f32_16x16x32_bf16 v[104:107], v[132:135], v[152:155], v[104:107]
    v_mfma_f32_16x16x32_bf16 v[108:111], v[136:139], v[152:155], v[108:111]
    v_mfma_f32_16x16x32_bf16 v[112:115], v[140:143], v[152:155], v[112:115]
    s_waitcnt lgkmcnt(0)
    s_setprio 1
    v_mfma_f32_16x16x32_bf16 v[60:63], v[216:219], v[224:227], v[60:63]
    ds_read_b64_tr_b16 v[148:149], v10 offset:12288
    v_mfma_f32_16x16x32_bf16 v[64:67], v[216:219], v[228:231], v[64:67]
    ds_read_b64_tr_b16 v[150:151], v10 offset:12800
    s_add_u32 m0, s37, 0
    s_nop 0
    buffer_load_dwordx4 v4, s[8:11], s45 offen lds
    v_mfma_f32_16x16x32_bf16 v[68:71], v[216:219], v[232:235], v[68:71]
    ds_read_b128 v[116:119], v9 offset:51200
    v_mfma_f32_16x16x32_bf16 v[72:75], v[216:219], v[236:239], v[72:75]
    ds_read_b128 v[120:123], v9 offset:53248
    v_mfma_f32_16x16x32_bf16 v[76:79], v[216:219], v[240:243], v[76:79]
    ds_read_b128 v[124:127], v9 offset:55296
    s_add_u32 m0, s37, 8192
    s_nop 0
    buffer_load_dwordx4 v5, s[8:11], s45 offen lds
    v_mfma_f32_16x16x32_bf16 v[80:83], v[216:219], v[244:247], v[80:83]
    ds_read_b128 v[128:131], v9 offset:57344
    v_mfma_f32_16x16x32_bf16 v[84:87], v[216:219], v[248:251], v[84:87]
    ds_read_b128 v[132:135], v9 offset:59392
    v_mfma_f32_16x16x32_bf16 v[36:39], v[212:215], v[228:231], v[36:39]
    ds_read_b128 v[136:139], v9 offset:61440
    v_mfma_f32_16x16x32_bf16 v[40:43], v[212:215], v[232:235], v[40:43]
    ds_read_b128 v[140:143], v9 offset:63488
    s_add_u32 m0, s37, 16384
    s_nop 0
    buffer_load_dwordx4 v6, s[8:11], s45 offen lds
    v_mfma_f32_16x16x32_bf16 v[44:47], v[212:215], v[236:239], v[44:47]
    s_setprio 0
    ds_read_b64_tr_b16 v[144:145], v10 offset:4096
    v_mfma_f32_16x16x32_bf16 v[48:51], v[212:215], v[240:243], v[48:51]
    ds_read_b64_tr_b16 v[146:147], v10 offset:4608
    v_mfma_f32_16x16x32_bf16 v[52:55], v[212:215], v[244:247], v[52:55]
    ds_read_b64_tr_b16 v[152:153], v10 offset:20480
    s_mov_b32 m0, s61
    s_nop 0
    buffer_load_dwordx4 v16, s[8:11], s45 offen lds
    v_mfma_f32_16x16x32_bf16 v[56:59], v[212:215], v[248:251], v[56:59]
    ds_read_b64_tr_b16 v[154:155], v10 offset:20992
    v_mfma_f32_16x16x32_bf16 v[88:91], v[224:227], v[220:223], v[88:91]
    v_mfma_f32_16x16x32_bf16 v[92:95], v[228:231], v[220:223], v[92:95]
    v_mfma_f32_16x16x32_bf16 v[96:99], v[232:235], v[220:223], v[96:99]
    v_mfma_f32_16x16x32_bf16 v[100:103], v[236:239], v[220:223], v[100:103]
    v_mfma_f32_16x16x32_bf16 v[104:107], v[240:243], v[220:223], v[104:107]
    v_mfma_f32_16x16x32_bf16 v[108:111], v[244:247], v[220:223], v[108:111]
    v_mfma_f32_16x16x32_bf16 v[112:115], v[248:251], v[220:223], v[112:115]
    s_waitcnt lgkmcnt(0)
    s_waitcnt vmcnt(9)
    s_cmp_eq_u32 s36, 0
    s_cbranch_scc0 PA_ok_35
    s_waitcnt vmcnt(13)
    v_readlane_b32 s96, v26, 0
    v_readlane_b32 s97, v26, 1
    s_nop 0
    s_add_u32 s96, s96, s97
    s_cmp_ge_u32 s96, 256
    s_cbranch_scc1 PA_ok_35
    s_mov_b32 s98, 0
PA_spin_36:
    s_sleep 2
    buffer_load_dword v26, v27, s[28:31], 0 offen sc1
    s_waitcnt vmcnt(0)
    v_readlane_b32 s96, v26, 0
    v_readlane_b32 s97, v26, 1
    s_nop 0
    s_add_u32 s96, s96, s97
    s_add_u32 s98, s98, 1
    s_cmp_ge_u32 s98, 100000
    s_cbranch_scc1 PA_ok_35
    s_cmp_lt_u32 s96, 256
    s_cbranch_scc1 PA_spin_36
PA_ok_35:
    s_barrier
    s_setprio 3
    v_mfma_f32_16x16x32_bf16 v[60:63], v[148:151], v[116:119], v[60:63]
    ds_read_b64_tr_b16 v[216:217], v11 offset:8192
    v_mfma_f32_16x16x32_bf16 v[64:67], v[148:151], v[120:123], v[64:67]
    ds_read_b64_tr_b16 v[218:219], v11 offset:8704
    v_mfma_f32_16x16x32_bf16 v[68:71], v[148:151], v[124:127], v[68:71]
    ds_read_b128 v[224:227], v18 offset:0
    buffer_load_dwordx2 v[156:157], v28, s[24:27], 0 offen offset:0 sc1
    v_mfma_f32_16x16x32_bf16 v[72:75], v[148:151], v[128:131], v[72:75]
    ds_read_b128 v[228:231], v18 offset:2048
    v_mfma_f32_16x16x32_bf16 v[76:79], v[148:151], v[132:135], v[76:79]
    ds_read_b128 v[232:235], v18 offset:4096
    v_mfma_f32_16x16x32_bf16 v[80:83], v[148:151], v[136:139], v[80:83]
    ds_read_b128 v[236:239], v18 offset:6144
    buffer_load_dwordx2 v[158:159], v28, s[24:27], 0 offen offset:128 sc1
    v_mfma_f32_16x16x32_bf16 v[84:87], v[148:151], v[140:143], v[84:87]
    ds_read_b128 v[240:243], v18 offset:8192
    v_mfma_f32_16x16x32_bf16 v[36:39], v[144:147], v[120:123], v[36:39]
    ds_read_b128 v[244:247], v18 offset:10240
    v_mfma_f32_16x16x32_bf16 v[40:43], v[144:147], v[124:127], v[40:43]
    ds_read_b128 v[248:251], v18 offset:12288
    v_mfma_f32_16x16x32_bf16 v[44:47], v[144:147], v[128:131], v[44:47]
    s_setprio 2
    ds_read_b64_tr_b16 v[212:213], v11 offset:0
    s_add_u32 m0, s37, 77824
    s_add_u32 s38, s54, 0
    buffer_load_dwordx4 v7, s[12:15], s38 offen lds
    v_mfma_f32_16x16x32_bf16 v[48:51], v[144:147], v[132:135], v[48:51]
    ds_read_b64_tr_b16 v[214:215], v11 offset:512
    v_mfma_f32_16x16x32_bf16 v[52:55], v[144:147], v[136:139], v[52:55]
    ds_read_b64_tr_b16 v[220:221], v11 offset:16384
    v_mfma_f32_16x16x32_bf16 v[56:59], v[144:147], v[140:143], v[56:59]
    ds_read_b64_tr_b16 v[222:223], v11 offset:16896
    s_add_u32 m0, s37, 86016
    s_add_u32 s38, s54, 1024
    buffer_load_dwordx4 v7, s[12:15], s38 offen lds
    v_mfma_f32_16x16x32_bf16 v[88:91], v[116:119], v[152:155], v[88:91]
    v_mfma_f32_16x16x32_bf16 v[92:95], v[120:123], v[152:155], v[92:95]
    v_mfma_f32_16x16x32_bf16 v[96:99], v[124:127], v[152:155], v[96:99]
    v_mfma_f32_16x16x32_bf16 v[100:103], v[128:131], v[152:155], v[100:103]
    s_add_u32 m0, s37, 94208
    s_add_u32 s38, s54, 2048
    buffer_load_dwordx4 v7, s[12:15], s38 offen lds
    v_mfma_f32_16x16x32_bf16 v[104:107], v[132:135], v[152:155], v[104:107]
    v_mfma_f32_16x16x32_bf16 v[108:111], v[136:139], v[152:155], v[108:111]
    v_mfma_f32_16x16x32_bf16 v[112:115], v[140:143], v[152:155], v[112:115]
    s_waitcnt lgkmcnt(0)
    s_setprio 1
    v_mfma_f32_16x16x32_bf16 v[60:63], v[216:219], v[224:227], v[60:63]
    buffer_load_dwordx2 v[160:161], v28, s[24:27], 0 offen offset:256 sc1
    ds_read_b64_tr_b16 v[148:149], v11 offset:12288
    v_mfma_f32_16x16x32_bf16 v[64:67], v[216:219], v[228:231], v[64:67]
    ds_read_b64_tr_b16 v[150:151], v11 offset:12800
    s_add_u32 m0, s37, 51200
    s_nop 0
    buffer_load_dwordx4 v4, s[8:11], s46 offen lds
    v_mfma_f32_16x16x32_bf16 v[68:71], v[216:219], v[232:235], v[68:71]
    ds_read_b128 v[116:119], v19 offset:0
    v_mfma_f32_16x16x32_bf16 v[72:75], v[216:219], v[236:239], v[72:75]
    ds_read_b128 v[120:123], v19 offset:2048
    v_mfma_f32_16x16x32_bf16 v[76:79], v[216:219], v[240:243], v[76:79]
    ds_read_b128 v[124:127], v19 offset:4096
    s_add_u32 m0, s37, 59392
    s_nop 0
    buffer_load_dwordx4 v5, s[8:11], s46 offen lds
    v_mfma_f32_16x16x32_bf16 v[80:83], v[216:219], v[244:247], v[80:83]
    ds_read_b128 v[128:131], v19 offset:6144
    v_mfma_f32_16x16x32_bf16 v[84:87], v[216:219], v[248:251], v[84:87]
    ds_read_b128 v[132:135], v19 offset:8192
    v_mfma_f32_16x16x32_bf16 v[36:39], v[212:215], v[228:231], v[36:39]
    ds_read_b128 v[136:139], v19 offset:10240
    v_mfma_f32_16x16x32_bf16 v[40:43], v[212:215], v[232:235], v[40:43]
    ds_read_b128 v[140:143], v19 offset:12288
    s_add_u32 m0, s37, 67584
    s_nop 0
    buffer_load_dwordx4 v6, s[8:11], s46 offen lds
    v_mfma_f32_16x16x32_bf16 v[44:47], v[212:215], v[236:239], v[44:47]
    s_setprio 0
    ds_read_b64_tr_b16 v[144:145], v11 offset:4096
    v_mfma_f32_16x16x32_bf16 v[48:51], v[212:215], v[240:243], v[48:51]
    ds_read_b64_tr_b16 v[146:147], v11 offset:4608
    v_mfma_f32_16x16x32_bf16 v[52:55], v[212:215], v[244:247], v[52:55]
    ds_read_b64_tr_b16 v[152:153], v11 offset:20480
    s_mov_b32 m0, s59
    s_nop 0
    buffer_load_dwordx4 v16, s[8:11], s46 offen lds
    v_mfma_f32_16x16x32_bf16 v[56:59], v[212:215], v[248:251], v[56:59]
    ds_read_b64_tr_b16 v[154:155], v11 offset:20992
    v_mfma_f32_16x16x32_bf16 v[88:91], v[224:227], v[220:223], v[88:91]
    v_mfma_f32_16x16x32_bf16 v[92:95], v[228:231], v[220:223], v[92:95]
    buffer_load_dwordx2 v[162:163], v28, s[24:27], 0 offen offset:384 sc1
    v_mfma_f32_16x16x32_bf16 v[96:99], v[232:235], v[220:223], v[96:99]
    v_mfma_f32_16x16x32_bf16 v[100:103], v[236:239], v[220:223], v[100:103]
    v_mfma_f32_16x16x32_bf16 v[104:107], v[240:243], v[220:223], v[104:107]
    v_mfma_f32_16x16x32_bf16 v[108:111], v[244:247], v[220:223], v[108:111]
    v_mfma_f32_16x16x32_bf16 v[112:115], v[248:251], v[220:223], v[112:115]
    s_waitcnt lgkmcnt(0)
    s_waitcnt vmcnt(11)
    s_barrier
    s_setprio 3
    v_mfma_f32_16x16x32_bf16 v[60:63], v[148:151], v[116:119], v[60:63]
    ds_read_b64_tr_b16 v[216:217], v12 offset:8192
    s_add_u32 m0, s37, 129024
    s_add_u32 s38, s55, 0
    buffer_load_dwordx4 v7, s[12:15], s38 offen lds
    v_mfma_f32_16x16x32_bf16 v[64:67], v[148:151], v[120:123], v[64:67]
    ds_read_b64_tr_b16 v[218:219], v12 offset:8704
    v_mfma_f32_16x16x32_bf16 v[68:71], v[148:151], v[124:127], v[68:71]
    ds_read_b128 v[224:227], v8 offset:0
    v_mfma_f32_16x16x32_bf16 v[72:75], v[148:151], v[128:131], v[72:75]
    ds_read_b128 v[228:231], v8 offset:2048
    v_mfma_f32_16x16x32_bf16 v[76:79], v[148:151], v[132:135], v[76:79]
    ds_read_b128 v[232:235], v8 offset:4096
    v_mfma_f32_16x16x32_bf16 v[80:83], v[148:151], v[136:139], v[80:83]
    ds_read_b128 v[236:239], v8 offset:6144
    v_mfma_f32_16x16x32_bf16 v[84:87], v[148:151], v[140:143], v[84:87]
    ds_read_b128 v[240:243], v8 offset:8192
    s_add_u32 m0, s37, 137216
    s_add_u32 s38, s55, 1024
    buffer_load_dwordx4 v7, s[12:15], s38 offen lds
    v_mfma_f32_16x16x32_bf16 v[36:39], v[144:147], v[120:123], v[36:39]
    ds_read_b128 v[244:247], v8 offset:10240
    v_mfma_f32_16x16x32_bf16 v[40:43], v[144:147], v[124:127], v[40:43]
    ds_read_b128 v[248:251], v8 offset:12288
    v_mfma_f32_16x16x32_bf16 v[44:47], v[144:147], v[128:131], v[44:47]
    s_setprio 2
    ds_read_b64_tr_b16 v[212:213], v12 offset:0
    v_mfma_f32_16x16x32_bf16 v[48:51], v[144:147], v[132:135], v[48:51]
    ds_read_b64_tr_b16 v[214:215], v12 offset:512
    v_mfma_f32_16x16x32_bf16 v[52:55], v[144:147], v[136:139], v[52:55]
    ds_read_b64_tr_b16 v[220:221], v12 offset:16384
    v_mfma_f32_16x16x32_bf16 v[56:59], v[144:147], v[140:143], v[56:59]
    ds_read_b64_tr_b16 v[222:223], v12 offset:16896
    v_mfma_f32_16x16x32_bf16 v[88:91], v[116:119], v[152:155], v[88:91]
    s_add_u32 m0, s37, 145408
    s_add_u32 s38, s55, 2048
    buffer_load_dwordx4 v7, s[12:15], s38 offen lds
    v_mfma_f32_16x16x32_bf16 v[92:95], v[120:123], v[152:155], v[92:95]
    v_mfma_f32_16x16x32_bf16 v[96:99], v[124:127], v[152:155], v[96:99]
    v_mfma_f32_16x16x32_bf16 v[100:103], v[128:131], v[152:155], v[100:103]
    v_mfma_f32_16x16x32_bf16 v[104:107], v[132:135], v[152:155], v[104:107]
    v_mfma_f32_16x16x32_bf16 v[108:111], v[136:139], v[152:155], v[108:111]
    v_mfma_f32_16x16x32_bf16 v[112:115], v[140:143], v[152:155], v[112:115]
    s_waitcnt lgkmcnt(0)
    s_setprio 1
    v_mfma_f32_16x16x32_bf16 v[60:63], v[216:219], v[224:227], v[60:63]
    ds_read_b64_tr_b16 v[148:149], v12 offset:12288
    v_mfma_f32_16x16x32_bf16 v[64:67], v[216:219], v[228:231], v[64:67]
    ds_read_b64_tr_b16 v[150:151], v12 offset:12800
    s_add_u32 m0, s37, 102400
    s_nop 0
    buffer_load_dwordx4 v4, s[8:11], s47 offen lds
    v_mfma_f32_16x16x32_bf16 v[68:71], v[216:219], v[232:235], v[68:71]
    ds_read_b128 v[116:119], v9 offset:0
    v_mfma_f32_16x16x32_bf16 v[72:75], v[216:219], v[236:239], v[72:75]
    ds_read_b128 v[120:123], v9 offset:2048
    v_mfma_f32_16x16x32_bf16 v[76:79], v[216:219], v[240:243], v[76:79]
    ds_read_b128 v[124:127], v9 offset:4096
    s_add_u32 m0, s37, 110592
    s_nop 0
    buffer_load_dwordx4 v5, s[8:11], s47 offen lds
    v_mfma_f32_16x16x32_bf16 v[80:83], v[216:219], v[244:247], v[80:83]
    ds_read_b128 v[128:131], v9 offset:6144
    v_mfma_f32_16x16x32_bf16 v[84:87], v[216:219], v[248:251], v[84:87]
    ds_read_b128 v[132:135], v9 offset:8192
    v_mfma_f32_16x16x32_bf16 v[36:39], v[212:215], v[228:231], v[36:39]
    ds_read_b128 v[136:139], v9 offset:10240
    v_mfma_f32_16x16x32_bf16 v[40:43], v[212:215], v[232:235], v[40:43]
    ds_read_b128 v[140:143], v9 offset:12288
    s_add_u32 m0, s37, 118784
    s_nop 0
    buffer_load_dwordx4 v6, s[8:11], s47 offen lds
    v_mfma_f32_16x16x32_bf16 v[44:47], v[212:215], v[236:239], v[44:47]
    s_setprio 0
    ds_read_b64_tr_b16 v[144:145], v12 offset:4096
    v_mfma_f32_16x16x32_bf16 v[48:51], v[212:215], v[240:243], v[48:51]
    ds_read_b64_tr_b16 v[146:147], v12 offset:4608
    v_mfma_f32_16x16x32_bf16 v[52:55], v[212:215], v[244:247], v[52:55]
    ds_read_b64_tr_b16 v[152:153], v12 offset:20480
    s_mov_b32 m0, s60
    s_nop 0
    buffer_load_dwordx4 v16, s[8:11], s47 offen lds
    v_mfma_f32_16x16x32_bf16 v[56:59], v[212:215], v[248:251], v[56:59]
    ds_read_b64_tr_b16 v[154:155], v12 offset:20992
    v_mfma_f32_16x16x32_bf16 v[88:91], v[224:227], v[220:223], v[88:91]
    v_mfma_f32_16x16x32_bf16 v[92:95], v[228:231], v[220:223], v[92:95]
    v_mfma_f32_16x16x32_bf16 v[96:99], v[232:235], v[220:223], v[96:99]
    v_mfma_f32_16x16x32_bf16 v[100:103], v[236:239], v[220:223], v[100:103]
    v_mfma_f32_16x16x32_bf16 v[104:107], v[240:243], v[220:223], v[104:107]
    v_mfma_f32_16x16x32_bf16 v[108:111], v[244:247], v[220:223], v[108:111]
    v_mfma_f32_16x16x32_bf16 v[112:115], v[248:251], v[220:223], v[112:115]
    s_waitcnt lgkmcnt(0)
    s_waitcnt vmcnt(7)
    s_mov_b32 s98, 0
PC_chk_38:
    v_and_b32 v172, v156, v157
    v_and_b32 v173, v158, v159
    v_and_b32 v172, v172, v173
    v_and_b32 v173, v160, v161
    v_and_b32 v172, v172, v173
    v_and_b32 v173, v162, v163
    v_and_b32 v172, v172, v173
    v_and_b32 v172, 1, v172
    v_cmp_eq_u32 vcc, 0, v172
    s_nop 0
    s_and_b64 vcc, vcc, s[100:101]
    s_cbranch_scc0 PC_ok_37
    s_add_u32 s98, s98, 1
    s_cmp_ge_u32 s98, 100000
    s_cbranch_scc1 PC_ok_37
    s_sleep 2
    buffer_load_dwordx2 v[156:157], v28, s[24:27], 0 offen offset:0 sc1
    buffer_load_dwordx2 v[158:159], v28, s[24:27], 0 offen offset:128 sc1
    buffer_load_dwordx2 v[160:161], v28, s[24:27], 0 offen offset:256 sc1
    buffer_load_dwordx2 v[162:163], v28, s[24:27], 0 offen offset:384 sc1
    s_waitcnt vmcnt(0)
    s_branch PC_chk_38
PC_ok_37:
    s_barrier
    s_setprio 3
    v_mfma_f32_16x16x32_bf16 v[60:63], v[148:151], v[116:119], v[60:63]
    s_add_u32 m0, s76, 0
    s_add_u32 s85, s75, 0
    s_and_b32 s85, s85, 15
    s_lshl_b32 s85, s85, 15
    buffer_load_dwordx4 v30, s[32:35], s85 offen lds
    ds_read_b64_tr_b16 v[216:217], v10 offset:8192
    v_mfma_f32_16x16x32_bf16 v[64:67], v[148:151], v[120:123], v[64:67]
    s_add_u32 m0, s76, 1024
    s_add_u32 s85, s85, s81
    buffer_load_dwordx4 v30, s[32:35], s85 offen lds
    ds_read_b64_tr_b16 v[218:219], v10 offset:8704
    v_mfma_f32_16x16x32_bf16 v[68:71], v[148:151], v[124:127], v[68:71]
    ds_read_b128 v[224:227], v8 offset:51200
    v_add_f32 v156, v156, v158
    v_add_f32 v157, v157, v159
    v_mfma_f32_16x16x32_bf16 v[72:75], v[148:151], v[128:131], v[72:75]
    ds_read_b128 v[228:231], v8 offset:53248
    v_add_f32 v156, v156, v160
    v_add_f32 v157, v157, v161
    v_mfma_f32_16x16x32_bf16 v[76:79], v[148:151], v[132:135], v[76:79]
    ds_read_b128 v[232:235], v8 offset:55296
    v_add_f32 v156, v156, v162
    v_add_f32 v157, v157, v163
    v_mfma_f32_16x16x32_bf16 v[80:83], v[148:151], v[136:139], v[80:83]
    ds_read_b128 v[236:239], v8 offset:57344
    v_mul_f32 v156, 0xbb000000, v156
    v_mul_f32 v157, 0x3b000000, v157
    v_mfma_f32_16x16x32_bf16 v[84:87], v[148:151], v[140:143], v[84:87]
    ds_read_b128 v[240:243], v8 offset:59392
    v_fma_f32 v157, -v156, v156, v157
    v_max_f32 v157, 0, v157
    v_mfma_f32_16x16x32_bf16 v[36:39], v[144:147], v[120:123], v[36:39]
    ds_read_b128 v[244:247], v8 offset:61440
    v_mfma_f32_16x16x32_bf16 v[40:43], v[144:147], v[124:127], v[40:43]
    ds_read_b128 v[248:251], v8 offset:63488
    v_cvt_pk_bf16_f32 v157, v157, v157
    v_lshlrev_b32 v157, 16, v157
    v_mfma_f32_16x16x32_bf16 v[44:47], v[144:147], v[128:131], v[44:47]
    s_setprio 2
    ds_read_b64_tr_b16 v[212:213], v10 offset:0
    v_add_f32 v157, 0x3727c5ac, v157
    v_cvt_pk_bf16_f32 v156, v156, v156
    v_mfma_f32_16x16x32_bf16 v[48:51], v[144:147], v[132:135], v[48:51]
    ds_read_b64_tr_b16 v[214:215], v10 offset:512
    v_cvt_pk_bf16_f32 v157, v157, v157
    v_lshlrev_b32 v157, 16, v157
    v_mfma_f32_16x16x32_bf16 v[52:55], v[144:147], v[136:139], v[52:55]
    ds_read_b64_tr_b16 v[220:221], v10 offset:16384
    v_sqrt_f32 v157, v157
    v_mfma_f32_16x16x32_bf16 v[56:59], v[144:147], v[140:143], v[56:59]
    ds_read_b64_tr_b16 v[222:223], v10 offset:16896
    v_cvt_pk_bf16_f32 v157, v157, v157
    v_lshlrev_b32 v157, 16, v157
    v_mfma_f32_16x16x32_bf16 v[88:91], v[116:119], v[152:155], v[88:91]
    v_mfma_f32_16x16x32_bf16 v[92:95], v[120:123], v[152:155], v[92:95]
    v_and_b32 v156, 0xffff, v156
    v_or_b32 v156, v156, v157
    v_mfma_f32_16x16x32_bf16 v[96:99], v[124:127], v[152:155], v[96:99]
    v_rcp_f32 v157, v157
    v_mfma_f32_16x16x32_bf16 v[100:103], v[128:131], v[152:155], v[100:103]
    ds_write_b64 v29, v[156:157]
    v_mfma_f32_16x16x32_bf16 v[104:107], v[132:135], v[152:155], v[104:107]
    v_lshrrev_b32 v158, 1, v29
    v_add_u32 v158, 81920, v158
    ds_write_b32 v158, v157
    v_mfma_f32_16x16x32_bf16 v[108:111], v[136:139], v[152:155], v[108:111]
    s_add_u32 m0, s76, 16384
    s_add_u32 s85, s75, 1
    s_and_b32 s85, s85, 15
    s_lshl_b32 s85, s85, 15
    buffer_load_dwordx4 v30, s[32:35], s85 offen lds
    v_mfma_f32_16x16x32_bf16 v[112:115], v[140:143], v[152:155], v[112:115]
    s_waitcnt lgkmcnt(0)
    s_setprio 1
    v_mfma_f32_16x16x32_bf16 v[60:63], v[216:219], v[224:227], v[60:63]
    s_add_u32 m0, s76, 17408
    s_add_u32 s85, s85, s81
    buffer_load_dwordx4 v30, s[32:35], s85 offen lds
    ds_read_b64_tr_b16 v[148:149], v10 offset:12288
    v_mfma_f32_16x16x32_bf16 v[64:67], v[216:219], v[228:231], v[64:67]
    s_add_u32 m0, s76, 32768
    s_add_u32 s85, s75, 2
    s_and_b32 s85, s85, 15
    s_lshl_b32 s85, s85, 15
    buffer_load_dwordx4 v30, s[32:35], s85 offen lds
    ds_read_b64_tr_b16 v[150:151], v10 offset:12800
    v_mfma_f32_16x16x32_bf16 v[68:71], v[216:219], v[232:235], v[68:71]
    s_add_u32 m0, s76, 33792
    s_add_u32 s85, s85, s81
    buffer_load_dwordx4 v30, s[32:35], s85 offen lds
    ds_read_b128 v[116:119], v9 offset:51200
    v_mfma_f32_16x16x32_bf16 v[72:75], v[216:219], v[236:239], v[72:75]
    ds_read_b128 v[120:123], v9 offset:53248
    v_lshrrev_b32 v26, 4, v1
    v_bfe_u32 v27, v1, 2, 2
    s_lshl_b32 s6, s77, 14
    s_lshl_b32 s7, s75, 10
    v_mfma_f32_16x16x32_bf16 v[76:79], v[216:219], v[240:243], v[76:79]
    ds_read_b128 v[124:127], v9 offset:55296
    v_and_b32 v28, 1, v26
    v_lshlrev_b32 v28, 1, v28
    s_add_u32 s40, s7, 0
    s_and_b32 s40, s40, 0x3c00
    s_or_b32 s40, s40, s6
    s_add_u32 s41, s7, 1024
    s_and_b32 s41, s41, 0x3c00
    s_or_b32 s41, s41, s6
    v_mfma_f32_16x16x32_bf16 v[80:83], v[216:219], v[244:247], v[80:83]
    ds_read_b128 v[128:131], v9 offset:57344
    v_lshrrev_b32 v29, 1, v27
    v_or_b32 v28, v28, v29
    s_add_u32 s42, s7, 2048
    s_and_b32 s42, s42, 0x3c00
    s_or_b32 s42, s42, s6
    s_add_u32 s43, s7, 3072
    s_and_b32 s43, s43, 0x3c00
    s_or_b32 s43, s43, s6
    v_mfma_f32_16x16x32_bf16 v[84:87], v[216:219], v[248:251], v[84:87]
    ds_read_b128 v[132:135], v9 offset:59392
    v_lshlrev_b32 v28, 5, v28
    v_and_b32 v29, 3, v1
    s_add_u32 s44, s7, 4096
    s_and_b32 s44, s44, 0x3c00
    s_or_b32 s44, s44, s6
    s_add_u32 s45, s7, 5120
    s_and_b32 s45, s45, 0x3c00
    s_or_b32 s45, s45, s6
    v_mfma_f32_16x16x32_bf16 v[36:39], v[212:215], v[228:231], v[36:39]
    ds_read_b128 v[136:139], v9 offset:61440
    v_lshl_add_u32 v28, v29, 3, v28
    v_lshl_add_u32 v29, v26, 2, v27
    s_add_u32 s46, s7, 6144
    s_and_b32 s46, s46, 0x3c00
    s_or_b32 s46, s46, s6
    s_add_u32 s47, s7, 7168
    s_and_b32 s47, s47, 0x3c00
    s_or_b32 s47, s47, s6
    v_mfma_f32_16x16x32_bf16 v[40:43], v[212:215], v[232:235], v[40:43]
    ds_read_b128 v[140:143], v9 offset:63488
    v_lshl_add_u32 v28, v29, 7, v28
    s_lshl_b32 s86, s77, 12
    v_add_u32 v20, s86, v28
    v_mfma_f32_16x16x32_bf16 v[44:47], v[212:215], v[236:239], v[44:47]
    s_setprio 0
    ds_read_b64_tr_b16 v[144:145], v10 offset:4096
    v_xor_b32 v21, 32, v20
    v_xor_b32 v22, 64, v20
    s_add_u32 s48, s7, 8192
    s_and_b32 s48, s48, 0x3c00
    s_or_b32 s48, s48, s6
    s_add_u32 s49, s7, 9216
    s_and_b32 s49, s49, 0x3c00
    s_or_b32 s49, s49, s6
    v_mfma_f32_16x16x32_bf16 v[48:51], v[212:215], v[240:243], v[48:51]
    ds_read_b64_tr_b16 v[146:147], v10 offset:4608
    v_xor_b32 v23, 0x60, v20
    v_and_b32 v28, 0x3ff, v35
    s_add_u32 s50, s7, 10240
    s_and_b32 s50, s50, 0x3c00
    s_or_b32 s50, s50, s6
    s_add_u32 s51, s7, 11264
    s_and_b32 s51, s51, 0x3c00
    s_or_b32 s51, s51, s6
    v_mfma_f32_16x16x32_bf16 v[52:55], v[212:215], v[244:247], v[52:55]
    ds_read_b64_tr_b16 v[152:153], v10 offset:20480
    v_mfma_f32_16x16x32_bf16 v[56:59], v[212:215], v[248:251], v[56:59]
    ds_read_b64_tr_b16 v[154:155], v10 offset:20992
    s_lshl_b32 s86, s77, 16
    s_lshl_b32 s87, s78, 14
    s_add_u32 s86, s86, s87
    s_add_u32 s86, s86, 1572864
    v_lshrrev_b32 v29, 3, v1
    v_lshl_add_u32 v28, v29, 10, v28
    v_mfma_f32_16x16x32_bf16 v[88:91], v[224:227], v[220:223], v[88:91]
    v_add_u32 v31, s86, v28
    s_lshl_b32 s86, s79, 2
    s_lshl_b32 s87, s78, 1
    s_add_u32 s86, s86, s87
    s_mul_i32 s87, s86, 74752
    v_mfma_f32_16x16x32_bf16 v[92:95], v[228:231], v[220:223], v[92:95]
    v_lshl_add_u32 v4, v1, 4, s87
    v_add_u32 v5, 74752, v4
    s_add_u32 s52, s7, 12288
    s_and_b32 s52, s52, 0x3c00
    s_or_b32 s52, s52, s6
    s_add_u32 s53, s7, 13312
    s_and_b32 s53, s53, 0x3c00
    s_or_b32 s53, s53, s6
    v_mfma_f32_16x16x32_bf16 v[96:99], v[232:235], v[220:223], v[96:99]
    v_lshrrev_b32 v26, 1, v1
    v_add_u32 v26, s75, v26
    v_and_b32 v26, 15, v26
    s_add_u32 s54, s7, 14336
    s_and_b32 s54, s54, 0x3c00
    s_or_b32 s54, s54, s6
    s_add_u32 s55, s7, 15360
    s_and_b32 s55, s55, 0x3c00
    s_or_b32 s55, s55, s6
    v_mfma_f32_16x16x32_bf16 v[100:103], v[236:239], v[220:223], v[100:103]
    v_and_b32 v27, 1, v1
    v_add_u32 v27, s86, v27
    s_lshl_b32 s6, s77, 11
    s_add_u32 s59, s6, 65536
    s_add_u32 s60, s6, 66560
    v_mfma_f32_16x16x32_bf16 v[104:107], v[240:243], v[220:223], v[104:107]
    v_add_u32 v28, 2, v27
    v_mul_u32_u24 v28, 6554, v28
    v_lshrrev_b32 v28, 16, v28
    s_mov_b32 s16, s90
    s_mov_b32 s17, s91
    s_mov_b32 s18, 2097152
    s_mov_b32 s19, 0x20000
    v_mfma_f32_16x16x32_bf16 v[108:111], v[244:247], v[220:223], v[108:111]
    v_mul_u32_u24 v27, 5958, v27
    v_lshrrev_b32 v27, 16, v27
    s_mov_b32 s12, s88
    s_mov_b32 s13, s89
    s_mov_b32 s14, 1835008
    s_mov_b32 s15, 0x20000
    v_mfma_f32_16x16x32_bf16 v[112:115], v[248:251], v[220:223], v[112:115]
    s_waitcnt lgkmcnt(0)
    s_waitcnt vmcnt(6)
    s_barrier
    s_setprio 2
    v_mfma_f32_16x16x32_bf16 v[60:63], v[148:151], v[116:119], v[60:63]
    ds_read_b64_tr_b16 v[216:217], v11 offset:8192
    v_add_u32 v28, -1, v28
    v_max_i32 v27, v27, v28
    v_mfma_f32_16x16x32_bf16 v[64:67], v[148:151], v[120:123], v[64:67]
    ds_read_b64_tr_b16 v[218:219], v11 offset:8704
    v_mul_u32_u24 v27, 14, v27
    v_lshrrev_b32 v28, 2, v26
    s_lshl_b32 s99, s77, 2
    s_sub_u32 s99, s99, 4
    v_mfma_f32_16x16x32_bf16 v[68:71], v[148:151], v[124:127], v[68:71]
    ds_read_b128 v[224:227], v18 offset:0
    v_add3_u32 v28, v28, s99, v27
    s_mul_i32 s86, s79, 21846
    s_lshr_b32 s86, s86, 16
    s_lshl_b32 s86, s86, 3
    s_add_u32 s86, s86, 168
    v_lshrrev_b32 v26, 1, v26
    v_mfma_f32_16x16x32_bf16 v[72:75], v[148:151], v[128:131], v[72:75]
    ds_read_b128 v[228:231], v18 offset:2048
    v_add_u32 v26, s86, v26
    s_cmp_eq_u32 s77, 0
    s_cselect_b64 s[100:101], -1, 0
    v_cndmask_b32 v28, v28, v26, s[100:101]
    v_mfma_f32_16x16x32_bf16 v[76:79], v[148:151], v[132:135], v[76:79]
    ds_read_b128 v[232:235], v18 offset:4096
    s_lshr_b32 s99, s77, 1
    s_add_u32 s99, s99, 12
    v_add_u32 v27, s99, v27
    s_mov_b32 s100, 0
    s_mov_b32 s101, -1
    v_cndmask_b32 v28, v28, v27, s[100:101]
    v_mfma_f32_16x16x32_bf16 v[80:83], v[148:151], v[136:139], v[80:83]
    ds_read_b128 v[236:239], v18 offset:6144
    v_lshlrev_b32 v6, 7, v28
    v_lshrrev_b32 v26, 3, v0
    v_mfma_f32_16x16x32_bf16 v[84:87], v[148:151], v[140:143], v[84:87]
    ds_read_b128 v[240:243], v18 offset:8192
    v_and_b32 v29, 7, v0
    v_lshlrev_b32 v26, 10, v26
    v_mfma_f32_16x16x32_bf16 v[36:39], v[144:147], v[120:123], v[36:39]
    ds_read_b128 v[244:247], v18 offset:10240
    s_lshl_b32 s86, s79, 16
    s_lshl_b32 s87, s80, 7
    s_add_u32 s86, s86, s87
    v_lshl_add_u32 v26, v29, 4, v26
    v_add_u32 v7, s86, v26
    v_mfma_f32_16x16x32_bf16 v[40:43], v[144:147], v[124:127], v[40:43]
    ds_read_b128 v[248:251], v18 offset:12288
    ds_read_b64 v[184:185], v14 offset:0
    v_mfma_f32_16x16x32_bf16 v[44:47], v[144:147], v[128:131], v[44:47]
    ds_read_b64_tr_b16 v[212:213], v11 offset:0
    ds_read_b64 v[186:187], v14 offset:128
    v_mfma_f32_16x16x32_bf16 v[48:51], v[144:147], v[132:135], v[48:51]
    ds_read_b64_tr_b16 v[214:215], v11 offset:512
    ds_read_b64 v[188:189], v14 offset:256
    v_mfma_f32_16x16x32_bf16 v[52:55], v[144:147], v[136:139], v[52:55]
    ds_read_b64_tr_b16 v[220:221], v11 offset:16384
    ds_read_b64 v[190:191], v14 offset:384
    v_mfma_f32_16x16x32_bf16 v[56:59], v[144:147], v[140:143], v[56:59]
    ds_read_b64_tr_b16 v[222:223], v11 offset:16896
    ds_read_b64 v[192:193], v14 offset:512
    v_mfma_f32_16x16x32_bf16 v[88:91], v[116:119], v[152:155], v[88:91]
    ds_read_b64 v[194:195], v14 offset:640
    v_mfma_f32_16x16x32_bf16 v[92:95], v[120:123], v[152:155], v[92:95]
    ds_read_b64 v[196:197], v14 offset:768
    v_mfma_f32_16x16x32_bf16 v[96:99], v[124:127], v[152:155], v[96:99]
    ds_read_b64 v[198:199], v15 offset:0
    v_mfma_f32_16x16x32_bf16 v[100:103], v[128:131], v[152:155], v[100:103]
    ds_read_b64 v[200:201], v15 offset:128
    v_mfma_f32_16x16x32_bf16 v[104:107], v[132:135], v[152:155], v[104:107]
    ds_read_b64 v[202:203], v15 offset:256
    v_mfma_f32_16x16x32_bf16 v[108:111], v[136:139], v[152:155], v[108:111]
    v_cmp_gt_u32 vcc, 16, v1
    v_mov_b32 v28, 0xffff
    v_mfma_f32_16x16x32_bf16 v[112:115], v[140:143], v[152:155], v[112:115]
    v_cndmask_b32 v29, 0, v28, vcc
    s_waitcnt lgkmcnt(0)
    v_mfma_f32_16x16x32_bf16 v[60:63], v[216:219], v[224:227], v[60:63]
    ds_read_b64_tr_b16 v[148:149], v11 offset:12288
    v_mfma_f32_16x16x32_bf16 v[64:67], v[216:219], v[228:231], v[64:67]
    ds_read_b64_tr_b16 v[150:151], v11 offset:12800
    v_and_b32 v205, v184, v29
    v_lshl_or_b32 v204, v205, 16, v205
    v_mfma_f32_16x16x32_bf16 v[68:71], v[216:219], v[232:235], v[68:71]
    ds_read_b128 v[116:119], v19 offset:0
    v_and_b32 v207, v186, v29
    v_lshl_or_b32 v206, v207, 16, v207
    v_mfma_f32_16x16x32_bf16 v[72:75], v[216:219], v[236:239], v[72:75]
    ds_read_b128 v[120:123], v19 offset:2048
    v_and_b32 v209, v188, v29
    v_lshl_or_b32 v208, v209, 16, v209
    v_mfma_f32_16x16x32_bf16 v[76:79], v[216:219], v[240:243], v[76:79]
    ds_read_b128 v[124:127], v19 offset:4096
    v_and_b32 v211, v190, v29
    v_lshl_or_b32 v210, v211, 16, v211
    v_mfma_f32_16x16x32_bf16 v[80:83], v[216:219], v[244:247], v[80:83]
    ds_read_b128 v[128:131], v19 offset:6144
    v_and_b32 v253, v192, v29
    v_lshl_or_b32 v252, v253, 16, v253
    v_mfma_f32_16x16x32_bf16 v[84:87], v[216:219], v[248:251], v[84:87]
    ds_read_b128 v[132:135], v19 offset:8192
    v_and_b32 v33, v194, v29
    v_lshl_or_b32 v32, v33, 16, v33
    v_mfma_f32_16x16x32_bf16 v[36:39], v[212:215], v[228:231], v[36:39]
    ds_read_b128 v[136:139], v19 offset:10240
    v_and_b32 v27, v196, v29
    v_lshl_or_b32 v26, v27, 16, v27
    v_mfma_f32_16x16x32_bf16 v[40:43], v[212:215], v[232:235], v[40:43]
    ds_read_b128 v[140:143], v19 offset:12288
    v_mfma_f32_16x16x32_bf16 v[44:47], v[212:215], v[236:239], v[44:47]
    ds_read_b64_tr_b16 v[144:145], v11 offset:4096
    ds_read_b128 v[156:159], v17 offset:0
    v_mfma_f32_16x16x32_bf16 v[48:51], v[212:215], v[240:243], v[48:51]
    ds_read_b64_tr_b16 v[146:147], v11 offset:4608
    ds_read_b128 v[160:163], v17 offset:64
    v_mfma_f32_16x16x32_bf16 v[52:55], v[212:215], v[244:247], v[52:55]
    ds_read_b64_tr_b16 v[152:153], v11 offset:20480
    ds_read_b128 v[164:167], v17 offset:128
    v_mfma_f32_16x16x32_bf16 v[56:59], v[212:215], v[248:251], v[56:59]
    ds_read_b64_tr_b16 v[154:155], v11 offset:20992
    ds_read_b128 v[168:171], v17 offset:192
    v_mfma_f32_16x16x32_bf16 v[88:91], v[224:227], v[220:223], v[88:91]
    ds_read_b128 v[172:175], v17 offset:256
    v_mfma_f32_16x16x32_bf16 v[92:95], v[228:231], v[220:223], v[92:95]
    ds_read_b128 v[176:179], v17 offset:320
    v_mfma_f32_16x16x32_bf16 v[96:99], v[232:235], v[220:223], v[96:99]
    ds_read_b128 v[180:183], v17 offset:384
    v_mfma_f32_16x16x32_bf16 v[100:103], v[236:239], v[220:223], v[100:103]
    v_mfma_f32_16x16x32_bf16 v[104:107], v[240:243], v[220:223], v[104:107]
    v_mfma_f32_16x16x32_bf16 v[108:111], v[244:247], v[220:223], v[108:111]
    v_mfma_f32_16x16x32_bf16 v[112:115], v[248:251], v[220:223], v[112:115]
    v_mfma_f32_16x16x16_bf16 v[60:63], v[200:201], v[204:205], v[60:63]
    v_mfma_f32_16x16x16_bf16 v[64:67], v[200:201], v[206:207], v[64:67]
    v_mfma_f32_16x16x16_bf16 v[36:39], v[198:199], v[206:207], v[36:39]
    v_mfma_f32_16x16x16_bf16 v[68:71], v[200:201], v[208:209], v[68:71]
    v_mfma_f32_16x16x16_bf16 v[40:43], v[198:199], v[208:209], v[40:43]
    v_mfma_f32_16x16x16_bf16 v[72:75], v[200:201], v[210:211], v[72:75]
    v_mfma_f32_16x16x16_bf16 v[44:47], v[198:199], v[210:211], v[44:47]
    v_mfma_f32_16x16x16_bf16 v[76:79], v[200:201], v[252:253], v[76:79]
    v_mfma_f32_16x16x16_bf16 v[48:51], v[198:199], v[252:253], v[48:51]
    v_mfma_f32_16x16x16_bf16 v[80:83], v[200:201], v[32:33], v[80:83]
    v_mfma_f32_16x16x16_bf16 v[52:55], v[198:199], v[32:33], v[52:55]
    v_mfma_f32_16x16x16_bf16 v[84:87], v[200:201], v[26:27], v[84:87]
    v_mfma_f32_16x16x16_bf16 v[56:59], v[198:199], v[26:27], v[56:59]
    v_mfma_f32_16x16x16_bf16 v[88:91], v[204:205], v[202:203], v[88:91]
    v_mfma_f32_16x16x16_bf16 v[92:95], v[206:207], v[202:203], v[92:95]
    v_mfma_f32_16x16x16_bf16 v[96:99], v[208:209], v[202:203], v[96:99]
    v_mfma_f32_16x16x16_bf16 v[100:103], v[210:211], v[202:203], v[100:103]
    v_mfma_f32_16x16x16_bf16 v[104:107], v[252:253], v[202:203], v[104:107]
    v_mfma_f32_16x16x16_bf16 v[108:111], v[32:33], v[202:203], v[108:111]
    v_mfma_f32_16x16x16_bf16 v[112:115], v[26:27], v[202:203], v[112:115]
    s_waitcnt lgkmcnt(0)
    v_mfma_f32_16x16x32_bf16 v[60:63], v[148:151], v[116:119], v[60:63]
    v_and_b32 v12, 15, v1
    v_lshrrev_b32 v15, 4, v1
    s_add_u32 s85, s75, 6
    s_and_b32 s85, s85, 15
    s_lshl_b32 s85, s85, 15
    buffer_load_dwordx4 v[220:223], v30, s[32:35], s85 offen
    v_mfma_f32_16x16x32_bf16 v[64:67], v[148:151], v[120:123], v[64:67]
    v_lshlrev_b32 v15, 2, v15
    v_mov_b32 v13, 0xf149f2ca
    v_sub_u32 v12, v12, v15
    v_mfma_f32_16x16x32_bf16 v[68:71], v[148:151], v[124:127], v[68:71]
    v_and_b32 v14, 1, v1
    v_lshlrev_b32 v14, 4, v14
    v_mov_b32 v15, 0xffff
    s_add_u32 s85, s85, s81
    buffer_load_dwordx4 v[224:227], v30, s[32:35], s85 offen
    v_mfma_f32_16x16x32_bf16 v[72:75], v[148:151], v[128:131], v[72:75]
    v_lshlrev_b32 v14, v14, v15
    v_cmp_le_i32 vcc, 0, v12
    s_cmp_lt_i32 s56, 0
    s_cselect_b64 s[68:69], -1, 0
    v_mfma_f32_16x16x32_bf16 v[76:79], v[148:151], v[132:135], v[76:79]
    v_cndmask_b32 v218, 0, v14, vcc
    v_cndmask_b32 v216, v14, 0, vcc
    v_cmp_le_i32 vcc, 2, v12
    v_mfma_f32_16x16x32_bf16 v[80:83], v[148:151], v[136:139], v[80:83]
    s_nop 0
    v_cndmask_b32 v219, 0, v14, vcc
    v_cndmask_b32 v217, v14, 0, vcc
    s_add_u32 s85, s75, 7
    s_and_b32 s85, s85, 15
    s_lshl_b32 s85, s85, 15
    buffer_load_dwordx4 v[228:231], v30, s[32:35], s85 offen
    v_mfma_f32_16x16x32_bf16 v[84:87], v[148:151], v[140:143], v[84:87]
    v_subrev_u32 v204, 0, v12
    v_add_u32 v208, 1, v204
    v_and_b32 v204, 0x80000001, v204
    v_mfma_f32_16x16x32_bf16 v[36:39], v[144:147], v[120:123], v[36:39]
    v_cmp_eq_u32 vcc, 0, v204
    v_and_b32 v208, 0x80000001, v208
    v_mov_b32 v8, 0x3f803f80
    v_cndmask_b32 v204, v13, 0, vcc
    s_add_u32 s85, s85, s81
    buffer_load_dwordx4 v[232:235], v30, s[32:35], s85 offen
    v_mfma_f32_16x16x32_bf16 v[40:43], v[144:147], v[124:127], v[40:43]
    v_cmp_eq_u32 vcc, 0x80000001, v208
    v_mul_f32 v186, 0x3eb8aa3b, v187
    v_mul_f32 v188, 0x3eb8aa3b, v189
    v_cndmask_b32 v208, v13, 0, vcc
    v_mfma_f32_16x16x32_bf16 v[44:47], v[144:147], v[128:131], v[44:47]
    v_subrev_u32 v205, 1, v12
    v_add_u32 v209, 1, v205
    v_and_b32 v205, 0x80000001, v205
    v_mfma_f32_16x16x32_bf16 v[48:51], v[144:147], v[132:135], v[48:51]
    v_cmp_eq_u32 vcc, 0, v205
    v_and_b32 v209, 0x80000001, v209
    v_mov_b32 v9, 0x3f803f80
    v_cndmask_b32 v205, v13, 0, vcc
    s_add_u32 s85, s75, 8
    s_and_b32 s85, s85, 15
    s_lshl_b32 s85, s85, 15
    buffer_load_dwordx4 v[236:239], v30, s[32:35], s85 offen
    v_mfma_f32_16x16x32_bf16 v[52:55], v[144:147], v[136:139], v[52:55]
    v_cmp_eq_u32 vcc, 0x80000001, v209
    v_mul_f32 v190, 0x3eb8aa3b, v191
    v_mul_f32 v192, 0x3eb8aa3b, v193
    v_cndmask_b32 v209, v13, 0, vcc
    v_mfma_f32_16x16x32_bf16 v[56:59], v[144:147], v[140:143], v[56:59]
    v_subrev_u32 v206, 2, v12
    v_add_u32 v210, 1, v206
    v_and_b32 v206, 0x80000001, v206
    s_add_u32 s85, s85, s81
    buffer_load_dwordx4 v[240:243], v30, s[32:35], s85 offen
    v_mfma_f32_16x16x32_bf16 v[88:91], v[116:119], v[152:155], v[88:91]
    v_cmp_eq_u32 vcc, 0, v206
    v_and_b32 v210, 0x80000001, v210
    v_mov_b32 v10, 0x3f803f80
    v_cndmask_b32 v206, v13, 0, vcc
    v_mfma_f32_16x16x32_bf16 v[92:95], v[120:123], v[152:155], v[92:95]
    v_cmp_eq_u32 vcc, 0x80000001, v210
    v_mul_f32 v194, 0x3eb8aa3b, v195
    v_mul_f32 v196, 0x3eb8aa3b, v197
    v_cndmask_b32 v210, v13, 0, vcc
    v_mfma_f32_16x16x32_bf16 v[96:99], v[124:127], v[152:155], v[96:99]
    v_subrev_u32 v207, 3, v12
    v_add_u32 v211, 1, v207
    v_and_b32 v207, 0x80000001, v207
    s_add_u32 s85, s75, 9
    s_and_b32 s85, s85, 15
    s_lshl_b32 s85, s85, 15
    buffer_load_dwordx4 v[244:247], v30, s[32:35], s85 offen
    v_mfma_f32_16x16x32_bf16 v[100:103], v[128:131], v[152:155], v[100:103]
    v_cmp_eq_u32 vcc, 0, v207
    v_and_b32 v211, 0x80000001, v211
    v_mov_b32 v11, 0x3f803f80
    v_cndmask_b32 v207, v13, 0, vcc
    v_mfma_f32_16x16x32_bf16 v[104:107], v[132:135], v[152:155], v[104:107]
    v_cmp_eq_u32 vcc, 0x80000001, v211
    s_nop 1
    v_cndmask_b32 v211, v13, 0, vcc
    s_add_u32 s85, s85, s81
    buffer_load_dwordx4 v[248:251], v30, s[32:35], s85 offen
    v_mfma_f32_16x16x32_bf16 v[108:111], v[136:139], v[152:155], v[108:111]
    v_cndmask_b32 v212, v208, v13, s[68:69]
    v_cndmask_b32 v213, v209, v13, s[68:69]
    v_mfma_f32_16x16x32_bf16 v[112:115], v[140:143], v[152:155], v[112:115]
    v_cndmask_b32 v214, v210, v13, s[68:69]
    v_cndmask_b32 v215, v211, v13, s[68:69]
    s_lshl_b32 s86, s36, 2
    s_add_u32 s86, s86, 161024
    v_mov_b32 v254, s86
    s_waitcnt vmcnt(8)
    ds_write_b32 v254, v25
    s_setprio 0
    s_lshl_b32 s86, s77, 10
    s_cmp_ge_u32 s77, 2
    s_cselect_b32 s87, 5632, 0
    s_add_u32 s86, s86, s87
    s_add_u32 s86, s86, 153600
    v_lshl_add_u32 v16, v1, 3, s86
    s_lshl_b32 s86, s77, 2
    s_add_u32 s86, s86, 161056
    v_mov_b32 v17, s86
    v_mul_f32 v84, v84, v197
    v_mul_f32 v85, v85, v197
    v_mul_f32 v86, v86, v197
    v_mul_f32 v87, v87, v197
    v_cvt_pk_bf16_f32 v128, v84, v85
    v_cvt_pk_bf16_f32 v129, v86, v87
    v_mul_f32 v112, v112, v180
    v_mul_f32 v113, v113, v181
    v_cvt_pk_bf16_f32 v142, v112, v113
    v_mul_f32 v114, v114, v182
    v_mul_f32 v115, v115, v183
    v_cvt_pk_bf16_f32 v143, v114, v115
    ds_write_b64 v16, v[128:129]
    ds_write_b64 v16, v[142:143] offset:512
    ds_write_b32 v17, v25
    v_mul_f32 v60, v60, v185
    v_mul_f32 v61, v61, v185
    v_mul_f32 v62, v62, v185
    v_mul_f32 v63, v63, v185
    v_cvt_pk_bf16_f32 v116, v60, v61
    v_cvt_pk_bf16_f32 v117, v62, v63
    v_mul_f32 v64, v64, v187
    v_mul_f32 v65, v65, v187
    v_mul_f32 v66, v66, v187
    v_mul_f32 v67, v67, v187
    v_cvt_pk_bf16_f32 v118, v64, v65
    v_cvt_pk_bf16_f32 v119, v66, v67
    v_cvt_pk_bf16_f32 v144, v36, v37
    v_cvt_pk_bf16_f32 v145, v38, v39
    v_mul_f32 v68, v68, v189
    v_mul_f32 v69, v69, v189
    v_mul_f32 v70, v70, v189
    v_mul_f32 v71, v71, v189
    v_cvt_pk_bf16_f32 v120, v68, v69
    v_cvt_pk_bf16_f32 v121, v70, v71
    v_cvt_pk_bf16_f32 v146, v40, v41
    v_cvt_pk_bf16_f32 v147, v42, v43
    v_mul_f32 v72, v72, v191
    v_mul_f32 v73, v73, v191
    v_mul_f32 v74, v74, v191
    v_mul_f32 v75, v75, v191
    v_cvt_pk_bf16_f32 v122, v72, v73
    v_cvt_pk_bf16_f32 v123, v74, v75
    v_cvt_pk_bf16_f32 v148, v44, v45
    v_cvt_pk_bf16_f32 v149, v46, v47
    v_mul_f32 v76, v76, v193
    v_mul_f32 v77, v77, v193
    v_mul_f32 v78, v78, v193
    v_mul_f32 v79, v79, v193
    v_cvt_pk_bf16_f32 v124, v76, v77
    v_cvt_pk_bf16_f32 v125, v78, v79
    v_cvt_pk_bf16_f32 v150, v48, v49
    v_cvt_pk_bf16_f32 v151, v50, v51
    v_mul_f32 v80, v80, v195
    v_mul_f32 v81, v81, v195
    v_mul_f32 v82, v82, v195
    v_mul_f32 v83, v83, v195
    v_cvt_pk_bf16_f32 v126, v80, v81
    v_cvt_pk_bf16_f32 v127, v82, v83
    v_cvt_pk_bf16_f32 v152, v52, v53
    v_cvt_pk_bf16_f32 v153, v54, v55
    v_cvt_pk_bf16_f32 v154, v56, v57
    v_cvt_pk_bf16_f32 v155, v58, v59
    v_mfma_f32_16x16x16_bf16 v[64:67], v[116:117], v[144:145], v[212:215]
    v_mul_f32 v88, v88, v156
    v_mul_f32 v89, v89, v157
    v_cvt_pk_bf16_f32 v130, v88, v89
    v_mfma_f32_16x16x16_bf16 v[36:39], v[118:119], v[144:145], v[204:207]
    v_mul_f32 v90, v90, v158
    v_mul_f32 v91, v91, v159
    v_cvt_pk_bf16_f32 v131, v90, v91
    v_mfma_f32_16x16x16_bf16 v[68:71], v[118:119], v[146:147], v[208:211]
    v_mul_f32 v92, v92, v160
    v_mul_f32 v93, v93, v161
    v_cvt_pk_bf16_f32 v132, v92, v93
    v_mfma_f32_16x16x16_bf16 v[40:43], v[120:121], v[146:147], v[204:207]
    v_mul_f32 v94, v94, v162
    v_mul_f32 v95, v95, v163
    v_cvt_pk_bf16_f32 v133, v94, v95
    v_mfma_f32_16x16x16_bf16 v[72:75], v[120:121], v[148:149], v[208:211]
    v_mul_f32 v96, v96, v164
    v_mul_f32 v97, v97, v165
    v_cvt_pk_bf16_f32 v134, v96, v97
    v_mfma_f32_16x16x16_bf16 v[44:47], v[122:123], v[148:149], v[204:207]
    v_mul_f32 v98, v98, v166
    v_mul_f32 v99, v99, v167
    v_cvt_pk_bf16_f32 v135, v98, v99
    v_mfma_f32_16x16x16_bf16 v[76:79], v[122:123], v[150:151], v[208:211]
    v_mul_f32 v100, v100, v168
    v_mul_f32 v101, v101, v169
    v_cvt_pk_bf16_f32 v136, v100, v101
    v_mfma_f32_16x16x16_bf16 v[48:51], v[124:125], v[150:151], v[204:207]
    v_mul_f32 v102, v102, v170
    v_mul_f32 v103, v103, v171
    v_cvt_pk_bf16_f32 v137, v102, v103
    v_mfma_f32_16x16x16_bf16 v[80:83], v[124:125], v[152:153], v[208:211]
    v_mul_f32 v104, v104, v172
    v_mul_f32 v105, v105, v173
    v_cvt_pk_bf16_f32 v138, v104, v105
    v_mfma_f32_16x16x16_bf16 v[52:55], v[126:127], v[152:153], v[204:207]
    v_mul_f32 v106, v106, v174
    v_mul_f32 v107, v107, v175
    v_cvt_pk_bf16_f32 v139, v106, v107
    v_mfma_f32_16x16x16_bf16 v[84:87], v[126:127], v[154:155], v[208:211]
    v_mul_f32 v108, v108, v176
    v_mul_f32 v109, v109, v177
    v_cvt_pk_bf16_f32 v140, v108, v109
    v_mfma_f32_16x16x16_bf16 v[56:59], v[128:129], v[154:155], v[204:207]
    v_mul_f32 v110, v110, v178
    v_mul_f32 v111, v111, v179
    v_cvt_pk_bf16_f32 v141, v110, v111
    v_max3_f32 v162, v64, v65, v36
    v_max3_f32 v163, v66, v67, v38
    v_max_f32 v162, v162, v37
    v_max_f32 v163, v163, v39
    v_max_f32 v160, v162, v163
    v_max_f32 v161, v162, v163
    v_max3_f32 v166, v68, v69, v40
    v_max3_f32 v167, v70, v71, v42
    v_max_f32 v166, v166, v41
    v_max_f32 v167, v167, v43
    v_max_f32 v164, v166, v167
    v_max_f32 v165, v166, v167
    v_max3_f32 v170, v72, v73, v44
    v_max3_f32 v171, v74, v75, v46
    v_max_f32 v170, v170, v45
    v_max_f32 v171, v171, v47
    v_max_f32 v168, v170, v171
    v_max_f32 v169, v170, v171
    v_max3_f32 v174, v76, v77, v48
    v_max3_f32 v175, v78, v79, v50
    v_max_f32 v174, v174, v49
    v_max_f32 v175, v175, v51
    v_max_f32 v172, v174, v175
    v_max_f32 v173, v174, v175
    v_max3_f32 v178, v80, v81, v52
    v_max3_f32 v179, v82, v83, v54
    v_max_f32 v178, v178, v53
    v_max_f32 v179, v179, v55
    v_max_f32 v176, v178, v179
    v_max_f32 v177, v178, v179
    v_max3_f32 v182, v84, v85, v56
    v_max3_f32 v183, v86, v87, v58
    v_max_f32 v182, v182, v57
    v_max_f32 v183, v183, v59
    v_max_f32 v180, v182, v183
    v_max_f32 v181, v182, v183
    v_permlane16_swap_b32 v160, v161
    v_permlane16_swap_b32 v164, v165
    v_permlane16_swap_b32 v168, v169
    v_permlane16_swap_b32 v172, v173
    v_permlane16_swap_b32 v176, v177
    v_permlane16_swap_b32 v180, v181
    v_max_f32 v160, v160, v161
    v_mov_b32 v161, v160
    v_max_f32 v164, v164, v165
    v_mov_b32 v165, v164
    v_max_f32 v168, v168, v169
    v_mov_b32 v169, v168
    v_max_f32 v172, v172, v173
    v_mov_b32 v173, v172
    v_max_f32 v176, v176, v177
    v_mov_b32 v177, v176
    v_max_f32 v180, v180, v181
    v_mov_b32 v181, v180
    v_permlane32_swap_b32 v160, v161
    v_permlane32_swap_b32 v164, v165
    v_permlane32_swap_b32 v168, v169
    v_permlane32_swap_b32 v172, v173
    v_permlane32_swap_b32 v176, v177
    v_permlane32_swap_b32 v180, v181
    v_max_f32 v160, v160, v161
    v_sub_f32 v162, v162, v160
    v_sub_f32 v163, v163, v160
    v_mul_f32 v162, v162, v186
    v_mul_f32 v163, v163, v186
    v_max_f32 v164, v164, v165
    v_sub_f32 v166, v166, v164
    v_sub_f32 v167, v167, v164
    v_mul_f32 v166, v166, v188
    v_mul_f32 v167, v167, v188
    v_max_f32 v168, v168, v169
    v_sub_f32 v170, v170, v168
    v_sub_f32 v171, v171, v168
    v_mul_f32 v170, v170, v190
    v_mul_f32 v171, v171, v190
    v_max_f32 v172, v172, v173
    v_sub_f32 v174, v174, v172
    v_sub_f32 v175, v175, v172
    v_mul_f32 v174, v174, v192
    v_mul_f32 v175, v175, v192
    v_max_f32 v176, v176, v177
    v_sub_f32 v178, v178, v176
    v_sub_f32 v179, v179, v176
    v_mul_f32 v178, v178, v194
    v_mul_f32 v179, v179, v194
    v_max_f32 v180, v180, v181
    v_sub_f32 v182, v182, v180
    v_sub_f32 v183, v183, v180
    v_mul_f32 v182, v182, v196
    v_mul_f32 v183, v183, v196
    v_exp_f32 v162, v162
    v_exp_f32 v163, v163
    v_exp_f32 v166, v166
    v_exp_f32 v167, v167
    v_exp_f32 v170, v170
    v_exp_f32 v171, v171
    v_exp_f32 v174, v174
    v_exp_f32 v175, v175
    v_exp_f32 v178, v178
    v_exp_f32 v179, v179
    v_exp_f32 v182, v182
    v_exp_f32 v183, v183
    v_cvt_pk_bf16_f32 v162, v162, v162
    v_cvt_pk_bf16_f32 v163, v163, v163
    v_and_b32 v92, v162, v216
    v_and_b32 v93, v163, v217
    v_and_b32 v94, v162, v218
    v_and_b32 v95, v163, v219
    v_cvt_pk_bf16_f32 v166, v166, v166
    v_cvt_pk_bf16_f32 v167, v167, v167
    v_and_b32 v96, v166, v216
    v_and_b32 v97, v167, v217
    v_and_b32 v98, v166, v218
    v_and_b32 v99, v167, v219
    v_mfma_f32_16x16x32_bf16 v[64:67], v[130:133], v[92:95], 0
    v_mfma_f32_16x16x32_bf16 v[36:39], v[8:11], v[92:95], 0
    v_cvt_pk_bf16_f32 v170, v170, v170
    v_cvt_pk_bf16_f32 v171, v171, v171
    v_and_b32 v100, v170, v216
    v_and_b32 v101, v171, v217
    v_and_b32 v102, v170, v218
    v_and_b32 v103, v171, v219
    v_mfma_f32_16x16x32_bf16 v[68:71], v[132:135], v[96:99], 0
    v_mfma_f32_16x16x32_bf16 v[40:43], v[8:11], v[96:99], 0
    v_cvt_pk_bf16_f32 v174, v174, v174
    v_cvt_pk_bf16_f32 v175, v175, v175
    v_and_b32 v104, v174, v216
    v_and_b32 v105, v175, v217
    v_and_b32 v106, v174, v218
    v_and_b32 v107, v175, v219
    v_mfma_f32_16x16x32_bf16 v[72:75], v[134:137], v[100:103], 0
    v_mfma_f32_16x16x32_bf16 v[44:47], v[8:11], v[100:103], 0
    v_cvt_pk_bf16_f32 v178, v178, v178
    v_cvt_pk_bf16_f32 v179, v179, v179
    v_and_b32 v108, v178, v216
    v_and_b32 v109, v179, v217
    v_and_b32 v110, v178, v218
    v_and_b32 v111, v179, v219
    v_mfma_f32_16x16x32_bf16 v[76:79], v[136:139], v[104:107], 0
    v_mfma_f32_16x16x32_bf16 v[48:51], v[8:11], v[104:107], 0
    v_cvt_pk_bf16_f32 v182, v182, v182
    v_cvt_pk_bf16_f32 v183, v183, v183
    v_and_b32 v112, v182, v216
    v_and_b32 v113, v183, v217
    v_and_b32 v114, v182, v218
    v_and_b32 v115, v183, v219
    v_mfma_f32_16x16x32_bf16 v[80:83], v[138:141], v[108:111], 0
    v_mfma_f32_16x16x32_bf16 v[52:55], v[8:11], v[108:111], 0
    v_mfma_f32_16x16x32_bf16 v[84:87], v[140:143], v[112:115], 0
    v_mfma_f32_16x16x32_bf16 v[56:59], v[8:11], v[112:115], 0
    v_rcp_f32 v36, v36
    v_rcp_f32 v40, v40
    v_mul_f32 v64, v64, v36
    v_mul_f32 v65, v65, v36
    v_mul_f32 v66, v66, v36
    v_mul_f32 v67, v67, v36
    v_cvt_pk_bf16_f32 v92, v64, v65
    v_cvt_pk_bf16_f32 v93, v66, v67
    v_mul_f32 v68, v68, v40
    v_mul_f32 v69, v69, v40
    v_mul_f32 v70, v70, v40
    v_mul_f32 v71, v71, v40
    v_cvt_pk_bf16_f32 v94, v68, v69
    v_cvt_pk_bf16_f32 v95, v70, v71
    s_add_u32 s38, s56, 74752
    v_permlane16_swap_b32 v92, v94
    v_permlane16_swap_b32 v93, v95
    buffer_store_dwordx4 v[92:95], v3, s[20:23], s38 offen sc1
    v_rcp_f32 v44, v44
    v_rcp_f32 v48, v48
    v_mul_f32 v72, v72, v44
    v_mul_f32 v73, v73, v44
    v_mul_f32 v74, v74, v44
    v_mul_f32 v75, v75, v44
    v_cvt_pk_bf16_f32 v100, v72, v73
    v_cvt_pk_bf16_f32 v101, v74, v75
    v_mul_f32 v76, v76, v48
    v_mul_f32 v77, v77, v48
    v_mul_f32 v78, v78, v48
    v_mul_f32 v79, v79, v48
    v_cvt_pk_bf16_f32 v102, v76, v77
    v_cvt_pk_bf16_f32 v103, v78, v79
    s_add_u32 s38, s56, 224256
    v_permlane16_swap_b32 v100, v102
    v_permlane16_swap_b32 v101, v103
    buffer_store_dwordx4 v[100:103], v3, s[20:23], s38 offen sc1
    v_rcp_f32 v52, v52
    v_rcp_f32 v56, v56
    v_mul_f32 v80, v80, v52
    v_mul_f32 v81, v81, v52
    v_mul_f32 v82, v82, v52
    v_mul_f32 v83, v83, v52
    v_cvt_pk_bf16_f32 v108, v80, v81
    v_cvt_pk_bf16_f32 v109, v82, v83
    v_mul_f32 v84, v84, v56
    v_mul_f32 v85, v85, v56
    v_mul_f32 v86, v86, v56
    v_mul_f32 v87, v87, v56
    v_cvt_pk_bf16_f32 v110, v84, v85
    v_cvt_pk_bf16_f32 v111, v86, v87
    s_add_u32 s38, s56, 373760
    v_permlane16_swap_b32 v108, v110
    v_permlane16_swap_b32 v109, v111
    buffer_store_dwordx4 v[108:111], v3, s[20:23], s38 offen sc1
    s_branch P2_start
K_qkvy:
    s_waitcnt vmcnt(4)
    s_cmp_lg_u32 s36, 0
    s_cbranch_scc1 AR_39
    s_bfe_u32 s96, s2, 0x10003
    s_lshl_b32 s96, s96, 7
    v_mov_b32 v254, 1
    v_mov_b32 v2, 0
    s_mov_b64 exec, 1
    buffer_atomic_add v254, v2, s[28:31], s96 offen sc1
    s_mov_b64 exec, -1
AR_39:
    s_barrier
    ds_read_b64_tr_b16 v[216:217], v10 offset:8192
    ds_read_b64_tr_b16 v[218:219], v10 offset:8704
    ds_read_b128 v[228:231], v8 offset:53248
    ds_read_b128 v[232:235], v8 offset:55296
    ds_read_b128 v[236:239], v8 offset:57344
    ds_read_b128 v[240:243], v8 offset:59392
    ds_read_b128 v[244:247], v8 offset:61440
    ds_read_b128 v[248:251], v8 offset:63488
    ds_read_b64_tr_b16 v[212:213], v10 offset:0
    ds_read_b64_tr_b16 v[214:215], v10 offset:512
    ds_read_b64_tr_b16 v[220:221], v10 offset:16384
    ds_read_b64_tr_b16 v[222:223], v10 offset:16896
    v_mov_b32 v156, 0x3f803f80
    v_mov_b32 v157, 0x3f803f80
    v_mov_b32 v158, 0x3f803f80
    v_mov_b32 v159, 0x3f803f80
    s_waitcnt lgkmcnt(0)
    s_setprio 1
    v_mfma_f32_16x16x32_bf16 v[64:67], v[216:219], v[228:231], 0
    s_add_u32 m0, s37, 129024
    s_add_u32 s38, s49, 0
    buffer_load_dwordx4 v7, s[12:15], s38 offen lds
    ds_read_b64_tr_b16 v[148:149], v10 offset:12288
    v_mfma_f32_16x16x32_bf16 v[68:71], v[216:219], v[232:235], 0
    s_add_u32 m0, s37, 137216
    s_add_u32 s38, s49, 1024
    buffer_load_dwordx4 v7, s[12:15], s38 offen lds
    ds_read_b64_tr_b16 v[150:151], v10 offset:12800
    v_mfma_f32_16x16x32_bf16 v[72:75], v[216:219], v[236:239], 0
    s_add_u32 m0, s37, 145408
    s_add_u32 s38, s49, 2048
    buffer_load_dwordx4 v7, s[12:15], s38 offen lds
    ds_read_b128 v[120:123], v9 offset:53248
    v_mfma_f32_16x16x32_bf16 v[76:79], v[216:219], v[240:243], 0
    ds_read_b128 v[124:127], v9 offset:55296
    v_mov_b32 v254, 0x80000000
    v_cmp_eq_u32 vcc, 0, v1
    v_mfma_f32_16x16x32_bf16 v[80:83], v[216:219], v[244:247], 0
    ds_read_b128 v[128:131], v9 offset:57344
    v_mov_b32 v25, 1
    v_cndmask_b32 v24, v254, 0, vcc
    v_mfma_f32_16x16x32_bf16 v[84:87], v[216:219], v[248:251], 0
    ds_read_b128 v[132:135], v9 offset:59392
    v_and_b32 v2, 15, v1
    v_cmp_eq_u32 vcc, 0, v2
    v_mfma_f32_16x16x32_bf16 v[36:39], v[212:215], v[228:231], 0
    ds_read_b128 v[136:139], v9 offset:61440
    v_and_b32 v26, 48, v1
    v_cndmask_b32 v23, v254, v26, vcc
    v_mfma_f32_16x16x32_bf16 v[40:43], v[212:215], v[232:235], 0
    ds_read_b128 v[140:143], v9 offset:63488
    s_lshl_b32 s98, s36, 2
    s_add_u32 s98, s98, 161024
    v_mov_b32 v2, s98
    v_mov_b32 v26, 0
    ds_write_b32 v2, v26
    ds_write_b32 v2, v26 offset:32
    v_mfma_f32_16x16x32_bf16 v[44:47], v[212:215], v[236:239], 0
    s_setprio 0
    ds_read_b64_tr_b16 v[144:145], v10 offset:4096
    s_lshl_b32 s56, s4, 2
    s_add_u32 s56, s56, s77
    s_lshl_b32 s98, s77, 10
    s_add_u32 s64, s64, s98
    s_cmp_lt_u32 s36, 4
    s_cselect_b32 s64, s64, 1073741824
    s_cmp_eq_u32 s36, 0
    s_cselect_b32 s67, s67, 1073741824
    v_bfe_u32 v2, v1, 2, 2
    v_lshrrev_b32 v26, 4, v1
    v_mfma_f32_16x16x32_bf16 v[48:51], v[212:215], v[240:243], 0
    ds_read_b64_tr_b16 v[146:147], v10 offset:4608
    s_lshl_b32 s98, s36, 9
    s_add_u32 s62, s62, s98
    v_cmp_eq_u32 vcc, v2, v26
    v_and_b32 v2, 15, v1
    v_mfma_f32_16x16x32_bf16 v[52:55], v[212:215], v[244:247], 0
    ds_read_b64_tr_b16 v[152:153], v10 offset:20480
    v_mfma_f32_16x16x32_bf16 v[56:59], v[212:215], v[248:251], 0
    ds_read_b64_tr_b16 v[154:155], v10 offset:20992
    v_lshlrev_b32 v2, 3, v2
    v_cndmask_b32 v22, v254, v2, vcc
    v_mfma_f32_16x16x32_bf16 v[92:95], v[228:231], v[220:223], 0
    s_lshr_b32 s98, s4, 2
    s_sub_u32 s98, s98, s78
    s_mul_i32 s98, s98, 6
    s_add_u32 s98, s98, s36
    s_add_u32 s98, s98, 1
    s_lshl_b32 s98, s98, 11
    s_add_u32 s98, s98, 51200
    v_add_u32 v20, s98, v8
    v_add_u32 v21, s98, v9
    v_mfma_f32_16x16x32_bf16 v[96:99], v[232:235], v[220:223], 0
    v_add_u32 v18, 102400, v8
    v_add_u32 v19, 102400, v9
    v_mfma_f32_16x16x32_bf16 v[100:103], v[236:239], v[220:223], 0
    v_add_u32 v11, 51200, v10
    v_subrev_u32 v12, 51200, v10
    v_mfma_f32_16x16x32_bf16 v[104:107], v[240:243], v[220:223], 0
    s_add_u32 m0, s37, 0
    s_nop 0
    buffer_load_dwordx4 v4, s[8:11], s42 offen lds
    v_mfma_f32_16x16x32_bf16 v[108:111], v[244:247], v[220:223], 0
    s_add_u32 m0, s37, 8192
    s_nop 0
    buffer_load_dwordx4 v5, s[8:11], s42 offen lds
    v_mfma_f32_16x16x32_bf16 v[112:115], v[248:251], v[220:223], 0
    s_waitcnt lgkmcnt(0)
    s_cmp_lt_u32 s36, 6
    s_cbranch_scc0 SK_40
    ds_read_b128 v[172:175], v20 offset:0
    ds_read_b128 v[176:179], v21 offset:0
SK_40:
    s_cmp_lt_u32 s36, 6
    s_cbranch_scc0 SK_41
    s_waitcnt lgkmcnt(0)
    v_mfma_f32_16x16x32_bf16 v[180:183], v[156:159], v[172:175], 0
    v_mfma_f32_16x16x32_bf16 v[184:187], v[172:175], v[172:175], 0
    v_mfma_f32_16x16x32_bf16 v[180:183], v[156:159], v[176:179], v[180:183]
    v_mfma_f32_16x16x32_bf16 v[184:187], v[176:179], v[176:179], v[184:187]
SK_41:
    s_barrier
    s_setprio 3
    v_mfma_f32_16x16x32_bf16 v[64:67], v[148:151], v[120:123], v[64:67]
    s_add_u32 m0, s37, 16384
    s_nop 0
    buffer_load_dwordx4 v6, s[8:11], s42 offen lds
    v_mfma_f32_16x16x32_bf16 v[68:71], v[148:151], v[124:127], v[68:71]
    s_add_u32 m0, s37, 26624
    s_add_u32 s38, s50, 0
    buffer_load_dwordx4 v7, s[12:15], s38 offen lds
    v_mfma_f32_16x16x32_bf16 v[72:75], v[148:151], v[128:131], v[72:75]
    s_add_u32 m0, s37, 34816
    s_add_u32 s38, s50, 1024
    buffer_load_dwordx4 v7, s[12:15], s38 offen lds
    v_mfma_f32_16x16x32_bf16 v[76:79], v[148:151], v[132:135], v[76:79]
    s_add_u32 m0, s37, 43008
    s_add_u32 s38, s50, 2048
    buffer_load_dwordx4 v7, s[12:15], s38 offen lds
    v_mfma_f32_16x16x32_bf16 v[80:83], v[148:151], v[136:139], v[80:83]
    s_lshl_b32 s98, s56, 10
    s_add_u32 s98, s98, 157696
    v_min_u32 v254, 47, v1
    v_lshl_add_u32 v28, v254, 2, s98
    v_mfma_f32_16x16x32_bf16 v[84:87], v[148:151], v[140:143], v[84:87]
    s_mul_i32 s97, s5, 12
    s_sub_u32 s97, s97, 1
    s_lshl_b32 s99, s77, 2
    s_add_u32 s99, s99, s97
    v_lshrrev_b32 v26, 4, v1
    v_add_u32 v254, s99, v26
    v_mfma_f32_16x16x32_bf16 v[36:39], v[144:147], v[120:123], v[36:39]
    v_cmp_gt_u32 vcc, 132, v254
    v_lshlrev_b32 v254, 9, v254
    s_mov_b64 s[100:101], vcc
    v_mfma_f32_16x16x32_bf16 v[40:43], v[144:147], v[124:127], v[40:43]
    v_and_b32 v2, 15, v1
    v_lshl_add_u32 v254, v2, 3, v254
    v_mfma_f32_16x16x32_bf16 v[44:47], v[144:147], v[128:131], v[44:47]
    s_setprio 2
    v_add_u32 v254, 32768, v254
    v_mov_b32 v3, 0x80000000
    v_mfma_f32_16x16x32_bf16 v[48:51], v[144:147], v[132:135], v[48:51]
    v_cndmask_b32 v254, v3, v254, s[100:101]
    v_cmp_gt_u32 vcc, 208, v0
    s_nop 0
    s_and_b64 s[100:101], s[100:101], vcc
    v_mfma_f32_16x16x32_bf16 v[52:55], v[144:147], v[136:139], v[52:55]
    s_cmp_ge_u32 s36, 4
    s_cselect_b64 vcc, -1, 0
    s_or_b64 s[100:101], s[100:101], vcc
    v_cndmask_b32 v28, v254, v28, vcc
    s_mul_i32 s98, s78, 384
    s_add_u32 s98, s98, 159744
    v_lshl_add_u32 v17, v26, 4, s98
    v_mfma_f32_16x16x32_bf16 v[56:59], v[144:147], v[140:143], v[56:59]
    v_and_b32 v254, 1, v26
    v_mul_u32_u24 v254, 74752, v254
    v_mfma_f32_16x16x32_bf16 v[92:95], v[120:123], v[152:155], v[92:95]
    v_lshrrev_b32 v26, 1, v26
    v_lshl_add_u32 v254, v26, 8, v254
    v_mfma_f32_16x16x32_bf16 v[96:99], v[124:127], v[152:155], v[96:99]
    s_and_b32 s98, s56, 1
    s_lshl_b32 s98, s98, 9
    v_lshl_add_u32 v254, v2, 4, v254
    v_add_u32 v3, s98, v254
    s_mov_b32 s96, s74
    s_add_u32 s96, s96, s97
    s_mul_i32 s96, s96, 73
    s_lshr_b32 s56, s56, 1
    s_add_u32 s56, s56, s96
    s_lshl_b32 s56, s56, 10
    v_mfma_f32_16x16x32_bf16 v[100:103], v[128:131], v[152:155], v[100:103]
    s_mov_b32 s68, 0x22222222
    s_mov_b32 s69, 0x22222222
    s_mov_b32 s70, 0x44444444
    s_mov_b32 s71, 0x44444444
    s_mov_b32 s72, 0x88888888
    s_mov_b32 s73, 0x88888888
    v_mov_b32 v254, 0x80000000
    v_cmp_gt_u32 vcc, 2, v1
    v_mfma_f32_16x16x32_bf16 v[104:107], v[132:135], v[152:155], v[104:107]
    s_add_u32 s20, s94, 1048576
    s_addc_u32 s21, s95, 0
    s_mov_b32 s22, 9568256
    s_mov_b32 s23, 0x20000
    v_lshlrev_b32 v2, 7, v1
    v_cndmask_b32 v27, v254, v2, vcc
    v_mfma_f32_16x16x32_bf16 v[108:111], v[136:139], v[152:155], v[108:111]
    s_add_u32 m0, s37, 77824
    s_add_u32 s38, s51, 0
    buffer_load_dwordx4 v7, s[12:15], s38 offen lds
    v_mfma_f32_16x16x32_bf16 v[112:115], v[140:143], v[152:155], v[112:115]
    s_add_u32 m0, s37, 86016
    s_add_u32 s38, s51, 1024
    buffer_load_dwordx4 v7, s[12:15], s38 offen lds
    s_waitcnt vmcnt(8)
    s_barrier
    ds_read_b64_tr_b16 v[216:217], v11 offset:8192
    ds_read_b64_tr_b16 v[218:219], v11 offset:8704
    ds_read_b128 v[228:231], v18 offset:2048
    ds_read_b128 v[232:235], v18 offset:4096
    ds_read_b128 v[236:239], v18 offset:6144
    ds_read_b128 v[240:243], v18 offset:8192
    ds_read_b128 v[244:247], v18 offset:10240
    ds_read_b128 v[248:251], v18 offset:12288
    ds_read_b64_tr_b16 v[212:213], v11 offset:0
    ds_read_b64_tr_b16 v[214:215], v11 offset:512
    ds_read_b64_tr_b16 v[220:221], v11 offset:16384
    ds_read_b64_tr_b16 v[222:223], v11 offset:16896
    s_waitcnt lgkmcnt(0)
    s_setprio 1
    v_mfma_f32_16x16x32_bf16 v[64:67], v[216:219], v[228:231], v[64:67]
    ds_read_b64_tr_b16 v[148:149], v11 offset:12288
    v_mfma_f32_16x16x32_bf16 v[68:71], v[216:219], v[232:235], v[68:71]
    ds_read_b64_tr_b16 v[150:151], v11 offset:12800
    s_add_u32 m0, s37, 94208
    s_add_u32 s38, s51, 2048
    buffer_load_dwordx4 v7, s[12:15], s38 offen lds
    v_mfma_f32_16x16x32_bf16 v[72:75], v[216:219], v[236:239], v[72:75]
    ds_read_b128 v[120:123], v19 offset:2048
    s_add_u32 m0, s37, 51200
    s_nop 0
    buffer_load_dwordx4 v4, s[8:11], s43 offen lds
    v_mfma_f32_16x16x32_bf16 v[76:79], v[216:219], v[240:243], v[76:79]
    ds_read_b128 v[124:127], v19 offset:4096
    s_add_u32 m0, s37, 59392
    s_nop 0
    buffer_load_dwordx4 v5, s[8:11], s43 offen lds
    v_mfma_f32_16x16x32_bf16 v[80:83], v[216:219], v[244:247], v[80:83]
    ds_read_b128 v[128:131], v19 offset:6144
    s_add_u32 m0, s37, 67584
    s_nop 0
    buffer_load_dwordx4 v6, s[8:11], s43 offen lds
    v_mfma_f32_16x16x32_bf16 v[84:87], v[216:219], v[248:251], v[84:87]
    ds_read_b128 v[132:135], v19 offset:8192
    s_mov_b32 s57, 0xbfb8aa3b
    s_and_b32 s96, s2, 7
    s_lshr_b32 s97, s2, 3
    s_and_b32 s98, s97, 3
    s_lshl_b32 s79, s96, 2
    s_add_u32 s79, s79, s98
    s_lshr_b32 s80, s97, 2
    v_lshlrev_b32 v29, 3, v0
    v_add_u32 v29, 155648, v29
    v_mfma_f32_16x16x32_bf16 v[36:39], v[212:215], v[228:231], v[36:39]
    ds_read_b128 v[136:139], v19 offset:10240
    s_lshl_b32 s75, s80, 1
    s_lshl_b32 s98, s98, 2
    s_add_u32 s75, s75, s98
    v_bfe_u32 v254, v1, 1, 2
    v_lshrrev_b32 v2, 4, v1
    v_mfma_f32_16x16x32_bf16 v[40:43], v[212:215], v[232:235], v[40:43]
    ds_read_b128 v[140:143], v19 offset:12288
    v_xor_b32 v254, v254, v2
    v_lshlrev_b32 v254, 5, v254
    v_mfma_f32_16x16x32_bf16 v[44:47], v[212:215], v[236:239], v[44:47]
    s_setprio 0
    ds_read_b64_tr_b16 v[144:145], v11 offset:4096
    s_sub_u32 s98, s77, 1
    s_lshl_b32 s98, s98, 19
    s_add_u32 s98, s88, s98
    s_addc_u32 s99, s89, 0
    s_cmp_eq_u32 s77, 0
    s_cselect_b32 s32, s82, s98
    s_cselect_b32 s33, s83, s99
    s_mov_b32 s34, 0x80000
    s_mov_b32 s35, 0x20000
    v_and_b32 v2, 1, v1
    v_lshl_add_u32 v254, v2, 4, v254
    v_mfma_f32_16x16x32_bf16 v[48:51], v[212:215], v[240:243], v[48:51]
    ds_read_b64_tr_b16 v[146:147], v11 offset:4608
    s_lshl_b32 s76, s77, 12
    s_lshl_b32 s98, s78, 11
    s_add_u32 s76, s76, s98
    v_lshrrev_b32 v2, 3, v1
    v_and_b32 v26, 4, v2
    v_mfma_f32_16x16x32_bf16 v[52:55], v[212:215], v[244:247], v[52:55]
    ds_read_b64_tr_b16 v[152:153], v11 offset:20480
    s_cmp_eq_u32 s77, 0
    s_cselect_b64 vcc, -1, 0
    s_cselect_b32 s81, 2, 1
    s_cselect_b32 s99, 12, 14
    s_lshl_b32 s81, s81, 13
    v_add_u32 v26, v26, v2
    v_cndmask_b32 v2, v2, v26, vcc
    v_mfma_f32_16x16x32_bf16 v[56:59], v[212:215], v[248:251], v[56:59]
    ds_read_b64_tr_b16 v[154:155], v11 offset:20992
    s_lshl_b32 s98, s80, 7
    s_lshl_b32 s99, s78, s99
    v_lshl_add_u32 v254, v2, 10, v254
    v_add_u32 v35, s98, v254
    v_mfma_f32_16x16x32_bf16 v[92:95], v[228:231], v[220:223], v[92:95]
    v_add_u32 v30, s99, v35
    s_lshl_b32 s98, s2, 3
    s_add_u32 s98, s98, s36
    s_mul_i32 s99, s98, 896
    s_lshl_b32 s98, s98, 8
    v_min_u32 v254, 6, v1
    v_mfma_f32_16x16x32_bf16 v[96:99], v[232:235], v[220:223], v[96:99]
    v_lshl_add_u32 v31, v254, 7, s99
    v_min_u32 v2, 1, v1
    v_mfma_f32_16x16x32_bf16 v[100:103], v[236:239], v[220:223], v[100:103]
    v_lshl_add_u32 v32, v2, 7, s98
    v_and_b32 v2, 15, v1
    v_mfma_f32_16x16x32_bf16 v[104:107], v[240:243], v[220:223], v[104:107]
    s_lshl_b32 s98, s74, 7
    s_add_u32 s98, s98, 155648
    v_lshl_add_u32 v14, v2, 3, s98
    v_mfma_f32_16x16x32_bf16 v[108:111], v[244:247], v[220:223], v[108:111]
    s_lshl_b32 s98, s77, 9
    s_add_u32 s98, s98, 157696
    v_lshl_add_u32 v15, v2, 3, s98
    v_mfma_f32_16x16x32_bf16 v[112:115], v[248:251], v[220:223], v[112:115]
    s_waitcnt lgkmcnt(0)
    s_cmp_lt_u32 s36, 6
    s_cbranch_scc0 SK_42
    ds_read_b128 v[172:175], v20 offset:51200
    ds_read_b128 v[176:179], v21 offset:51200
SK_42:
    s_cmp_lt_u32 s36, 6
    s_cbranch_scc0 SK_43
    s_waitcnt lgkmcnt(0)
    v_mfma_f32_16x16x32_bf16 v[180:183], v[156:159], v[172:175], v[180:183]
    v_mfma_f32_16x16x32_bf16 v[184:187], v[172:175], v[172:175], v[184:187]
    v_mfma_f32_16x16x32_bf16 v[180:183], v[156:159], v[176:179], v[180:183]
    v_mfma_f32_16x16x32_bf16 v[184:187], v[176:179], v[176:179], v[184:187]
SK_43:
    s_waitcnt vmcnt(6)
    s_barrier
    s_setprio 3
    v_mfma_f32_16x16x32_bf16 v[64:67], v[148:151], v[120:123], v[64:67]
    ds_read_b64_tr_b16 v[216:217], v12 offset:8192
    v_mfma_f32_16x16x32_bf16 v[68:71], v[148:151], v[124:127], v[68:71]
    ds_read_b64_tr_b16 v[218:219], v12 offset:8704
    v_mfma_f32_16x16x32_bf16 v[72:75], v[148:151], v[128:131], v[72:75]
    ds_read_b128 v[228:231], v8 offset:2048
    v_mfma_f32_16x16x32_bf16 v[76:79], v[148:151], v[132:135], v[76:79]
    ds_read_b128 v[232:235], v8 offset:4096
    v_mfma_f32_16x16x32_bf16 v[80:83], v[148:151], v[136:139], v[80:83]
    ds_read_b128 v[236:239], v8 offset:6144
    v_mfma_f32_16x16x32_bf16 v[84:87], v[148:151], v[140:143], v[84:87]
    ds_read_b128 v[240:243], v8 offset:8192
    v_mfma_f32_16x16x32_bf16 v[36:39], v[144:147], v[120:123], v[36:39]
    ds_read_b128 v[244:247], v8 offset:10240
    s_cmp_lt_u32 s36, 6
    s_cbranch_scc0 SK_44
    v_cndmask_b32 v184, v184, v185, s[68:69]
    v_cndmask_b32 v184, v184, v186, s[70:71]
    v_cndmask_b32 v184, v184, v187, s[72:73]
    v_or_b32 v180, 1, v180
    v_or_b32 v181, 1, v184
    buffer_store_dwordx2 v[180:181], v22, s[24:27], s62 offen sc1
SK_44:
    v_mfma_f32_16x16x32_bf16 v[40:43], v[144:147], v[124:127], v[40:43]
    ds_read_b128 v[248:251], v8 offset:12288
    v_mfma_f32_16x16x32_bf16 v[44:47], v[144:147], v[128:131], v[44:47]
    s_setprio 2
    ds_read_b64_tr_b16 v[212:213], v12 offset:0
    v_mfma_f32_16x16x32_bf16 v[48:51], v[144:147], v[132:135], v[48:51]
    ds_read_b64_tr_b16 v[214:215], v12 offset:512
    v_mfma_f32_16x16x32_bf16 v[52:55], v[144:147], v[136:139], v[52:55]
    ds_read_b64_tr_b16 v[220:221], v12 offset:16384
    s_add_u32 m0, s37, 129024
    s_add_u32 s38, s52, 0
    buffer_load_dwordx4 v7, s[12:15], s38 offen lds
    v_mfma_f32_16x16x32_bf16 v[56:59], v[144:147], v[140:143], v[56:59]
    ds_read_b64_tr_b16 v[222:223], v12 offset:16896
    v_mfma_f32_16x16x32_bf16 v[92:95], v[120:123], v[152:155], v[92:95]
    v_mfma_f32_16x16x32_bf16 v[96:99], v[124:127], v[152:155], v[96:99]
    v_mfma_f32_16x16x32_bf16 v[100:103], v[128:131], v[152:155], v[100:103]
    s_add_u32 m0, s37, 137216
    s_add_u32 s38, s52, 1024
    buffer_load_dwordx4 v7, s[12:15], s38 offen lds
    v_mfma_f32_16x16x32_bf16 v[104:107], v[132:135], v[152:155], v[104:107]
    v_mfma_f32_16x16x32_bf16 v[108:111], v[136:139], v[152:155], v[108:111]
    v_mfma_f32_16x16x32_bf16 v[112:115], v[140:143], v[152:155], v[112:115]
    s_waitcnt lgkmcnt(0)
    s_setprio 1
    v_mfma_f32_16x16x32_bf16 v[64:67], v[216:219], v[228:231], v[64:67]
    ds_read_b64_tr_b16 v[148:149], v12 offset:12288
    v_mfma_f32_16x16x32_bf16 v[68:71], v[216:219], v[232:235], v[68:71]
    ds_read_b64_tr_b16 v[150:151], v12 offset:12800
    s_add_u32 m0, s37, 145408
    s_add_u32 s38, s52, 2048
    buffer_load_dwordx4 v7, s[12:15], s38 offen lds
    v_mfma_f32_16x16x32_bf16 v[72:75], v[216:219], v[236:239], v[72:75]
    ds_read_b128 v[120:123], v9 offset:2048
    v_mfma_f32_16x16x32_bf16 v[76:79], v[216:219], v[240:243], v[76:79]
    ds_read_b128 v[124:127], v9 offset:4096
    v_mfma_f32_16x16x32_bf16 v[80:83], v[216:219], v[244:247], v[80:83]
    ds_read_b128 v[128:131], v9 offset:6144
    s_add_u32 m0, s37, 102400
    s_nop 0
    buffer_load_dwordx4 v4, s[8:11], s44 offen lds
    v_mfma_f32_16x16x32_bf16 v[84:87], v[216:219], v[248:251], v[84:87]
    ds_read_b128 v[132:135], v9 offset:8192
    v_mfma_f32_16x16x32_bf16 v[36:39], v[212:215], v[228:231], v[36:39]
    ds_read_b128 v[136:139], v9 offset:10240
    v_mfma_f32_16x16x32_bf16 v[40:43], v[212:215], v[232:235], v[40:43]
    ds_read_b128 v[140:143], v9 offset:12288
    s_add_u32 m0, s37, 110592
    s_nop 0
    buffer_load_dwordx4 v5, s[8:11], s44 offen lds
    v_mfma_f32_16x16x32_bf16 v[44:47], v[212:215], v[236:239], v[44:47]
    s_setprio 0
    ds_read_b64_tr_b16 v[144:145], v12 offset:4096
    v_mfma_f32_16x16x32_bf16 v[48:51], v[212:215], v[240:243], v[48:51]
    ds_read_b64_tr_b16 v[146:147], v12 offset:4608
    v_mfma_f32_16x16x32_bf16 v[52:55], v[212:215], v[244:247], v[52:55]
    ds_read_b64_tr_b16 v[152:153], v12 offset:20480
    s_add_u32 m0, s37, 118784
    s_nop 0
    buffer_load_dwordx4 v6, s[8:11], s44 offen lds
    v_mfma_f32_16x16x32_bf16 v[56:59], v[212:215], v[248:251], v[56:59]
    ds_read_b64_tr_b16 v[154:155], v12 offset:20992
    v_mfma_f32_16x16x32_bf16 v[92:95], v[228:231], v[220:223], v[92:95]
    v_mfma_f32_16x16x32_bf16 v[96:99], v[232:235], v[220:223], v[96:99]
    v_mfma_f32_16x16x32_bf16 v[100:103], v[236:239], v[220:223], v[100:103]
    v_mfma_f32_16x16x32_bf16 v[104:107], v[240:243], v[220:223], v[104:107]
    v_mfma_f32_16x16x32_bf16 v[108:111], v[244:247], v[220:223], v[108:111]
    v_mfma_f32_16x16x32_bf16 v[112:115], v[248:251], v[220:223], v[112:115]
    s_waitcnt lgkmcnt(0)
    s_waitcnt vmcnt(6)
    s_barrier
    s_setprio 3
    v_mfma_f32_16x16x32_bf16 v[64:67], v[148:151], v[120:123], v[64:67]
    ds_read_b64_tr_b16 v[216:217], v10 offset:8192
    s_add_u32 m0, s37, 26624
    s_add_u32 s38, s53, 0
    buffer_load_dwordx4 v7, s[12:15], s38 offen lds
    v_mfma_f32_16x16x32_bf16 v[68:71], v[148:151], v[124:127], v[68:71]
    ds_read_b64_tr_b16 v[218:219], v10 offset:8704
    v_mfma_f32_16x16x32_bf16 v[72:75], v[148:151], v[128:131], v[72:75]
    ds_read_b128 v[228:231], v8 offset:53248
    v_mfma_f32_16x16x32_bf16 v[76:79], v[148:151], v[132:135], v[76:79]
    ds_read_b128 v[232:235], v8 offset:55296
    v_mfma_f32_16x16x32_bf16 v[80:83], v[148:151], v[136:139], v[80:83]
    ds_read_b128 v[236:239], v8 offset:57344
    v_mfma_f32_16x16x32_bf16 v[84:87], v[148:151], v[140:143], v[84:87]
    ds_read_b128 v[240:243], v8 offset:59392
    v_mfma_f32_16x16x32_bf16 v[36:39], v[144:147], v[120:123], v[36:39]
    ds_read_b128 v[244:247], v8 offset:61440
    v_mfma_f32_16x16x32_bf16 v[40:43], v[144:147], v[124:127], v[40:43]
    ds_read_b128 v[248:251], v8 offset:63488
    v_mfma_f32_16x16x32_bf16 v[44:47], v[144:147], v[128:131], v[44:47]
    s_setprio 2
    ds_read_b64_tr_b16 v[212:213], v10 offset:0
    v_mfma_f32_16x16x32_bf16 v[48:51], v[144:147], v[132:135], v[48:51]
    global_load_dword v33, v31, s[88:89]
    global_load_dword v34, v32, s[82:83]
    ds_read_b64_tr_b16 v[214:215], v10 offset:512
    s_add_u32 m0, s37, 34816
    s_add_u32 s38, s53, 1024
    buffer_load_dwordx4 v7, s[12:15], s38 offen lds
    v_mfma_f32_16x16x32_bf16 v[52:55], v[144:147], v[136:139], v[52:55]
    ds_read_b64_tr_b16 v[220:221], v10 offset:16384
    v_mfma_f32_16x16x32_bf16 v[56:59], v[144:147], v[140:143], v[56:59]
    ds_read_b64_tr_b16 v[222:223], v10 offset:16896
    v_mfma_f32_16x16x32_bf16 v[92:95], v[120:123], v[152:155], v[92:95]
    v_mfma_f32_16x16x32_bf16 v[96:99], v[124:127], v[152:155], v[96:99]
    v_mfma_f32_16x16x32_bf16 v[100:103], v[128:131], v[152:155], v[100:103]
    v_mfma_f32_16x16x32_bf16 v[104:107], v[132:135], v[152:155], v[104:107]
    v_mfma_f32_16x16x32_bf16 v[108:111], v[136:139], v[152:155], v[108:111]
    v_mfma_f32_16x16x32_bf16 v[112:115], v[140:143], v[152:155], v[112:115]
    s_waitcnt lgkmcnt(0)
    s_setprio 1
    v_mfma_f32_16x16x32_bf16 v[64:67], v[216:219], v[228:231], v[64:67]
    ds_read_b64_tr_b16 v[148:149], v10 offset:12288
    v_mfma_f32_16x16x32_bf16 v[68:71], v[216:219], v[232:235], v[68:71]
    ds_read_b64_tr_b16 v[150:151], v10 offset:12800
    s_add_u32 m0, s37, 43008
    s_add_u32 s38, s53, 2048
    buffer_load_dwordx4 v7, s[12:15], s38 offen lds
    v_mfma_f32_16x16x32_bf16 v[72:75], v[216:219], v[236:239], v[72:75]
    ds_read_b128 v[120:123], v9 offset:53248
    v_mfma_f32_16x16x32_bf16 v[76:79], v[216:219], v[240:243], v[76:79]
    ds_read_b128 v[124:127], v9 offset:55296
    v_mfma_f32_16x16x32_bf16 v[80:83], v[216:219], v[244:247], v[80:83]
    ds_read_b128 v[128:131], v9 offset:57344
    s_add_u32 m0, s37, 0
    s_nop 0
    buffer_load_dwordx4 v4, s[8:11], s45 offen lds
    v_mfma_f32_16x16x32_bf16 v[84:87], v[216:219], v[248:251], v[84:87]
    ds_read_b128 v[132:135], v9 offset:59392
    v_mfma_f32_16x16x32_bf16 v[36:39], v[212:215], v[228:231], v[36:39]
    ds_read_b128 v[136:139], v9 offset:61440
    v_mfma_f32_16x16x32_bf16 v[40:43], v[212:215], v[232:235], v[40:43]
    ds_read_b128 v[140:143], v9 offset:63488
    s_add_u32 m0, s37, 8192
    s_nop 0
    buffer_load_dwordx4 v5, s[8:11], s45 offen lds
    v_mfma_f32_16x16x32_bf16 v[44:47], v[212:215], v[236:239], v[44:47]
    s_setprio 0
    ds_read_b64_tr_b16 v[144:145], v10 offset:4096
    v_mfma_f32_16x16x32_bf16 v[48:51], v[212:215], v[240:243], v[48:51]
    ds_read_b64_tr_b16 v[146:147], v10 offset:4608
    v_mfma_f32_16x16x32_bf16 v[52:55], v[212:215], v[244:247], v[52:55]
    ds_read_b64_tr_b16 v[152:153], v10 offset:20480
    s_add_u32 m0, s37, 16384
    s_nop 0
    buffer_load_dwordx4 v6, s[8:11], s45 offen lds
    v_mfma_f32_16x16x32_bf16 v[56:59], v[212:215], v[248:251], v[56:59]
    ds_read_b64_tr_b16 v[154:155], v10 offset:20992
    v_mfma_f32_16x16x32_bf16 v[92:95], v[228:231], v[220:223], v[92:95]
    v_mfma_f32_16x16x32_bf16 v[96:99], v[232:235], v[220:223], v[96:99]
    v_mfma_f32_16x16x32_bf16 v[100:103], v[236:239], v[220:223], v[100:103]
    v_mfma_f32_16x16x32_bf16 v[104:107], v[240:243], v[220:223], v[104:107]
    v_mfma_f32_16x16x32_bf16 v[108:111], v[244:247], v[220:223], v[108:111]
    v_mfma_f32_16x16x32_bf16 v[112:115], v[248:251], v[220:223], v[112:115]
    s_waitcnt lgkmcnt(0)
    s_waitcnt vmcnt(8)
    s_barrier
    s_setprio 3
    v_mfma_f32_16x16x32_bf16 v[64:67], v[148:151], v[120:123], v[64:67]
    ds_read_b64_tr_b16 v[216:217], v11 offset:8192
    v_mfma_f32_16x16x32_bf16 v[68:71], v[148:151], v[124:127], v[68:71]
    ds_read_b64_tr_b16 v[218:219], v11 offset:8704
    v_mfma_f32_16x16x32_bf16 v[72:75], v[148:151], v[128:131], v[72:75]
    ds_read_b128 v[228:231], v18 offset:2048
    buffer_load_dword v156, v28, s[24:27], 0 offen offset:0 sc1
    v_mfma_f32_16x16x32_bf16 v[76:79], v[148:151], v[132:135], v[76:79]
    ds_read_b128 v[232:235], v18 offset:4096
    v_mfma_f32_16x16x32_bf16 v[80:83], v[148:151], v[136:139], v[80:83]
    ds_read_b128 v[236:239], v18 offset:6144
    v_mfma_f32_16x16x32_bf16 v[84:87], v[148:151], v[140:143], v[84:87]
    ds_read_b128 v[240:243], v18 offset:8192
    v_mfma_f32_16x16x32_bf16 v[36:39], v[144:147], v[120:123], v[36:39]
    ds_read_b128 v[244:247], v18 offset:10240
    buffer_load_dword v157, v28, s[24:27], 0 offen offset:256 sc1
    v_mfma_f32_16x16x32_bf16 v[40:43], v[144:147], v[124:127], v[40:43]
    ds_read_b128 v[248:251], v18 offset:12288
    v_mfma_f32_16x16x32_bf16 v[44:47], v[144:147], v[128:131], v[44:47]
    s_setprio 2
    ds_read_b64_tr_b16 v[212:213], v11 offset:0
    v_mfma_f32_16x16x32_bf16 v[48:51], v[144:147], v[132:135], v[48:51]
    ds_read_b64_tr_b16 v[214:215], v11 offset:512
    v_mfma_f32_16x16x32_bf16 v[52:55], v[144:147], v[136:139], v[52:55]
    ds_read_b64_tr_b16 v[220:221], v11 offset:16384
    s_add_u32 m0, s37, 77824
    s_add_u32 s38, s54, 0
    buffer_load_dwordx4 v7, s[12:15], s38 offen lds
    v_mfma_f32_16x16x32_bf16 v[56:59], v[144:147], v[140:143], v[56:59]
    ds_read_b64_tr_b16 v[222:223], v11 offset:16896
    v_mfma_f32_16x16x32_bf16 v[92:95], v[120:123], v[152:155], v[92:95]
    v_mfma_f32_16x16x32_bf16 v[96:99], v[124:127], v[152:155], v[96:99]
    v_mfma_f32_16x16x32_bf16 v[100:103], v[128:131], v[152:155], v[100:103]
    s_add_u32 m0, s37, 86016
    s_add_u32 s38, s54, 1024
    buffer_load_dwordx4 v7, s[12:15], s38 offen lds
    v_mfma_f32_16x16x32_bf16 v[104:107], v[132:135], v[152:155], v[104:107]
    v_mfma_f32_16x16x32_bf16 v[108:111], v[136:139], v[152:155], v[108:111]
    v_mfma_f32_16x16x32_bf16 v[112:115], v[140:143], v[152:155], v[112:115]
    s_waitcnt lgkmcnt(0)
    s_setprio 1
    v_mfma_f32_16x16x32_bf16 v[64:67], v[216:219], v[228:231], v[64:67]
    buffer_load_dword v158, v28, s[24:27], 0 offen offset:512 sc1
    ds_read_b64_tr_b16 v[148:149], v11 offset:12288
    v_mfma_f32_16x16x32_bf16 v[68:71], v[216:219], v[232:235], v[68:71]
    ds_read_b64_tr_b16 v[150:151], v11 offset:12800
    s_add_u32 m0, s37, 94208
    s_add_u32 s38, s54, 2048
    buffer_load_dwordx4 v7, s[12:15], s38 offen lds
    v_mfma_f32_16x16x32_bf16 v[72:75], v[216:219], v[236:239], v[72:75]
    ds_read_b128 v[120:123], v19 offset:2048
    v_mfma_f32_16x16x32_bf16 v[76:79], v[216:219], v[240:243], v[76:79]
    ds_read_b128 v[124:127], v19 offset:4096
    v_mfma_f32_16x16x32_bf16 v[80:83], v[216:219], v[244:247], v[80:83]
    ds_read_b128 v[128:131], v19 offset:6144
    s_add_u32 m0, s37, 51200
    s_nop 0
    buffer_load_dwordx4 v4, s[8:11], s46 offen lds
    v_mfma_f32_16x16x32_bf16 v[84:87], v[216:219], v[248:251], v[84:87]
    ds_read_b128 v[132:135], v19 offset:8192
    v_mfma_f32_16x16x32_bf16 v[36:39], v[212:215], v[228:231], v[36:39]
    ds_read_b128 v[136:139], v19 offset:10240
    v_mfma_f32_16x16x32_bf16 v[40:43], v[212:215], v[232:235], v[40:43]
    ds_read_b128 v[140:143], v19 offset:12288
    s_add_u32 m0, s37, 59392
    s_nop 0
    buffer_load_dwordx4 v5, s[8:11], s46 offen lds
    v_mfma_f32_16x16x32_bf16 v[44:47], v[212:215], v[236:239], v[44:47]
    s_setprio 0
    ds_read_b64_tr_b16 v[144:145], v11 offset:4096
    v_mfma_f32_16x16x32_bf16 v[48:51], v[212:215], v[240:243], v[48:51]
    ds_read_b64_tr_b16 v[146:147], v11 offset:4608
    v_mfma_f32_16x16x32_bf16 v[52:55], v[212:215], v[244:247], v[52:55]
    ds_read_b64_tr_b16 v[152:153], v11 offset:20480
    s_add_u32 m0, s37, 67584
    s_nop 0
    buffer_load_dwordx4 v6, s[8:11], s46 offen lds
    v_mfma_f32_16x16x32_bf16 v[56:59], v[212:215], v[248:251], v[56:59]
    ds_read_b64_tr_b16 v[154:155], v11 offset:20992
    v_mfma_f32_16x16x32_bf16 v[92:95], v[228:231], v[220:223], v[92:95]
    buffer_load_dword v159, v28, s[24:27], 0 offen offset:768 sc1
    v_mfma_f32_16x16x32_bf16 v[96:99], v[232:235], v[220:223], v[96:99]
    v_mfma_f32_16x16x32_bf16 v[100:103], v[236:239], v[220:223], v[100:103]
    v_mfma_f32_16x16x32_bf16 v[104:107], v[240:243], v[220:223], v[104:107]
    v_mfma_f32_16x16x32_bf16 v[108:111], v[244:247], v[220:223], v[108:111]
    v_mfma_f32_16x16x32_bf16 v[112:115], v[248:251], v[220:223], v[112:115]
    s_waitcnt lgkmcnt(0)
    s_waitcnt vmcnt(10)
    s_barrier
    s_setprio 3
    v_mfma_f32_16x16x32_bf16 v[64:67], v[148:151], v[120:123], v[64:67]
    ds_read_b64_tr_b16 v[216:217], v12 offset:8192
    s_add_u32 m0, s37, 129024
    s_add_u32 s38, s55, 0
    buffer_load_dwordx4 v7, s[12:15], s38 offen lds
    v_mfma_f32_16x16x32_bf16 v[68:71], v[148:151], v[124:127], v[68:71]
    ds_read_b64_tr_b16 v[218:219], v12 offset:8704
    v_mfma_f32_16x16x32_bf16 v[72:75], v[148:151], v[128:131], v[72:75]
    ds_read_b128 v[228:231], v8 offset:2048
    v_mfma_f32_16x16x32_bf16 v[76:79], v[148:151], v[132:135], v[76:79]
    ds_read_b128 v[232:235], v8 offset:4096
    v_mfma_f32_16x16x32_bf16 v[80:83], v[148:151], v[136:139], v[80:83]
    ds_read_b128 v[236:239], v8 offset:6144
    v_mfma_f32_16x16x32_bf16 v[84:87], v[148:151], v[140:143], v[84:87]
    ds_read_b128 v[240:243], v8 offset:8192
    v_mfma_f32_16x16x32_bf16 v[36:39], v[144:147], v[120:123], v[36:39]
    ds_read_b128 v[244:247], v8 offset:10240
    v_mfma_f32_16x16x32_bf16 v[40:43], v[144:147], v[124:127], v[40:43]
    ds_read_b128 v[248:251], v8 offset:12288
    v_mfma_f32_16x16x32_bf16 v[44:47], v[144:147], v[128:131], v[44:47]
    s_setprio 2
    ds_read_b64_tr_b16 v[212:213], v12 offset:0
    v_mfma_f32_16x16x32_bf16 v[48:51], v[144:147], v[132:135], v[48:51]
    ds_read_b64_tr_b16 v[214:215], v12 offset:512
    s_add_u32 m0, s37, 137216
    s_add_u32 s38, s55, 1024
    buffer_load_dwordx4 v7, s[12:15], s38 offen lds
    v_mfma_f32_16x16x32_bf16 v[52:55], v[144:147], v[136:139], v[52:55]
    ds_read_b64_tr_b16 v[220:221], v12 offset:16384
    v_mfma_f32_16x16x32_bf16 v[56:59], v[144:147], v[140:143], v[56:59]
    ds_read_b64_tr_b16 v[222:223], v12 offset:16896
    v_mfma_f32_16x16x32_bf16 v[92:95], v[120:123], v[152:155], v[92:95]
    v_mfma_f32_16x16x32_bf16 v[96:99], v[124:127], v[152:155], v[96:99]
    v_mfma_f32_16x16x32_bf16 v[100:103], v[128:131], v[152:155], v[100:103]
    v_mfma_f32_16x16x32_bf16 v[104:107], v[132:135], v[152:155], v[104:107]
    v_mfma_f32_16x16x32_bf16 v[108:111], v[136:139], v[152:155], v[108:111]
    v_mfma_f32_16x16x32_bf16 v[112:115], v[140:143], v[152:155], v[112:115]
    s_waitcnt lgkmcnt(0)
    s_setprio 1
    v_mfma_f32_16x16x32_bf16 v[64:67], v[216:219], v[228:231], v[64:67]
    ds_read_b64_tr_b16 v[148:149], v12 offset:12288
    v_mfma_f32_16x16x32_bf16 v[68:71], v[216:219], v[232:235], v[68:71]
    ds_read_b64_tr_b16 v[150:151], v12 offset:12800
    s_add_u32 m0, s37, 145408
    s_add_u32 s38, s55, 2048
    buffer_load_dwordx4 v7, s[12:15], s38 offen lds
    v_mfma_f32_16x16x32_bf16 v[72:75], v[216:219], v[236:239], v[72:75]
    ds_read_b128 v[120:123], v9 offset:2048
    v_mfma_f32_16x16x32_bf16 v[76:79], v[216:219], v[240:243], v[76:79]
    ds_read_b128 v[124:127], v9 offset:4096
    v_mfma_f32_16x16x32_bf16 v[80:83], v[216:219], v[244:247], v[80:83]
    ds_read_b128 v[128:131], v9 offset:6144
    s_add_u32 m0, s37, 102400
    s_nop 0
    buffer_load_dwordx4 v4, s[8:11], s47 offen lds
    v_mfma_f32_16x16x32_bf16 v[84:87], v[216:219], v[248:251], v[84:87]
    ds_read_b128 v[132:135], v9 offset:8192
    v_mfma_f32_16x16x32_bf16 v[36:39], v[212:215], v[228:231], v[36:39]
    ds_read_b128 v[136:139], v9 offset:10240
    v_mfma_f32_16x16x32_bf16 v[40:43], v[212:215], v[232:235], v[40:43]
    ds_read_b128 v[140:143], v9 offset:12288
    s_add_u32 m0, s37, 110592
    s_nop 0
    buffer_load_dwordx4 v5, s[8:11], s47 offen lds
    v_mfma_f32_16x16x32_bf16 v[44:47], v[212:215], v[236:239], v[44:47]
    s_setprio 0
    ds_read_b64_tr_b16 v[144:145], v12 offset:4096
    v_mfma_f32_16x16x32_bf16 v[48:51], v[212:215], v[240:243], v[48:51]
    ds_read_b64_tr_b16 v[146:147], v12 offset:4608
    v_mfma_f32_16x16x32_bf16 v[52:55], v[212:215], v[244:247], v[52:55]
    ds_read_b64_tr_b16 v[152:153], v12 offset:20480
    s_add_u32 m0, s37, 118784
    s_nop 0
    buffer_load_dwordx4 v6, s[8:11], s47 offen lds
    v_mfma_f32_16x16x32_bf16 v[56:59], v[212:215], v[248:251], v[56:59]
    ds_read_b64_tr_b16 v[154:155], v12 offset:20992
    v_mfma_f32_16x16x32_bf16 v[92:95], v[228:231], v[220:223], v[92:95]
    v_mfma_f32_16x16x32_bf16 v[96:99], v[232:235], v[220:223], v[96:99]
    v_mfma_f32_16x16x32_bf16 v[100:103], v[236:239], v[220:223], v[100:103]
    v_mfma_f32_16x16x32_bf16 v[104:107], v[240:243], v[220:223], v[104:107]
    v_mfma_f32_16x16x32_bf16 v[108:111], v[244:247], v[220:223], v[108:111]
    v_mfma_f32_16x16x32_bf16 v[112:115], v[248:251], v[220:223], v[112:115]
    s_waitcnt lgkmcnt(0)
    s_waitcnt vmcnt(6)
    s_mov_b32 s98, 0
PC_chk_46:
    v_and_b32 v172, v156, v157
    v_and_b32 v173, v158, v159
    v_and_b32 v172, v172, v173
    v_and_b32 v172, 1, v172
    v_cmp_eq_u32 vcc, 0, v172
    s_nop 0
    s_and_b64 vcc, vcc, s[100:101]
    s_cbranch_scc0 PC_ok_45
    s_add_u32 s98, s98, 1
    s_cmp_ge_u32 s98, 100000
    s_cbranch_scc1 PC_ok_45
    s_sleep 2
    buffer_load_dword v156, v28, s[24:27], 0 offen offset:0 sc1
    buffer_load_dword v157, v28, s[24:27], 0 offen offset:256 sc1
    buffer_load_dword v158, v28, s[24:27], 0 offen offset:512 sc1
    buffer_load_dword v159, v28, s[24:27], 0 offen offset:768 sc1
    s_waitcnt vmcnt(0)
    s_branch PC_chk_46
PC_ok_45:
    s_barrier
    s_setprio 3
    v_mfma_f32_16x16x32_bf16 v[64:67], v[148:151], v[120:123], v[64:67]
    s_add_u32 m0, s76, 0
    s_add_u32 s85, s75, 0
    s_and_b32 s85, s85, 15
    s_lshl_b32 s85, s85, 15
    buffer_load_dwordx4 v30, s[32:35], s85 offen lds
    ds_read_b64_tr_b16 v[216:217], v10 offset:8192
    v_mfma_f32_16x16x32_bf16 v[68:71], v[148:151], v[124:127], v[68:71]
    s_add_u32 m0, s76, 1024
    s_add_u32 s85, s85, s81
    buffer_load_dwordx4 v30, s[32:35], s85 offen lds
    ds_read_b64_tr_b16 v[218:219], v10 offset:8704
    v_mfma_f32_16x16x32_bf16 v[72:75], v[148:151], v[128:131], v[72:75]
    ds_read_b128 v[228:231], v8 offset:53248
    v_add_f32 v156, v156, v157
    v_add_f32 v158, v158, v159
    v_mfma_f32_16x16x32_bf16 v[76:79], v[148:151], v[132:135], v[76:79]
    ds_read_b128 v[232:235], v8 offset:55296
    v_mfma_f32_16x16x32_bf16 v[80:83], v[148:151], v[136:139], v[80:83]
    ds_read_b128 v[236:239], v8 offset:57344
    v_add_f32 v156, v156, v158
    v_cvt_pk_bf16_f32 v158, v156, v156
    v_mfma_f32_16x16x32_bf16 v[84:87], v[148:151], v[140:143], v[84:87]
    ds_read_b128 v[240:243], v8 offset:59392
    v_mfma_f32_16x16x32_bf16 v[36:39], v[144:147], v[120:123], v[36:39]
    ds_read_b128 v[244:247], v8 offset:61440
    v_lshlrev_b32 v157, 16, v158
    v_sub_f32 v156, v156, v157
    v_mfma_f32_16x16x32_bf16 v[40:43], v[144:147], v[124:127], v[40:43]
    ds_read_b128 v[248:251], v8 offset:63488
    v_mfma_f32_16x16x32_bf16 v[44:47], v[144:147], v[128:131], v[44:47]
    s_setprio 2
    ds_read_b64_tr_b16 v[212:213], v10 offset:0
    v_cvt_pk_bf16_f32 v160, v156, v156
    v_lshlrev_b32 v157, 16, v160
    v_mfma_f32_16x16x32_bf16 v[48:51], v[144:147], v[132:135], v[48:51]
    ds_read_b64_tr_b16 v[214:215], v10 offset:512
    v_mfma_f32_16x16x32_bf16 v[52:55], v[144:147], v[136:139], v[52:55]
    ds_read_b64_tr_b16 v[220:221], v10 offset:16384
    v_sub_f32 v156, v156, v157
    v_cvt_pk_bf16_f32 v159, v156, v156
    v_mfma_f32_16x16x32_bf16 v[56:59], v[144:147], v[140:143], v[56:59]
    ds_read_b64_tr_b16 v[222:223], v10 offset:16896
    v_mfma_f32_16x16x32_bf16 v[92:95], v[120:123], v[152:155], v[92:95]
    v_and_b32 v158, 0xffff, v158
    v_or_b32 v158, v158, v157
    v_mfma_f32_16x16x32_bf16 v[96:99], v[124:127], v[152:155], v[96:99]
    v_mfma_f32_16x16x32_bf16 v[100:103], v[128:131], v[152:155], v[100:103]
    v_and_b32 v159, 0xffff, v159
    ds_write_b64 v29, v[158:159]
    v_mfma_f32_16x16x32_bf16 v[104:107], v[132:135], v[152:155], v[104:107]
    v_mfma_f32_16x16x32_bf16 v[108:111], v[136:139], v[152:155], v[108:111]
    s_add_u32 m0, s76, 16384
    s_add_u32 s85, s75, 1
    s_and_b32 s85, s85, 15
    s_lshl_b32 s85, s85, 15
    buffer_load_dwordx4 v30, s[32:35], s85 offen lds
    v_mfma_f32_16x16x32_bf16 v[112:115], v[140:143], v[152:155], v[112:115]
    s_waitcnt lgkmcnt(0)
    s_setprio 1
    v_mfma_f32_16x16x32_bf16 v[64:67], v[216:219], v[228:231], v[64:67]
    s_add_u32 m0, s76, 17408
    s_add_u32 s85, s85, s81
    buffer_load_dwordx4 v30, s[32:35], s85 offen lds
    ds_read_b64_tr_b16 v[148:149], v10 offset:12288
    v_mfma_f32_16x16x32_bf16 v[68:71], v[216:219], v[232:235], v[68:71]
    s_add_u32 m0, s76, 32768
    s_add_u32 s85, s75, 2
    s_and_b32 s85, s85, 15
    s_lshl_b32 s85, s85, 15
    buffer_load_dwordx4 v30, s[32:35], s85 offen lds
    ds_read_b64_tr_b16 v[150:151], v10 offset:12800
    v_mfma_f32_16x16x32_bf16 v[72:75], v[216:219], v[236:239], v[72:75]
    s_add_u32 m0, s76, 33792
    s_add_u32 s85, s85, s81
    buffer_load_dwordx4 v30, s[32:35], s85 offen lds
    ds_read_b128 v[120:123], v9 offset:53248
    v_mfma_f32_16x16x32_bf16 v[76:79], v[216:219], v[240:243], v[76:79]
    ds_read_b128 v[124:127], v9 offset:55296
    v_lshrrev_b32 v26, 4, v1
    v_bfe_u32 v27, v1, 2, 2
    s_lshl_b32 s6, s77, 14
    s_lshl_b32 s7, s75, 10
    v_mfma_f32_16x16x32_bf16 v[80:83], v[216:219], v[244:247], v[80:83]
    ds_read_b128 v[128:131], v9 offset:57344
    v_and_b32 v28, 1, v26
    v_lshlrev_b32 v28, 1, v28
    s_add_u32 s40, s7, 0
    s_and_b32 s40, s40, 0x3c00
    s_or_b32 s40, s40, s6
    s_add_u32 s41, s7, 1024
    s_and_b32 s41, s41, 0x3c00
    s_or_b32 s41, s41, s6
    v_mfma_f32_16x16x32_bf16 v[84:87], v[216:219], v[248:251], v[84:87]
    ds_read_b128 v[132:135], v9 offset:59392
    v_lshrrev_b32 v29, 1, v27
    v_or_b32 v28, v28, v29
    s_add_u32 s42, s7, 2048
    s_and_b32 s42, s42, 0x3c00
    s_or_b32 s42, s42, s6
    s_add_u32 s43, s7, 3072
    s_and_b32 s43, s43, 0x3c00
    s_or_b32 s43, s43, s6
    v_mfma_f32_16x16x32_bf16 v[36:39], v[212:215], v[228:231], v[36:39]
    ds_read_b128 v[136:139], v9 offset:61440
    v_lshlrev_b32 v28, 5, v28
    v_and_b32 v29, 3, v1
    s_add_u32 s44, s7, 4096
    s_and_b32 s44, s44, 0x3c00
    s_or_b32 s44, s44, s6
    s_add_u32 s45, s7, 5120
    s_and_b32 s45, s45, 0x3c00
    s_or_b32 s45, s45, s6
    v_mfma_f32_16x16x32_bf16 v[40:43], v[212:215], v[232:235], v[40:43]
    ds_read_b128 v[140:143], v9 offset:63488
    v_lshl_add_u32 v28, v29, 3, v28
    v_lshl_add_u32 v29, v26, 2, v27
    s_add_u32 s46, s7, 6144
    s_and_b32 s46, s46, 0x3c00
    s_or_b32 s46, s46, s6
    s_add_u32 s47, s7, 7168
    s_and_b32 s47, s47, 0x3c00
    s_or_b32 s47, s47, s6
    v_mfma_f32_16x16x32_bf16 v[44:47], v[212:215], v[236:239], v[44:47]
    s_setprio 0
    ds_read_b64_tr_b16 v[144:145], v10 offset:4096
    v_lshl_add_u32 v28, v29, 7, v28
    s_lshl_b32 s86, s77, 12
    v_add_u32 v20, s86, v28
    v_mfma_f32_16x16x32_bf16 v[48:51], v[212:215], v[240:243], v[48:51]
    ds_read_b64_tr_b16 v[146:147], v10 offset:4608
    v_xor_b32 v21, 32, v20
    v_xor_b32 v22, 64, v20
    s_add_u32 s48, s7, 8192
    s_and_b32 s48, s48, 0x3c00
    s_or_b32 s48, s48, s6
    s_add_u32 s49, s7, 9216
    s_and_b32 s49, s49, 0x3c00
    s_or_b32 s49, s49, s6
    v_mfma_f32_16x16x32_bf16 v[52:55], v[212:215], v[244:247], v[52:55]
    ds_read_b64_tr_b16 v[152:153], v10 offset:20480
    v_xor_b32 v23, 0x60, v20
    v_and_b32 v28, 0x3ff, v35
    s_add_u32 s50, s7, 10240
    s_and_b32 s50, s50, 0x3c00
    s_or_b32 s50, s50, s6
    s_add_u32 s51, s7, 11264
    s_and_b32 s51, s51, 0x3c00
    s_or_b32 s51, s51, s6
    v_mfma_f32_16x16x32_bf16 v[56:59], v[212:215], v[248:251], v[56:59]
    ds_read_b64_tr_b16 v[154:155], v10 offset:20992
    s_lshl_b32 s86, s77, 16
    s_lshl_b32 s87, s78, 14
    s_add_u32 s86, s86, s87
    s_add_u32 s86, s86, 1572864
    v_lshrrev_b32 v29, 3, v1
    v_lshl_add_u32 v28, v29, 10, v28
    v_mfma_f32_16x16x32_bf16 v[92:95], v[228:231], v[220:223], v[92:95]
    v_add_u32 v31, s86, v28
    s_lshl_b32 s86, s79, 2
    s_lshl_b32 s87, s78, 1
    s_add_u32 s86, s86, s87
    s_mul_i32 s87, s86, 74752
    v_mfma_f32_16x16x32_bf16 v[96:99], v[232:235], v[220:223], v[96:99]
    v_lshl_add_u32 v4, v1, 4, s87
    v_add_u32 v5, 74752, v4
    s_add_u32 s52, s7, 12288
    s_and_b32 s52, s52, 0x3c00
    s_or_b32 s52, s52, s6
    s_add_u32 s53, s7, 13312
    s_and_b32 s53, s53, 0x3c00
    s_or_b32 s53, s53, s6
    v_mfma_f32_16x16x32_bf16 v[100:103], v[236:239], v[220:223], v[100:103]
    v_lshrrev_b32 v26, 1, v1
    v_add_u32 v26, s75, v26
    v_and_b32 v26, 15, v26
    s_add_u32 s54, s7, 14336
    s_and_b32 s54, s54, 0x3c00
    s_or_b32 s54, s54, s6
    s_add_u32 s55, s7, 15360
    s_and_b32 s55, s55, 0x3c00
    s_or_b32 s55, s55, s6
    v_mfma_f32_16x16x32_bf16 v[104:107], v[240:243], v[220:223], v[104:107]
    v_and_b32 v27, 1, v1
    v_add_u32 v27, s86, v27
    s_lshl_b32 s6, s77, 11
    s_add_u32 s59, s6, 65536
    s_add_u32 s60, s6, 66560
    v_mfma_f32_16x16x32_bf16 v[108:111], v[244:247], v[220:223], v[108:111]
    v_add_u32 v28, 2, v27
    v_mul_u32_u24 v28, 6554, v28
    v_lshrrev_b32 v28, 16, v28
    s_mov_b32 s16, s90
    s_mov_b32 s17, s91
    s_mov_b32 s18, 2097152
    s_mov_b32 s19, 0x20000
    v_mfma_f32_16x16x32_bf16 v[112:115], v[248:251], v[220:223], v[112:115]
    v_mul_u32_u24 v27, 5958, v27
    v_lshrrev_b32 v27, 16, v27
    s_mov_b32 s12, s88
    s_mov_b32 s13, s89
    s_mov_b32 s14, 1835008
    s_mov_b32 s15, 0x20000
    s_waitcnt lgkmcnt(0)
    s_waitcnt vmcnt(6)
    s_barrier
    s_setprio 1
    s_add_u32 m0, s76, 49152
    s_add_u32 s85, s75, 3
    s_and_b32 s85, s85, 15
    s_lshl_b32 s85, s85, 15
    buffer_load_dwordx4 v30, s[32:35], s85 offen lds
    s_add_u32 m0, s76, 47104
    s_nop 0
    buffer_load_dwordx4 v35, s[32:35], s85 offen lds
    s_add_u32 m0, s76, 50176
    s_add_u32 s85, s85, s81
    buffer_load_dwordx4 v30, s[32:35], s85 offen lds
    s_add_u32 m0, s76, 48128
    s_nop 0
    buffer_load_dwordx4 v35, s[32:35], s85 offen lds
    s_add_u32 m0, s76, 65536
    s_add_u32 s85, s75, 4
    s_and_b32 s85, s85, 15
    s_lshl_b32 s85, s85, 15
    buffer_load_dwordx4 v30, s[32:35], s85 offen lds
    s_add_u32 m0, s76, 63488
    s_nop 0
    buffer_load_dwordx4 v35, s[32:35], s85 offen lds
    s_add_u32 m0, s76, 66560
    s_add_u32 s85, s85, s81
    buffer_load_dwordx4 v30, s[32:35], s85 offen lds
    s_add_u32 m0, s76, 64512
    s_nop 0
    buffer_load_dwordx4 v35, s[32:35], s85 offen lds
    s_add_u32 m0, s76, 81920
    s_add_u32 s85, s75, 5
    s_and_b32 s85, s85, 15
    s_lshl_b32 s85, s85, 15
    buffer_load_dwordx4 v30, s[32:35], s85 offen lds
    s_add_u32 m0, s76, 79872
    s_nop 0
    buffer_load_dwordx4 v35, s[32:35], s85 offen lds
    s_add_u32 m0, s76, 82944
    s_add_u32 s85, s85, s81
    buffer_load_dwordx4 v30, s[32:35], s85 offen lds
    s_add_u32 m0, s76, 80896
    s_nop 0
    buffer_load_dwordx4 v35, s[32:35], s85 offen lds
    v_mfma_f32_16x16x32_bf16 v[64:67], v[148:151], v[120:123], v[64:67]
    ds_read_b64_tr_b16 v[216:217], v11 offset:8192
    v_add_u32 v28, -1, v28
    v_max_i32 v27, v27, v28
    v_mul_u32_u24 v27, 14, v27
    v_lshrrev_b32 v28, 2, v26
    s_lshl_b32 s99, s77, 2
    s_sub_u32 s99, s99, 4
    v_mfma_f32_16x16x32_bf16 v[68:71], v[148:151], v[124:127], v[68:71]
    ds_read_b64_tr_b16 v[218:219], v11 offset:8704
    v_add3_u32 v28, v28, s99, v27
    s_mul_i32 s86, s79, 21846
    s_lshr_b32 s86, s86, 16
    s_lshl_b32 s86, s86, 3
    s_add_u32 s86, s86, 168
    v_lshrrev_b32 v26, 1, v26
    v_mfma_f32_16x16x32_bf16 v[72:75], v[148:151], v[128:131], v[72:75]
    ds_read_b128 v[228:231], v18 offset:2048
    v_add_u32 v26, s86, v26
    s_cmp_eq_u32 s77, 0
    s_cselect_b64 s[100:101], -1, 0
    v_cndmask_b32 v28, v28, v26, s[100:101]
    v_mfma_f32_16x16x32_bf16 v[76:79], v[148:151], v[132:135], v[76:79]
    ds_read_b128 v[232:235], v18 offset:4096
    s_lshr_b32 s99, s77, 1
    s_add_u32 s99, s99, 12
    v_add_u32 v27, s99, v27
    s_mov_b32 s100, 0
    s_mov_b32 s101, -1
    v_cndmask_b32 v28, v28, v27, s[100:101]
    v_mfma_f32_16x16x32_bf16 v[80:83], v[148:151], v[136:139], v[80:83]
    ds_read_b128 v[236:239], v18 offset:6144
    v_lshlrev_b32 v6, 7, v28
    v_lshrrev_b32 v26, 3, v0
    v_mfma_f32_16x16x32_bf16 v[84:87], v[148:151], v[140:143], v[84:87]
    ds_read_b128 v[240:243], v18 offset:8192
    v_and_b32 v29, 7, v0
    v_lshlrev_b32 v26, 10, v26
    v_mfma_f32_16x16x32_bf16 v[36:39], v[144:147], v[120:123], v[36:39]
    ds_read_b128 v[244:247], v18 offset:10240
    s_lshl_b32 s86, s79, 16
    s_lshl_b32 s87, s80, 7
    s_add_u32 s86, s86, s87
    v_lshl_add_u32 v26, v29, 4, v26
    v_add_u32 v7, s86, v26
    v_mfma_f32_16x16x32_bf16 v[40:43], v[144:147], v[124:127], v[40:43]
    ds_read_b128 v[248:251], v18 offset:12288
    ds_read_b64 v[186:187], v14 offset:128
    v_mfma_f32_16x16x32_bf16 v[44:47], v[144:147], v[128:131], v[44:47]
    ds_read_b64_tr_b16 v[212:213], v11 offset:0
    ds_read_b64 v[188:189], v14 offset:256
    v_mfma_f32_16x16x32_bf16 v[48:51], v[144:147], v[132:135], v[48:51]
    ds_read_b64_tr_b16 v[214:215], v11 offset:512
    ds_read_b64 v[190:191], v14 offset:384
    v_mfma_f32_16x16x32_bf16 v[52:55], v[144:147], v[136:139], v[52:55]
    ds_read_b64_tr_b16 v[220:221], v11 offset:16384
    ds_read_b64 v[192:193], v14 offset:512
    v_mfma_f32_16x16x32_bf16 v[56:59], v[144:147], v[140:143], v[56:59]
    ds_read_b64_tr_b16 v[222:223], v11 offset:16896
    ds_read_b64 v[194:195], v14 offset:640
    v_mfma_f32_16x16x32_bf16 v[92:95], v[120:123], v[152:155], v[92:95]
    ds_read_b64 v[196:197], v14 offset:768
    v_mfma_f32_16x16x32_bf16 v[96:99], v[124:127], v[152:155], v[96:99]
    ds_read_b64 v[198:199], v15 offset:0
    v_mfma_f32_16x16x32_bf16 v[100:103], v[128:131], v[152:155], v[100:103]
    ds_read_b64 v[200:201], v15 offset:128
    v_mfma_f32_16x16x32_bf16 v[104:107], v[132:135], v[152:155], v[104:107]
    ds_read_b64 v[202:203], v15 offset:256
    v_mfma_f32_16x16x32_bf16 v[108:111], v[136:139], v[152:155], v[108:111]
    v_cmp_gt_u32 vcc, 16, v1
    v_mov_b32 v28, 0xffff
    v_mfma_f32_16x16x32_bf16 v[112:115], v[140:143], v[152:155], v[112:115]
    v_cndmask_b32 v29, 0, v28, vcc
    s_waitcnt lgkmcnt(0)
    v_mfma_f32_16x16x32_bf16 v[64:67], v[216:219], v[228:231], v[64:67]
    ds_read_b64_tr_b16 v[148:149], v11 offset:12288
    v_mfma_f32_16x16x32_bf16 v[68:71], v[216:219], v[232:235], v[68:71]
    ds_read_b64_tr_b16 v[150:151], v11 offset:12800
    v_and_b32 v207, v186, v29
    v_lshl_or_b32 v206, v207, 16, v207
    v_mfma_f32_16x16x32_bf16 v[72:75], v[216:219], v[236:239], v[72:75]
    ds_read_b128 v[120:123], v19 offset:2048
    v_and_b32 v209, v188, v29
    v_lshl_or_b32 v208, v209, 16, v209
    v_mfma_f32_16x16x32_bf16 v[76:79], v[216:219], v[240:243], v[76:79]
    ds_read_b128 v[124:127], v19 offset:4096
    v_and_b32 v211, v190, v29
    v_lshl_or_b32 v210, v211, 16, v211
    v_mfma_f32_16x16x32_bf16 v[80:83], v[216:219], v[244:247], v[80:83]
    ds_read_b128 v[128:131], v19 offset:6144
    v_mfma_f32_16x16x32_bf16 v[84:87], v[216:219], v[248:251], v[84:87]
    ds_read_b128 v[132:135], v19 offset:8192
    v_and_b32 v253, v192, v29
    v_lshl_or_b32 v252, v253, 16, v253
    v_mfma_f32_16x16x32_bf16 v[36:39], v[212:215], v[228:231], v[36:39]
    ds_read_b128 v[136:139], v19 offset:10240
    v_and_b32 v33, v194, v29
    v_lshl_or_b32 v32, v33, 16, v33
    v_mfma_f32_16x16x32_bf16 v[40:43], v[212:215], v[232:235], v[40:43]
    ds_read_b128 v[140:143], v19 offset:12288
    v_and_b32 v27, v196, v29
    v_lshl_or_b32 v26, v27, 16, v27
    v_mfma_f32_16x16x32_bf16 v[44:47], v[212:215], v[236:239], v[44:47]
    ds_read_b64_tr_b16 v[144:145], v11 offset:4096
    v_mfma_f32_16x16x32_bf16 v[48:51], v[212:215], v[240:243], v[48:51]
    ds_read_b64_tr_b16 v[146:147], v11 offset:4608
    ds_read_b128 v[160:163], v17 offset:64
    v_mfma_f32_16x16x32_bf16 v[52:55], v[212:215], v[244:247], v[52:55]
    ds_read_b64_tr_b16 v[152:153], v11 offset:20480
    ds_read_b128 v[164:167], v17 offset:128
    v_mfma_f32_16x16x32_bf16 v[56:59], v[212:215], v[248:251], v[56:59]
    ds_read_b64_tr_b16 v[154:155], v11 offset:20992
    ds_read_b128 v[168:171], v17 offset:192
    v_mfma_f32_16x16x32_bf16 v[92:95], v[228:231], v[220:223], v[92:95]
    v_mfma_f32_16x16x32_bf16 v[96:99], v[232:235], v[220:223], v[96:99]
    ds_read_b128 v[172:175], v17 offset:256
    v_mfma_f32_16x16x32_bf16 v[100:103], v[236:239], v[220:223], v[100:103]
    ds_read_b128 v[176:179], v17 offset:320
    v_mfma_f32_16x16x32_bf16 v[104:107], v[240:243], v[220:223], v[104:107]
    ds_read_b128 v[180:183], v17 offset:384
    v_mfma_f32_16x16x32_bf16 v[108:111], v[244:247], v[220:223], v[108:111]
    v_mfma_f32_16x16x32_bf16 v[112:115], v[248:251], v[220:223], v[112:115]
    v_mfma_f32_16x16x16_bf16 v[64:67], v[200:201], v[206:207], v[64:67]
    v_mfma_f32_16x16x16_bf16 v[36:39], v[198:199], v[206:207], v[36:39]
    v_mfma_f32_16x16x16_bf16 v[68:71], v[200:201], v[208:209], v[68:71]
    v_mfma_f32_16x16x16_bf16 v[40:43], v[198:199], v[208:209], v[40:43]
    v_mfma_f32_16x16x16_bf16 v[72:75], v[200:201], v[210:211], v[72:75]
    v_mfma_f32_16x16x16_bf16 v[44:47], v[198:199], v[210:211], v[44:47]
    v_mfma_f32_16x16x16_bf16 v[76:79], v[200:201], v[252:253], v[76:79]
    v_mfma_f32_16x16x16_bf16 v[48:51], v[198:199], v[252:253], v[48:51]
    v_mfma_f32_16x16x16_bf16 v[80:83], v[200:201], v[32:33], v[80:83]
    v_mfma_f32_16x16x16_bf16 v[52:55], v[198:199], v[32:33], v[52:55]
    v_mfma_f32_16x16x16_bf16 v[84:87], v[200:201], v[26:27], v[84:87]
    v_mfma_f32_16x16x16_bf16 v[56:59], v[198:199], v[26:27], v[56:59]
    v_mfma_f32_16x16x16_bf16 v[92:95], v[206:207], v[202:203], v[92:95]
    v_mfma_f32_16x16x16_bf16 v[96:99], v[208:209], v[202:203], v[96:99]
    v_mfma_f32_16x16x16_bf16 v[100:103], v[210:211], v[202:203], v[100:103]
    v_mfma_f32_16x16x16_bf16 v[104:107], v[252:253], v[202:203], v[104:107]
    v_mfma_f32_16x16x16_bf16 v[108:111], v[32:33], v[202:203], v[108:111]
    v_mfma_f32_16x16x16_bf16 v[112:115], v[26:27], v[202:203], v[112:115]
    s_waitcnt lgkmcnt(0)
    v_mfma_f32_16x16x32_bf16 v[64:67], v[148:151], v[120:123], v[64:67]
    v_and_b32 v12, 15, v1
    v_lshrrev_b32 v15, 4, v1
    s_add_u32 s85, s75, 6
    s_and_b32 s85, s85, 15
    s_lshl_b32 s85, s85, 15
    buffer_load_dwordx4 v[220:223], v30, s[32:35], s85 offen
    v_mfma_f32_16x16x32_bf16 v[68:71], v[148:151], v[124:127], v[68:71]
    v_lshlrev_b32 v15, 2, v15
    v_mov_b32 v13, 0xf149f2ca
    v_sub_u32 v12, v12, v15
    v_mfma_f32_16x16x32_bf16 v[72:75], v[148:151], v[128:131], v[72:75]
    v_and_b32 v14, 1, v1
    v_lshlrev_b32 v14, 4, v14
    v_mov_b32 v15, 0xffff
    s_add_u32 s85, s85, s81
    buffer_load_dwordx4 v[224:227], v30, s[32:35], s85 offen
    v_mfma_f32_16x16x32_bf16 v[76:79], v[148:151], v[132:135], v[76:79]
    v_lshlrev_b32 v14, v14, v15
    v_cmp_le_i32 vcc, 0, v12
    s_cmp_lt_i32 s56, 0
    s_cselect_b64 s[68:69], -1, 0
    v_mfma_f32_16x16x32_bf16 v[80:83], v[148:151], v[136:139], v[80:83]
    v_cndmask_b32 v218, 0, v14, vcc
    v_cndmask_b32 v216, v14, 0, vcc
    v_cmp_le_i32 vcc, 2, v12
    s_add_u32 s85, s75, 7
    s_and_b32 s85, s85, 15
    s_lshl_b32 s85, s85, 15
    buffer_load_dwordx4 v[228:231], v30, s[32:35], s85 offen
    v_mfma_f32_16x16x32_bf16 v[84:87], v[148:151], v[140:143], v[84:87]
    v_cndmask_b32 v219, 0, v14, vcc
    v_cndmask_b32 v217, v14, 0, vcc
    v_mfma_f32_16x16x32_bf16 v[36:39], v[144:147], v[120:123], v[36:39]
    v_subrev_u32 v204, 0, v12
    v_add_u32 v208, 1, v204
    v_and_b32 v204, 0x80000001, v204
    s_add_u32 s85, s85, s81
    buffer_load_dwordx4 v[232:235], v30, s[32:35], s85 offen
    v_mfma_f32_16x16x32_bf16 v[40:43], v[144:147], v[124:127], v[40:43]
    v_cmp_eq_u32 vcc, 0, v204
    v_and_b32 v208, 0x80000001, v208
    v_mov_b32 v8, 0x3f803f80
    v_cndmask_b32 v204, v13, 0, vcc
    v_mfma_f32_16x16x32_bf16 v[44:47], v[144:147], v[128:131], v[44:47]
    v_cmp_eq_u32 vcc, 0x80000001, v208
    v_mul_f32 v186, 0x3eb8aa3b, v187
    v_mul_f32 v188, 0x3eb8aa3b, v189
    v_cndmask_b32 v208, v13, 0, vcc
    v_mfma_f32_16x16x32_bf16 v[48:51], v[144:147], v[132:135], v[48:51]
    v_subrev_u32 v205, 1, v12
    v_add_u32 v209, 1, v205
    v_and_b32 v205, 0x80000001, v205
    s_add_u32 s85, s75, 8
    s_and_b32 s85, s85, 15
    s_lshl_b32 s85, s85, 15
    buffer_load_dwordx4 v[236:239], v30, s[32:35], s85 offen
    v_mfma_f32_16x16x32_bf16 v[52:55], v[144:147], v[136:139], v[52:55]
    v_cmp_eq_u32 vcc, 0, v205
    v_and_b32 v209, 0x80000001, v209
    v_mov_b32 v9, 0x3f803f80
    v_cndmask_b32 v205, v13, 0, vcc
    v_mfma_f32_16x16x32_bf16 v[56:59], v[144:147], v[140:143], v[56:59]
    v_cmp_eq_u32 vcc, 0x80000001, v209
    v_mul_f32 v190, 0x3eb8aa3b, v191
    v_mul_f32 v192, 0x3eb8aa3b, v193
    v_cndmask_b32 v209, v13, 0, vcc
    s_add_u32 s85, s85, s81
    buffer_load_dwordx4 v[240:243], v30, s[32:35], s85 offen
    v_mfma_f32_16x16x32_bf16 v[92:95], v[120:123], v[152:155], v[92:95]
    v_subrev_u32 v206, 2, v12
    v_add_u32 v210, 1, v206
    v_and_b32 v206, 0x80000001, v206
    v_mfma_f32_16x16x32_bf16 v[96:99], v[124:127], v[152:155], v[96:99]
    v_cmp_eq_u32 vcc, 0, v206
    v_and_b32 v210, 0x80000001, v210
    v_mov_b32 v10, 0x3f803f80
    v_cndmask_b32 v206, v13, 0, vcc
    s_add_u32 s85, s75, 9
    s_and_b32 s85, s85, 15
    s_lshl_b32 s85, s85, 15
    buffer_load_dwordx4 v[244:247], v30, s[32:35], s85 offen
    v_mfma_f32_16x16x32_bf16 v[100:103], v[128:131], v[152:155], v[100:103]
    v_cmp_eq_u32 vcc, 0x80000001, v210
    v_mul_f32 v194, 0x3eb8aa3b, v195
    v_mul_f32 v196, 0x3eb8aa3b, v197
    v_cndmask_b32 v210, v13, 0, vcc
    v_mfma_f32_16x16x32_bf16 v[104:107], v[132:135], v[152:155], v[104:107]
    v_subrev_u32 v207, 3, v12
    v_add_u32 v211, 1, v207
    v_and_b32 v207, 0x80000001, v207
    s_add_u32 s85, s85, s81
    buffer_load_dwordx4 v[248:251], v30, s[32:35], s85 offen
    v_mfma_f32_16x16x32_bf16 v[108:111], v[136:139], v[152:155], v[108:111]
    v_cmp_eq_u32 vcc, 0, v207
    v_and_b32 v211, 0x80000001, v211
    v_mov_b32 v11, 0x3f803f80
    v_cndmask_b32 v207, v13, 0, vcc
    v_mfma_f32_16x16x32_bf16 v[112:115], v[140:143], v[152:155], v[112:115]
    v_cmp_eq_u32 vcc, 0x80000001, v211
    s_nop 1
    v_cndmask_b32 v211, v13, 0, vcc
    s_lshl_b32 s86, s36, 2
    s_add_u32 s86, s86, 161024
    v_mov_b32 v254, s86
    s_waitcnt vmcnt(8)
    ds_write_b32 v254, v25
    s_setprio 0
    s_lshl_b32 s86, s77, 10
    s_cmp_ge_u32 s77, 2
    s_cselect_b32 s87, 5632, 0
    s_add_u32 s86, s86, s87
    s_add_u32 s86, s86, 153600
    v_lshl_add_u32 v16, v1, 3, s86
    s_lshl_b32 s86, s77, 2
    s_add_u32 s86, s86, 161056
    v_mov_b32 v17, s86
KV_47:
    ds_read_b32 v18, v17
    ds_read_b64 v[116:117], v16
    ds_read_b64 v[130:131], v16 offset:512
    s_waitcnt lgkmcnt(0)
    v_readfirstlane_b32 s96, v18
    s_nop 0
    s_cmp_eq_u32 s96, 0
    s_cbranch_scc1 KV_47
    v_mul_f32 v64, v64, v187
    v_mul_f32 v65, v65, v187
    v_mul_f32 v66, v66, v187
    v_mul_f32 v67, v67, v187
    v_cvt_pk_bf16_f32 v118, v64, v65
    v_cvt_pk_bf16_f32 v119, v66, v67
    v_cvt_pk_bf16_f32 v144, v36, v37
    v_cvt_pk_bf16_f32 v145, v38, v39
    v_mul_f32 v68, v68, v189
    v_mul_f32 v69, v69, v189
    v_mul_f32 v70, v70, v189
    v_mul_f32 v71, v71, v189
    v_cvt_pk_bf16_f32 v120, v68, v69
    v_cvt_pk_bf16_f32 v121, v70, v71
    v_cvt_pk_bf16_f32 v146, v40, v41
    v_cvt_pk_bf16_f32 v147, v42, v43
    v_mul_f32 v72, v72, v191
    v_mul_f32 v73, v73, v191
    v_mul_f32 v74, v74, v191
    v_mul_f32 v75, v75, v191
    v_cvt_pk_bf16_f32 v122, v72, v73
    v_cvt_pk_bf16_f32 v123, v74, v75
    v_cvt_pk_bf16_f32 v148, v44, v45
    v_cvt_pk_bf16_f32 v149, v46, v47
    v_mul_f32 v76, v76, v193
    v_mul_f32 v77, v77, v193
    v_mul_f32 v78, v78, v193
    v_mul_f32 v79, v79, v193
    v_cvt_pk_bf16_f32 v124, v76, v77
    v_cvt_pk_bf16_f32 v125, v78, v79
    v_cvt_pk_bf16_f32 v150, v48, v49
    v_cvt_pk_bf16_f32 v151, v50, v51
    v_mul_f32 v80, v80, v195
    v_mul_f32 v81, v81, v195
    v_mul_f32 v82, v82, v195
    v_mul_f32 v83, v83, v195
    v_cvt_pk_bf16_f32 v126, v80, v81
    v_cvt_pk_bf16_f32 v127, v82, v83
    v_cvt_pk_bf16_f32 v152, v52, v53
    v_cvt_pk_bf16_f32 v153, v54, v55
    v_mul_f32 v84, v84, v197
    v_mul_f32 v85, v85, v197
    v_mul_f32 v86, v86, v197
    v_mul_f32 v87, v87, v197
    v_cvt_pk_bf16_f32 v128, v84, v85
    v_cvt_pk_bf16_f32 v129, v86, v87
    v_cvt_pk_bf16_f32 v154, v56, v57
    v_cvt_pk_bf16_f32 v155, v58, v59
    v_mfma_f32_16x16x16_bf16 v[64:67], v[116:117], v[144:145], v[208:211]
    v_mul_f32 v92, v92, v160
    v_mul_f32 v93, v93, v161
    v_cvt_pk_bf16_f32 v132, v92, v93
    v_mfma_f32_16x16x16_bf16 v[36:39], v[118:119], v[144:145], v[204:207]
    v_mul_f32 v94, v94, v162
    v_mul_f32 v95, v95, v163
    v_cvt_pk_bf16_f32 v133, v94, v95
    v_mfma_f32_16x16x16_bf16 v[68:71], v[118:119], v[146:147], v[208:211]
    v_mul_f32 v96, v96, v164
    v_mul_f32 v97, v97, v165
    v_cvt_pk_bf16_f32 v134, v96, v97
    v_mfma_f32_16x16x16_bf16 v[40:43], v[120:121], v[146:147], v[204:207]
    v_mul_f32 v98, v98, v166
    v_mul_f32 v99, v99, v167
    v_cvt_pk_bf16_f32 v135, v98, v99
    v_mfma_f32_16x16x16_bf16 v[72:75], v[120:121], v[148:149], v[208:211]
    v_mul_f32 v100, v100, v168
    v_mul_f32 v101, v101, v169
    v_cvt_pk_bf16_f32 v136, v100, v101
    v_mfma_f32_16x16x16_bf16 v[44:47], v[122:123], v[148:149], v[204:207]
    v_mul_f32 v102, v102, v170
    v_mul_f32 v103, v103, v171
    v_cvt_pk_bf16_f32 v137, v102, v103
    v_mfma_f32_16x16x16_bf16 v[76:79], v[122:123], v[150:151], v[208:211]
    v_mul_f32 v104, v104, v172
    v_mul_f32 v105, v105, v173
    v_cvt_pk_bf16_f32 v138, v104, v105
    v_mfma_f32_16x16x16_bf16 v[48:51], v[124:125], v[150:151], v[204:207]
    v_mul_f32 v106, v106, v174
    v_mul_f32 v107, v107, v175
    v_cvt_pk_bf16_f32 v139, v106, v107
    v_mfma_f32_16x16x16_bf16 v[80:83], v[124:125], v[152:153], v[208:211]
    v_mul_f32 v108, v108, v176
    v_mul_f32 v109, v109, v177
    v_cvt_pk_bf16_f32 v140, v108, v109
    v_mfma_f32_16x16x16_bf16 v[52:55], v[126:127], v[152:153], v[204:207]
    v_mul_f32 v110, v110, v178
    v_mul_f32 v111, v111, v179
    v_cvt_pk_bf16_f32 v141, v110, v111
    v_mfma_f32_16x16x16_bf16 v[84:87], v[126:127], v[154:155], v[208:211]
    v_mul_f32 v112, v112, v180
    v_mul_f32 v113, v113, v181
    v_cvt_pk_bf16_f32 v142, v112, v113
    v_mfma_f32_16x16x16_bf16 v[56:59], v[128:129], v[154:155], v[204:207]
    v_mul_f32 v114, v114, v182
    v_mul_f32 v115, v115, v183
    v_cvt_pk_bf16_f32 v143, v114, v115
    v_max3_f32 v162, v64, v65, v36
    v_max3_f32 v163, v66, v67, v38
    v_max_f32 v162, v162, v37
    v_max_f32 v163, v163, v39
    v_max_f32 v160, v162, v163
    v_max_f32 v161, v162, v163
    v_max3_f32 v166, v68, v69, v40
    v_max3_f32 v167, v70, v71, v42
    v_max_f32 v166, v166, v41
    v_max_f32 v167, v167, v43
    v_max_f32 v164, v166, v167
    v_max_f32 v165, v166, v167
    v_max3_f32 v170, v72, v73, v44
    v_max3_f32 v171, v74, v75, v46
    v_max_f32 v170, v170, v45
    v_max_f32 v171, v171, v47
    v_max_f32 v168, v170, v171
    v_max_f32 v169, v170, v171
    v_max3_f32 v174, v76, v77, v48
    v_max3_f32 v175, v78, v79, v50
    v_max_f32 v174, v174, v49
    v_max_f32 v175, v175, v51
    v_max_f32 v172, v174, v175
    v_max_f32 v173, v174, v175
    v_max3_f32 v178, v80, v81, v52
    v_max3_f32 v179, v82, v83, v54
    v_max_f32 v178, v178, v53
    v_max_f32 v179, v179, v55
    v_max_f32 v176, v178, v179
    v_max_f32 v177, v178, v179
    v_max3_f32 v182, v84, v85, v56
    v_max3_f32 v183, v86, v87, v58
    v_max_f32 v182, v182, v57
    v_max_f32 v183, v183, v59
    v_max_f32 v180, v182, v183
    v_max_f32 v181, v182, v183
    v_permlane16_swap_b32 v160, v161
    v_permlane16_swap_b32 v164, v165
    v_permlane16_swap_b32 v168, v169
    v_permlane16_swap_b32 v172, v173
    v_permlane16_swap_b32 v176, v177
    v_permlane16_swap_b32 v180, v181
    v_max_f32 v160, v160, v161
    v_mov_b32 v161, v160
    v_max_f32 v164, v164, v165
    v_mov_b32 v165, v164
    v_max_f32 v168, v168, v169
    v_mov_b32 v169, v168
    v_max_f32 v172, v172, v173
    v_mov_b32 v173, v172
    v_max_f32 v176, v176, v177
    v_mov_b32 v177, v176
    v_max_f32 v180, v180, v181
    v_mov_b32 v181, v180
    v_permlane32_swap_b32 v160, v161
    v_permlane32_swap_b32 v164, v165
    v_permlane32_swap_b32 v168, v169
    v_permlane32_swap_b32 v172, v173
    v_permlane32_swap_b32 v176, v177
    v_permlane32_swap_b32 v180, v181
    v_max_f32 v160, v160, v161
    v_sub_f32 v162, v162, v160
    v_sub_f32 v163, v163, v160
    v_mul_f32 v162, v162, v186
    v_mul_f32 v163, v163, v186
    v_max_f32 v164, v164, v165
    v_sub_f32 v166, v166, v164
    v_sub_f32 v167, v167, v164
    v_mul_f32 v166, v166, v188
    v_mul_f32 v167, v167, v188
    v_max_f32 v168, v168, v169
    v_sub_f32 v170, v170, v168
    v_sub_f32 v171, v171, v168
    v_mul_f32 v170, v170, v190
    v_mul_f32 v171, v171, v190
    v_max_f32 v172, v172, v173
    v_sub_f32 v174, v174, v172
    v_sub_f32 v175, v175, v172
    v_mul_f32 v174, v174, v192
    v_mul_f32 v175, v175, v192
    v_max_f32 v176, v176, v177
    v_sub_f32 v178, v178, v176
    v_sub_f32 v179, v179, v176
    v_mul_f32 v178, v178, v194
    v_mul_f32 v179, v179, v194
    v_max_f32 v180, v180, v181
    v_sub_f32 v182, v182, v180
    v_sub_f32 v183, v183, v180
    v_mul_f32 v182, v182, v196
    v_mul_f32 v183, v183, v196
    v_exp_f32 v162, v162
    v_exp_f32 v163, v163
    v_exp_f32 v166, v166
    v_exp_f32 v167, v167
    v_exp_f32 v170, v170
    v_exp_f32 v171, v171
    v_exp_f32 v174, v174
    v_exp_f32 v175, v175
    v_exp_f32 v178, v178
    v_exp_f32 v179, v179
    v_exp_f32 v182, v182
    v_exp_f32 v183, v183
    v_cvt_pk_bf16_f32 v162, v162, v162
    v_cvt_pk_bf16_f32 v163, v163, v163
    v_and_b32 v92, v162, v216
    v_and_b32 v93, v163, v217
    v_and_b32 v94, v162, v218
    v_and_b32 v95, v163, v219
    v_cvt_pk_bf16_f32 v166, v166, v166
    v_cvt_pk_bf16_f32 v167, v167, v167
    v_and_b32 v96, v166, v216
    v_and_b32 v97, v167, v217
    v_and_b32 v98, v166, v218
    v_and_b32 v99, v167, v219
    v_mfma_f32_16x16x32_bf16 v[64:67], v[130:133], v[92:95], 0
    v_mfma_f32_16x16x32_bf16 v[36:39], v[8:11], v[92:95], 0
    v_cvt_pk_bf16_f32 v170, v170, v170
    v_cvt_pk_bf16_f32 v171, v171, v171
    v_and_b32 v100, v170, v216
    v_and_b32 v101, v171, v217
    v_and_b32 v102, v170, v218
    v_and_b32 v103, v171, v219
    v_mfma_f32_16x16x32_bf16 v[68:71], v[132:135], v[96:99], 0
    v_mfma_f32_16x16x32_bf16 v[40:43], v[8:11], v[96:99], 0
    v_cvt_pk_bf16_f32 v174, v174, v174
    v_cvt_pk_bf16_f32 v175, v175, v175
    v_and_b32 v104, v174, v216
    v_and_b32 v105, v175, v217
    v_and_b32 v106, v174, v218
    v_and_b32 v107, v175, v219
    v_mfma_f32_16x16x32_bf16 v[72:75], v[134:137], v[100:103], 0
    v_mfma_f32_16x16x32_bf16 v[44:47], v[8:11], v[100:103], 0
    v_cvt_pk_bf16_f32 v178, v178, v178
    v_cvt_pk_bf16_f32 v179, v179, v179
    v_and_b32 v108, v178, v216
    v_and_b32 v109, v179, v217
    v_and_b32 v110, v178, v218
    v_and_b32 v111, v179, v219
    v_mfma_f32_16x16x32_bf16 v[76:79], v[136:139], v[104:107], 0
    v_mfma_f32_16x16x32_bf16 v[48:51], v[8:11], v[104:107], 0
    v_cvt_pk_bf16_f32 v182, v182, v182
    v_cvt_pk_bf16_f32 v183, v183, v183
    v_and_b32 v112, v182, v216
    v_and_b32 v113, v183, v217
    v_and_b32 v114, v182, v218
    v_and_b32 v115, v183, v219
    v_mfma_f32_16x16x32_bf16 v[80:83], v[138:141], v[108:111], 0
    v_mfma_f32_16x16x32_bf16 v[52:55], v[8:11], v[108:111], 0
    v_mfma_f32_16x16x32_bf16 v[84:87], v[140:143], v[112:115], 0
    v_mfma_f32_16x16x32_bf16 v[56:59], v[8:11], v[112:115], 0
    v_rcp_f32 v36, v36
    v_rcp_f32 v40, v40
    v_mul_f32 v64, v64, v36
    v_mul_f32 v65, v65, v36
    v_mul_f32 v66, v66, v36
    v_mul_f32 v67, v67, v36
    v_cvt_pk_bf16_f32 v92, v64, v65
    v_cvt_pk_bf16_f32 v93, v66, v67
    v_mul_f32 v68, v68, v40
    v_mul_f32 v69, v69, v40
    v_mul_f32 v70, v70, v40
    v_mul_f32 v71, v71, v40
    v_cvt_pk_bf16_f32 v94, v68, v69
    v_cvt_pk_bf16_f32 v95, v70, v71
    s_add_u32 s38, s56, 74752
    v_permlane16_swap_b32 v92, v94
    v_permlane16_swap_b32 v93, v95
    buffer_store_dwordx4 v[92:95], v3, s[20:23], s38 offen sc1
    v_rcp_f32 v44, v44
    v_rcp_f32 v48, v48
    v_mul_f32 v72, v72, v44
    v_mul_f32 v73, v73, v44
    v_mul_f32 v74, v74, v44
    v_mul_f32 v75, v75, v44
    v_cvt_pk_bf16_f32 v100, v72, v73
    v_cvt_pk_bf16_f32 v101, v74, v75
    v_mul_f32 v76, v76, v48
    v_mul_f32 v77, v77, v48
    v_mul_f32 v78, v78, v48
    v_mul_f32 v79, v79, v48
    v_cvt_pk_bf16_f32 v102, v76, v77
    v_cvt_pk_bf16_f32 v103, v78, v79
    s_add_u32 s38, s56, 224256
    v_permlane16_swap_b32 v100, v102
    v_permlane16_swap_b32 v101, v103
    buffer_store_dwordx4 v[100:103], v3, s[20:23], s38 offen sc1
    v_rcp_f32 v52, v52
    v_rcp_f32 v56, v56
    v_mul_f32 v80, v80, v52
    v_mul_f32 v81, v81, v52
    v_mul_f32 v82, v82, v52
    v_mul_f32 v83, v83, v52
    v_cvt_pk_bf16_f32 v108, v80, v81
    v_cvt_pk_bf16_f32 v109, v82, v83
    v_mul_f32 v84, v84, v56
    v_mul_f32 v85, v85, v56
    v_mul_f32 v86, v86, v56
    v_mul_f32 v87, v87, v56
    v_cvt_pk_bf16_f32 v110, v84, v85
    v_cvt_pk_bf16_f32 v111, v86, v87
    s_add_u32 s38, s56, 373760
    v_permlane16_swap_b32 v108, v110
    v_permlane16_swap_b32 v109, v111
    buffer_store_dwordx4 v[108:111], v3, s[20:23], s38 offen sc1
P2_start:
    v_xor_b32 v254, 16, v254
P2_pf:
    ds_read_b32 v16, v254
    v_add_u32 v8, 0x10000, v20
    v_add_u32 v9, 0x10000, v21
    v_add_u32 v10, 0x10000, v22
    v_add_u32 v11, 0x10000, v23
    s_waitcnt lgkmcnt(0)
    v_readfirstlane_b32 s96, v16
    s_nop 0
    s_cmp_eq_u32 s96, 0
    s_cbranch_scc1 P2_pf
    ds_read_b64_tr_b16 v[68:69], v20 offset:0
    ds_read_b64_tr_b16 v[70:71], v20 offset:2048
    ds_read_b64_tr_b16 v[72:73], v21 offset:0
    ds_read_b64_tr_b16 v[74:75], v21 offset:2048
    ds_read_b64_tr_b16 v[76:77], v22 offset:0
    ds_read_b64_tr_b16 v[78:79], v22 offset:2048
    ds_read_b64_tr_b16 v[80:81], v23 offset:0
    ds_read_b64_tr_b16 v[82:83], v23 offset:2048
    ds_read_b64_tr_b16 v[84:85], v20 offset:16384
    ds_read_b64_tr_b16 v[86:87], v20 offset:18432
    ds_read_b64_tr_b16 v[88:89], v21 offset:16384
    ds_read_b64_tr_b16 v[90:91], v21 offset:18432
    ds_read_b64_tr_b16 v[92:93], v22 offset:16384
    ds_read_b64_tr_b16 v[94:95], v22 offset:18432
    ds_read_b64_tr_b16 v[96:97], v23 offset:16384
    ds_read_b64_tr_b16 v[98:99], v23 offset:18432
    ds_read_b64_tr_b16 v[100:101], v20 offset:32768
    ds_read_b64_tr_b16 v[102:103], v20 offset:34816
    ds_read_b64_tr_b16 v[104:105], v21 offset:32768
    ds_read_b64_tr_b16 v[106:107], v21 offset:34816
    ds_read_b64_tr_b16 v[108:109], v22 offset:32768
    ds_read_b64_tr_b16 v[110:111], v22 offset:34816
    ds_read_b64_tr_b16 v[112:113], v23 offset:32768
    ds_read_b64_tr_b16 v[114:115], v23 offset:34816
    ds_read_b64_tr_b16 v[116:117], v20 offset:49152
    ds_read_b64_tr_b16 v[118:119], v20 offset:51200
    ds_read_b64_tr_b16 v[120:121], v21 offset:49152
    ds_read_b64_tr_b16 v[122:123], v21 offset:51200
    ds_read_b64_tr_b16 v[124:125], v22 offset:49152
    ds_read_b64_tr_b16 v[126:127], v22 offset:51200
    ds_read_b64_tr_b16 v[128:129], v23 offset:49152
    ds_read_b64_tr_b16 v[130:131], v23 offset:51200
    ds_read_b64_tr_b16 v[132:133], v8 offset:0
    ds_read_b64_tr_b16 v[134:135], v8 offset:2048
    ds_read_b64_tr_b16 v[136:137], v9 offset:0
    ds_read_b64_tr_b16 v[138:139], v9 offset:2048
    ds_read_b64_tr_b16 v[140:141], v10 offset:0
    ds_read_b64_tr_b16 v[142:143], v10 offset:2048
    ds_read_b64_tr_b16 v[144:145], v11 offset:0
    ds_read_b64_tr_b16 v[146:147], v11 offset:2048
    ds_read_b64_tr_b16 v[148:149], v8 offset:16384
    ds_read_b64_tr_b16 v[150:151], v8 offset:18432
    ds_read_b64_tr_b16 v[152:153], v9 offset:16384
    ds_read_b64_tr_b16 v[154:155], v9 offset:18432
    ds_read_b64_tr_b16 v[156:157], v10 offset:16384
    ds_read_b64_tr_b16 v[158:159], v10 offset:18432
    ds_read_b64_tr_b16 v[160:161], v11 offset:16384
    ds_read_b64_tr_b16 v[162:163], v11 offset:18432
    s_add_u32 s86, s76, 98304
    v_lshl_add_u32 v32, v1, 4, s86
    s_waitcnt vmcnt(0) lgkmcnt(0)
    s_barrier
    buffer_store_dword v25, v24, s[24:27], s67 offen sc1
    s_setprio 3
    s_add_u32 m0, s76, 0
    s_add_u32 s85, s75, 10
    s_and_b32 s85, s85, 15
    s_lshl_b32 s85, s85, 15
    buffer_load_dwordx4 v30, s[32:35], s85 offen lds
    ds_write_b128 v32, v[220:223] offset:0
    s_add_u32 m0, s76, 1024
    s_add_u32 s85, s85, s81
    buffer_load_dwordx4 v30, s[32:35], s85 offen lds
    ds_write_b128 v32, v[224:227] offset:1024
    s_add_u32 m0, s76, 16384
    s_add_u32 s85, s75, 11
    s_and_b32 s85, s85, 15
    s_lshl_b32 s85, s85, 15
    buffer_load_dwordx4 v30, s[32:35], s85 offen lds
    ds_write_b128 v32, v[228:231] offset:16384
    s_add_u32 m0, s76, 17408
    s_add_u32 s85, s85, s81
    buffer_load_dwordx4 v30, s[32:35], s85 offen lds
    ds_write_b128 v32, v[232:235] offset:17408
    s_add_u32 m0, s76, 32768
    s_add_u32 s85, s75, 12
    s_and_b32 s85, s85, 15
    s_lshl_b32 s85, s85, 15
    buffer_load_dwordx4 v30, s[32:35], s85 offen lds
    ds_write_b128 v32, v[236:239] offset:32768
    s_add_u32 m0, s76, 33792
    s_add_u32 s85, s85, s81
    buffer_load_dwordx4 v30, s[32:35], s85 offen lds
    ds_write_b128 v32, v[240:243] offset:33792
    buffer_load_dword v2, v6, s[24:27], 0 offen sc1
    s_add_u32 m0, s76, 49152
    s_add_u32 s85, s75, 13
    s_and_b32 s85, s85, 15
    s_lshl_b32 s85, s85, 15
    buffer_load_dwordx4 v30, s[32:35], s85 offen lds
    ds_write_b128 v32, v[244:247] offset:49152
    s_add_u32 m0, s76, 50176
    s_add_u32 s85, s85, s81
    buffer_load_dwordx4 v30, s[32:35], s85 offen lds
    ds_write_b128 v32, v[248:251] offset:50176
    s_add_u32 m0, s76, 65536
    s_add_u32 s85, s75, 14
    s_and_b32 s85, s85, 15
    s_lshl_b32 s85, s85, 15
    buffer_load_dwordx4 v30, s[32:35], s85 offen lds
    s_add_u32 m0, s76, 66560
    s_add_u32 s85, s85, s81
    buffer_load_dwordx4 v30, s[32:35], s85 offen lds
    s_add_u32 m0, s76, 81920
    s_add_u32 s85, s75, 15
    s_and_b32 s85, s85, 15
    s_lshl_b32 s85, s85, 15
    buffer_load_dwordx4 v30, s[32:35], s85 offen lds
    s_add_u32 m0, s76, 82944
    s_add_u32 s85, s85, s81
    buffer_load_dwordx4 v30, s[32:35], s85 offen lds
    v_add_u32 v12, 0x20000, v20
    v_add_u32 v13, 0x20000, v21
    v_add_u32 v14, 0x20000, v22
    v_add_u32 v15, 0x20000, v23
    s_mul_i32 s86, s77, 17408
    s_mul_i32 s87, s78, 8704
    s_add_u32 s86, s86, s87
    v_and_b32 v16, 15, v1
    v_lshrrev_b32 v17, 4, v1
    v_mul_u32_u24 v16, 272, v16
    v_lshl_add_u32 v16, v17, 4, v16
    v_add_u32 v16, s86, v16
    v_add_u32 v19, 69632, v16
    v_lshrrev_b32 v17, 3, v0
    v_and_b32 v18, 7, v0
    v_mul_u32_u24 v17, 272, v17
    v_lshl_add_u32 v17, v18, 5, v17
    v_add_u32 v18, 69632, v17
    s_waitcnt vmcnt(6)
    v_cmp_ne_u32 vcc, 0, v2
    s_nop 0
    s_lshr_b64 s[68:69], vcc, 1
    s_and_b64 s[68:69], s[68:69], vcc
    s_bitcmp1_b64 s[68:69], 0
    s_cbranch_scc0 HP_49
HR_48:
    buffer_load_dwordx4 v[164:167], v4, s[20:23], s40 offen sc1
    buffer_load_dwordx4 v[168:171], v5, s[20:23], s40 offen sc1
    s_bitcmp1_b64 s[68:69], 2
    s_cbranch_scc0 HP_51
HR_50:
    buffer_load_dwordx4 v[172:175], v4, s[20:23], s41 offen sc1
    buffer_load_dwordx4 v[176:179], v5, s[20:23], s41 offen sc1
    s_bitcmp1_b64 s[68:69], 4
    s_cbranch_scc0 HP_53
HR_52:
    buffer_load_dwordx4 v[180:183], v4, s[20:23], s42 offen sc1
    buffer_load_dwordx4 v[184:187], v5, s[20:23], s42 offen sc1
    s_bitcmp1_b64 s[68:69], 6
    s_cbranch_scc0 HP_55
HR_54:
    buffer_load_dwordx4 v[188:191], v4, s[20:23], s43 offen sc1
    buffer_load_dwordx4 v[192:195], v5, s[20:23], s43 offen sc1
    buffer_load_dword v2, v6, s[24:27], 0 offen sc1
    s_waitcnt vmcnt(7)
    v_mfma_f32_16x16x32_bf16 v[36:39], v[68:71], v[164:167], 0
    s_bitcmp1_b64 s[68:69], 8
    s_cbranch_scc0 HP_57
HR_56:
    buffer_load_dwordx4 v[196:199], v4, s[20:23], s44 offen sc1
    buffer_load_dwordx4 v[200:203], v5, s[20:23], s44 offen sc1
    v_mfma_f32_16x16x32_bf16 v[52:55], v[68:71], v[168:171], 0
    v_mfma_f32_16x16x32_bf16 v[40:43], v[72:75], v[164:167], 0
    v_mfma_f32_16x16x32_bf16 v[56:59], v[72:75], v[168:171], 0
    v_mfma_f32_16x16x32_bf16 v[44:47], v[76:79], v[164:167], 0
    v_mfma_f32_16x16x32_bf16 v[60:63], v[76:79], v[168:171], 0
    v_mfma_f32_16x16x32_bf16 v[48:51], v[80:83], v[164:167], 0
    v_mfma_f32_16x16x32_bf16 v[64:67], v[80:83], v[168:171], 0
    s_setprio 2
    s_waitcnt vmcnt(7)
    v_mfma_f32_16x16x32_bf16 v[36:39], v[84:87], v[172:175], v[36:39]
    s_bitcmp1_b64 s[68:69], 10
    s_cbranch_scc0 HP_59
HR_58:
    buffer_load_dwordx4 v[164:167], v4, s[20:23], s45 offen sc1
    buffer_load_dwordx4 v[168:171], v5, s[20:23], s45 offen sc1
    v_mfma_f32_16x16x32_bf16 v[52:55], v[84:87], v[176:179], v[52:55]
    v_mfma_f32_16x16x32_bf16 v[40:43], v[88:91], v[172:175], v[40:43]
    v_mfma_f32_16x16x32_bf16 v[56:59], v[88:91], v[176:179], v[56:59]
    v_mfma_f32_16x16x32_bf16 v[44:47], v[92:95], v[172:175], v[44:47]
    v_mfma_f32_16x16x32_bf16 v[60:63], v[92:95], v[176:179], v[60:63]
    v_mfma_f32_16x16x32_bf16 v[48:51], v[96:99], v[172:175], v[48:51]
    v_mfma_f32_16x16x32_bf16 v[64:67], v[96:99], v[176:179], v[64:67]
    s_setprio 1
    s_waitcnt vmcnt(7)
    v_mfma_f32_16x16x32_bf16 v[36:39], v[100:103], v[180:183], v[36:39]
    s_bitcmp1_b64 s[68:69], 12
    s_cbranch_scc0 HP_61
HR_60:
    buffer_load_dwordx4 v[172:175], v4, s[20:23], s46 offen sc1
    buffer_load_dwordx4 v[176:179], v5, s[20:23], s46 offen sc1
    v_mfma_f32_16x16x32_bf16 v[52:55], v[100:103], v[184:187], v[52:55]
    v_mfma_f32_16x16x32_bf16 v[40:43], v[104:107], v[180:183], v[40:43]
    v_mfma_f32_16x16x32_bf16 v[56:59], v[104:107], v[184:187], v[56:59]
    v_mfma_f32_16x16x32_bf16 v[44:47], v[108:111], v[180:183], v[44:47]
    v_mfma_f32_16x16x32_bf16 v[60:63], v[108:111], v[184:187], v[60:63]
    v_mfma_f32_16x16x32_bf16 v[48:51], v[112:115], v[180:183], v[48:51]
    v_mfma_f32_16x16x32_bf16 v[64:67], v[112:115], v[184:187], v[64:67]
    s_setprio 3
    s_waitcnt vmcnt(7) lgkmcnt(0)
    s_barrier
    v_mfma_f32_16x16x32_bf16 v[36:39], v[116:119], v[188:191], v[36:39]
    s_bitcmp1_b64 s[68:69], 14
    s_cbranch_scc0 HP_63
HR_62:
    buffer_load_dwordx4 v[180:183], v4, s[20:23], s47 offen sc1
    buffer_load_dwordx4 v[184:187], v5, s[20:23], s47 offen sc1
    v_mfma_f32_16x16x32_bf16 v[52:55], v[116:119], v[192:195], v[52:55]
    v_mfma_f32_16x16x32_bf16 v[40:43], v[120:123], v[188:191], v[40:43]
    v_mfma_f32_16x16x32_bf16 v[56:59], v[120:123], v[192:195], v[56:59]
    v_mfma_f32_16x16x32_bf16 v[44:47], v[124:127], v[188:191], v[44:47]
    v_mfma_f32_16x16x32_bf16 v[60:63], v[124:127], v[192:195], v[60:63]
    v_mfma_f32_16x16x32_bf16 v[48:51], v[128:131], v[188:191], v[48:51]
    v_mfma_f32_16x16x32_bf16 v[64:67], v[128:131], v[192:195], v[64:67]
    s_waitcnt vmcnt(6)
    v_mfma_f32_16x16x32_bf16 v[36:39], v[132:135], v[196:199], v[36:39]
    ds_read_b64_tr_b16 v[68:69], v8 offset:32768
    s_bitcmp1_b64 s[68:69], 16
    s_cbranch_scc0 HP_65
HR_64:
    buffer_load_dwordx4 v[188:191], v4, s[20:23], s48 offen sc1
    buffer_load_dwordx4 v[192:195], v5, s[20:23], s48 offen sc1
    v_mfma_f32_16x16x32_bf16 v[52:55], v[132:135], v[200:203], v[52:55]
    ds_read_b64_tr_b16 v[70:71], v8 offset:34816
    v_mfma_f32_16x16x32_bf16 v[40:43], v[136:139], v[196:199], v[40:43]
    ds_read_b64_tr_b16 v[72:73], v9 offset:32768
    v_mfma_f32_16x16x32_bf16 v[56:59], v[136:139], v[200:203], v[56:59]
    ds_read_b64_tr_b16 v[74:75], v9 offset:34816
    v_mfma_f32_16x16x32_bf16 v[44:47], v[140:143], v[196:199], v[44:47]
    ds_read_b64_tr_b16 v[76:77], v10 offset:32768
    v_mfma_f32_16x16x32_bf16 v[60:63], v[140:143], v[200:203], v[60:63]
    ds_read_b64_tr_b16 v[78:79], v10 offset:34816
    v_mfma_f32_16x16x32_bf16 v[48:51], v[144:147], v[196:199], v[48:51]
    ds_read_b64_tr_b16 v[80:81], v11 offset:32768
    v_mfma_f32_16x16x32_bf16 v[64:67], v[144:147], v[200:203], v[64:67]
    ds_read_b64_tr_b16 v[82:83], v11 offset:34816
    s_setprio 2
    s_waitcnt vmcnt(6)
    v_mfma_f32_16x16x32_bf16 v[36:39], v[148:151], v[164:167], v[36:39]
    s_waitcnt vmcnt(10)
    v_cmp_ne_u32 vcc, 0, v2
    s_nop 0
    s_lshr_b64 s[68:69], vcc, 1
    s_and_b64 s[68:69], s[68:69], vcc
    ds_read_b64_tr_b16 v[84:85], v8 offset:49152
    s_bitcmp1_b64 s[68:69], 18
    s_cbranch_scc0 HP_67
HR_66:
    buffer_load_dwordx4 v[196:199], v4, s[20:23], s49 offen sc1
    buffer_load_dwordx4 v[200:203], v5, s[20:23], s49 offen sc1
    v_mfma_f32_16x16x32_bf16 v[52:55], v[148:151], v[168:171], v[52:55]
    ds_read_b64_tr_b16 v[86:87], v8 offset:51200
    v_mfma_f32_16x16x32_bf16 v[40:43], v[152:155], v[164:167], v[40:43]
    ds_read_b64_tr_b16 v[88:89], v9 offset:49152
    v_mfma_f32_16x16x32_bf16 v[56:59], v[152:155], v[168:171], v[56:59]
    ds_read_b64_tr_b16 v[90:91], v9 offset:51200
    v_mfma_f32_16x16x32_bf16 v[44:47], v[156:159], v[164:167], v[44:47]
    ds_read_b64_tr_b16 v[92:93], v10 offset:49152
    v_mfma_f32_16x16x32_bf16 v[60:63], v[156:159], v[168:171], v[60:63]
    ds_read_b64_tr_b16 v[94:95], v10 offset:51200
    v_mfma_f32_16x16x32_bf16 v[48:51], v[160:163], v[164:167], v[48:51]
    ds_read_b64_tr_b16 v[96:97], v11 offset:49152
    v_mfma_f32_16x16x32_bf16 v[64:67], v[160:163], v[168:171], v[64:67]
    ds_read_b64_tr_b16 v[98:99], v11 offset:51200
    s_waitcnt vmcnt(6) lgkmcnt(8)
    v_mfma_f32_16x16x32_bf16 v[36:39], v[68:71], v[172:175], v[36:39]
    ds_read_b64_tr_b16 v[100:101], v12 offset:0
    s_bitcmp1_b64 s[68:69], 20
    s_cbranch_scc0 HP_69
HR_68:
    buffer_load_dwordx4 v[164:167], v4, s[20:23], s50 offen sc1
    buffer_load_dwordx4 v[168:171], v5, s[20:23], s50 offen sc1
    v_mfma_f32_16x16x32_bf16 v[52:55], v[68:71], v[176:179], v[52:55]
    ds_read_b64_tr_b16 v[102:103], v12 offset:2048
    v_mfma_f32_16x16x32_bf16 v[40:43], v[72:75], v[172:175], v[40:43]
    ds_read_b64_tr_b16 v[104:105], v13 offset:0
    v_mfma_f32_16x16x32_bf16 v[56:59], v[72:75], v[176:179], v[56:59]
    ds_read_b64_tr_b16 v[106:107], v13 offset:2048
    v_mfma_f32_16x16x32_bf16 v[44:47], v[76:79], v[172:175], v[44:47]
    ds_read_b64_tr_b16 v[108:109], v14 offset:0
    v_mfma_f32_16x16x32_bf16 v[60:63], v[76:79], v[176:179], v[60:63]
    ds_read_b64_tr_b16 v[110:111], v14 offset:2048
    v_mfma_f32_16x16x32_bf16 v[48:51], v[80:83], v[172:175], v[48:51]
    ds_read_b64_tr_b16 v[112:113], v15 offset:0
    v_mfma_f32_16x16x32_bf16 v[64:67], v[80:83], v[176:179], v[64:67]
    ds_read_b64_tr_b16 v[114:115], v15 offset:2048
    s_setprio 1
    s_waitcnt vmcnt(6) lgkmcnt(8)
    v_mfma_f32_16x16x32_bf16 v[36:39], v[84:87], v[180:183], v[36:39]
    ds_read_b64_tr_b16 v[116:117], v12 offset:16384
    s_bitcmp1_b64 s[68:69], 22
    s_cbranch_scc0 HP_71
HR_70:
    buffer_load_dwordx4 v[172:175], v4, s[20:23], s51 offen sc1
    buffer_load_dwordx4 v[176:179], v5, s[20:23], s51 offen sc1
    v_mfma_f32_16x16x32_bf16 v[52:55], v[84:87], v[184:187], v[52:55]
    ds_read_b64_tr_b16 v[118:119], v12 offset:18432
    v_mfma_f32_16x16x32_bf16 v[40:43], v[88:91], v[180:183], v[40:43]
    ds_read_b64_tr_b16 v[120:121], v13 offset:16384
    v_mfma_f32_16x16x32_bf16 v[56:59], v[88:91], v[184:187], v[56:59]
    ds_read_b64_tr_b16 v[122:123], v13 offset:18432
    v_mfma_f32_16x16x32_bf16 v[44:47], v[92:95], v[180:183], v[44:47]
    ds_read_b64_tr_b16 v[124:125], v14 offset:16384
    v_mfma_f32_16x16x32_bf16 v[60:63], v[92:95], v[184:187], v[60:63]
    ds_read_b64_tr_b16 v[126:127], v14 offset:18432
    v_mfma_f32_16x16x32_bf16 v[48:51], v[96:99], v[180:183], v[48:51]
    ds_read_b64_tr_b16 v[128:129], v15 offset:16384
    v_mfma_f32_16x16x32_bf16 v[64:67], v[96:99], v[184:187], v[64:67]
    ds_read_b64_tr_b16 v[130:131], v15 offset:18432
    s_setprio 0
    s_waitcnt vmcnt(6) lgkmcnt(8)
    v_mfma_f32_16x16x32_bf16 v[36:39], v[100:103], v[188:191], v[36:39]
    ds_read_b64_tr_b16 v[68:69], v20 offset:0
    s_bitcmp1_b64 s[68:69], 24
    s_cbranch_scc0 HP_73
HR_72:
    buffer_load_dwordx4 v[180:183], v4, s[20:23], s52 offen sc1
    buffer_load_dwordx4 v[184:187], v5, s[20:23], s52 offen sc1
    v_mfma_f32_16x16x32_bf16 v[52:55], v[100:103], v[192:195], v[52:55]
    ds_read_b64_tr_b16 v[70:71], v20 offset:2048
    v_mfma_f32_16x16x32_bf16 v[40:43], v[104:107], v[188:191], v[40:43]
    ds_read_b64_tr_b16 v[72:73], v21 offset:0
    v_mfma_f32_16x16x32_bf16 v[56:59], v[104:107], v[192:195], v[56:59]
    ds_read_b64_tr_b16 v[74:75], v21 offset:2048
    v_mfma_f32_16x16x32_bf16 v[44:47], v[108:111], v[188:191], v[44:47]
    ds_read_b64_tr_b16 v[76:77], v22 offset:0
    v_mfma_f32_16x16x32_bf16 v[60:63], v[108:111], v[192:195], v[60:63]
    ds_read_b64_tr_b16 v[78:79], v22 offset:2048
    v_mfma_f32_16x16x32_bf16 v[48:51], v[112:115], v[188:191], v[48:51]
    ds_read_b64_tr_b16 v[80:81], v23 offset:0
    v_mfma_f32_16x16x32_bf16 v[64:67], v[112:115], v[192:195], v[64:67]
    ds_read_b64_tr_b16 v[82:83], v23 offset:2048
    s_setprio 3
    s_waitcnt vmcnt(6) lgkmcnt(8)
    s_barrier
    v_mfma_f32_16x16x32_bf16 v[36:39], v[116:119], v[196:199], v[36:39]
    ds_read_b64_tr_b16 v[84:85], v20 offset:16384
    s_bitcmp1_b64 s[68:69], 26
    s_cbranch_scc0 HP_75
HR_74:
    buffer_load_dwordx4 v[188:191], v4, s[20:23], s53 offen sc1
    buffer_load_dwordx4 v[192:195], v5, s[20:23], s53 offen sc1
    v_mfma_f32_16x16x32_bf16 v[52:55], v[116:119], v[200:203], v[52:55]
    ds_read_b64_tr_b16 v[86:87], v20 offset:18432
    v_mfma_f32_16x16x32_bf16 v[40:43], v[120:123], v[196:199], v[40:43]
    ds_read_b64_tr_b16 v[88:89], v21 offset:16384
    s_add_u32 m0, s76, 131072
    s_mov_b32 s85, 0
    buffer_load_dwordx4 v31, s[12:15], s85 offen lds
    v_mfma_f32_16x16x32_bf16 v[56:59], v[120:123], v[200:203], v[56:59]
    ds_read_b64_tr_b16 v[90:91], v21 offset:18432
    s_add_u32 m0, s76, 132096
    s_mov_b32 s85, 8192
    buffer_load_dwordx4 v31, s[12:15], s85 offen lds
    v_mfma_f32_16x16x32_bf16 v[44:47], v[124:127], v[196:199], v[44:47]
    ds_read_b64_tr_b16 v[92:93], v22 offset:16384
    s_add_u32 m0, s76, 147456
    s_mov_b32 s85, 32768
    buffer_load_dwordx4 v31, s[12:15], s85 offen lds
    v_mfma_f32_16x16x32_bf16 v[60:63], v[124:127], v[200:203], v[60:63]
    ds_read_b64_tr_b16 v[94:95], v22 offset:18432
    s_add_u32 m0, s76, 148480
    s_mov_b32 s85, 40960
    buffer_load_dwordx4 v31, s[12:15], s85 offen lds
    v_mfma_f32_16x16x32_bf16 v[48:51], v[128:131], v[196:199], v[48:51]
    ds_read_b64_tr_b16 v[96:97], v23 offset:16384
    v_mfma_f32_16x16x32_bf16 v[64:67], v[128:131], v[200:203], v[64:67]
    ds_read_b64_tr_b16 v[98:99], v23 offset:18432
    s_setprio 2
    s_waitcnt vmcnt(10) lgkmcnt(8)
    v_mfma_f32_16x16x32_bf16 v[36:39], v[68:71], v[164:167], v[36:39]
    ds_read_b64_tr_b16 v[100:101], v20 offset:32768
    s_bitcmp1_b64 s[68:69], 28
    s_cbranch_scc0 HP_77
HR_76:
    buffer_load_dwordx4 v[196:199], v4, s[20:23], s54 offen sc1
    buffer_load_dwordx4 v[200:203], v5, s[20:23], s54 offen sc1
    v_mfma_f32_16x16x32_bf16 v[52:55], v[68:71], v[168:171], v[52:55]
    ds_read_b64_tr_b16 v[102:103], v20 offset:34816
    v_mfma_f32_16x16x32_bf16 v[40:43], v[72:75], v[164:167], v[40:43]
    ds_read_b64_tr_b16 v[104:105], v21 offset:32768
    v_mfma_f32_16x16x32_bf16 v[56:59], v[72:75], v[168:171], v[56:59]
    ds_read_b64_tr_b16 v[106:107], v21 offset:34816
    v_mfma_f32_16x16x32_bf16 v[44:47], v[76:79], v[164:167], v[44:47]
    ds_read_b64_tr_b16 v[108:109], v22 offset:32768
    v_mfma_f32_16x16x32_bf16 v[60:63], v[76:79], v[168:171], v[60:63]
    ds_read_b64_tr_b16 v[110:111], v22 offset:34816
    v_mfma_f32_16x16x32_bf16 v[48:51], v[80:83], v[164:167], v[48:51]
    ds_read_b64_tr_b16 v[112:113], v23 offset:32768
    v_mfma_f32_16x16x32_bf16 v[64:67], v[80:83], v[168:171], v[64:67]
    ds_read_b64_tr_b16 v[114:115], v23 offset:34816
    s_waitcnt vmcnt(10) lgkmcnt(8)
    v_mfma_f32_16x16x32_bf16 v[36:39], v[84:87], v[172:175], v[36:39]
    ds_read_b64_tr_b16 v[116:117], v20 offset:49152
    s_bitcmp1_b64 s[68:69], 30
    s_cbranch_scc0 HP_79
HR_78:
    buffer_load_dwordx4 v[164:167], v4, s[20:23], s55 offen sc1
    buffer_load_dwordx4 v[168:171], v5, s[20:23], s55 offen sc1
    v_mfma_f32_16x16x32_bf16 v[52:55], v[84:87], v[176:179], v[52:55]
    ds_read_b64_tr_b16 v[118:119], v20 offset:51200
    v_mfma_f32_16x16x32_bf16 v[40:43], v[88:91], v[172:175], v[40:43]
    ds_read_b64_tr_b16 v[120:121], v21 offset:49152
    v_mfma_f32_16x16x32_bf16 v[56:59], v[88:91], v[176:179], v[56:59]
    ds_read_b64_tr_b16 v[122:123], v21 offset:51200
    v_mfma_f32_16x16x32_bf16 v[44:47], v[92:95], v[172:175], v[44:47]
    ds_read_b64_tr_b16 v[124:125], v22 offset:49152
    buffer_load_dwordx4 v[26:29], v7, s[8:11], 0 offen
    v_mfma_f32_16x16x32_bf16 v[60:63], v[92:95], v[176:179], v[60:63]
    ds_read_b64_tr_b16 v[126:127], v22 offset:51200
    v_mfma_f32_16x16x32_bf16 v[48:51], v[96:99], v[172:175], v[48:51]
    ds_read_b64_tr_b16 v[128:129], v23 offset:49152
    v_mfma_f32_16x16x32_bf16 v[64:67], v[96:99], v[176:179], v[64:67]
    ds_read_b64_tr_b16 v[130:131], v23 offset:51200
    s_setprio 1
    s_waitcnt vmcnt(11) lgkmcnt(8)
    v_mfma_f32_16x16x32_bf16 v[36:39], v[100:103], v[180:183], v[36:39]
    ds_read_b64_tr_b16 v[68:69], v8 offset:0
    s_bitcmp1_b64 s[68:69], 32
    s_cbranch_scc0 HP_81
HR_80:
    buffer_load_dwordx4 v[172:175], v4, s[20:23], s59 offen sc1
    buffer_load_dwordx4 v[176:179], v5, s[20:23], s59 offen sc1
    v_mfma_f32_16x16x32_bf16 v[52:55], v[100:103], v[184:187], v[52:55]
    ds_read_b64_tr_b16 v[70:71], v8 offset:2048
    v_mfma_f32_16x16x32_bf16 v[40:43], v[104:107], v[180:183], v[40:43]
    ds_read_b64_tr_b16 v[72:73], v9 offset:0
    v_mfma_f32_16x16x32_bf16 v[56:59], v[104:107], v[184:187], v[56:59]
    ds_read_b64_tr_b16 v[74:75], v9 offset:2048
    v_mfma_f32_16x16x32_bf16 v[44:47], v[108:111], v[180:183], v[44:47]
    ds_read_b64_tr_b16 v[76:77], v10 offset:0
    v_mfma_f32_16x16x32_bf16 v[60:63], v[108:111], v[184:187], v[60:63]
    ds_read_b64_tr_b16 v[78:79], v10 offset:2048
    v_mfma_f32_16x16x32_bf16 v[48:51], v[112:115], v[180:183], v[48:51]
    ds_read_b64_tr_b16 v[80:81], v11 offset:0
    v_mfma_f32_16x16x32_bf16 v[64:67], v[112:115], v[184:187], v[64:67]
    ds_read_b64_tr_b16 v[82:83], v11 offset:2048
    s_setprio 0
    s_waitcnt vmcnt(11) lgkmcnt(8)
    v_mfma_f32_16x16x32_bf16 v[36:39], v[116:119], v[188:191], v[36:39]
    ds_read_b64_tr_b16 v[84:85], v8 offset:16384
    s_bitcmp1_b64 s[68:69], 34
    s_cbranch_scc0 HP_83
HR_82:
    buffer_load_dwordx4 v[180:183], v4, s[20:23], s60 offen sc1
    buffer_load_dwordx4 v[184:187], v5, s[20:23], s60 offen sc1
    v_mfma_f32_16x16x32_bf16 v[52:55], v[116:119], v[192:195], v[52:55]
    ds_read_b64_tr_b16 v[86:87], v8 offset:18432
    v_mfma_f32_16x16x32_bf16 v[40:43], v[120:123], v[188:191], v[40:43]
    ds_read_b64_tr_b16 v[88:89], v9 offset:16384
    v_mfma_f32_16x16x32_bf16 v[56:59], v[120:123], v[192:195], v[56:59]
    ds_read_b64_tr_b16 v[90:91], v9 offset:18432
    v_mfma_f32_16x16x32_bf16 v[44:47], v[124:127], v[188:191], v[44:47]
    ds_read_b64_tr_b16 v[92:93], v10 offset:16384
    v_mfma_f32_16x16x32_bf16 v[60:63], v[124:127], v[192:195], v[60:63]
    ds_read_b64_tr_b16 v[94:95], v10 offset:18432
    v_mfma_f32_16x16x32_bf16 v[48:51], v[128:131], v[188:191], v[48:51]
    ds_read_b64_tr_b16 v[96:97], v11 offset:16384
    v_mfma_f32_16x16x32_bf16 v[64:67], v[128:131], v[192:195], v[64:67]
    ds_read_b64_tr_b16 v[98:99], v11 offset:18432
    s_setprio 3
    s_waitcnt vmcnt(7) lgkmcnt(0)
    s_barrier
    v_mfma_f32_16x16x32_bf16 v[36:39], v[68:71], v[196:199], v[36:39]
    ds_read_b64_tr_b16 v[100:101], v12 offset:0
    v_mfma_f32_16x16x32_bf16 v[52:55], v[68:71], v[200:203], v[52:55]
    ds_read_b64_tr_b16 v[102:103], v12 offset:2048
    v_mfma_f32_16x16x32_bf16 v[40:43], v[72:75], v[196:199], v[40:43]
    ds_read_b64_tr_b16 v[104:105], v13 offset:0
    v_mfma_f32_16x16x32_bf16 v[56:59], v[72:75], v[200:203], v[56:59]
    ds_read_b64_tr_b16 v[106:107], v13 offset:2048
    v_mfma_f32_16x16x32_bf16 v[44:47], v[76:79], v[196:199], v[44:47]
    ds_read_b64_tr_b16 v[108:109], v14 offset:0
    v_mfma_f32_16x16x32_bf16 v[60:63], v[76:79], v[200:203], v[60:63]
    ds_read_b64_tr_b16 v[110:111], v14 offset:2048
    v_mfma_f32_16x16x32_bf16 v[48:51], v[80:83], v[196:199], v[48:51]
    ds_read_b64_tr_b16 v[112:113], v15 offset:0
    v_mfma_f32_16x16x32_bf16 v[64:67], v[80:83], v[200:203], v[64:67]
    ds_read_b64_tr_b16 v[114:115], v15 offset:2048
    s_setprio 2
    s_waitcnt vmcnt(5) lgkmcnt(8)
    v_mfma_f32_16x16x32_bf16 v[36:39], v[84:87], v[164:167], v[36:39]
    ds_read_b64_tr_b16 v[116:117], v12 offset:16384
    v_mfma_f32_16x16x32_bf16 v[52:55], v[84:87], v[168:171], v[52:55]
    ds_read_b64_tr_b16 v[118:119], v12 offset:18432
    v_mfma_f32_16x16x32_bf16 v[40:43], v[88:91], v[164:167], v[40:43]
    ds_read_b64_tr_b16 v[120:121], v13 offset:16384
    v_mfma_f32_16x16x32_bf16 v[56:59], v[88:91], v[168:171], v[56:59]
    ds_read_b64_tr_b16 v[122:123], v13 offset:18432
    v_mfma_f32_16x16x32_bf16 v[44:47], v[92:95], v[164:167], v[44:47]
    ds_read_b64_tr_b16 v[124:125], v14 offset:16384
    v_mfma_f32_16x16x32_bf16 v[60:63], v[92:95], v[168:171], v[60:63]
    ds_read_b64_tr_b16 v[126:127], v14 offset:18432
    v_mfma_f32_16x16x32_bf16 v[48:51], v[96:99], v[164:167], v[48:51]
    ds_read_b64_tr_b16 v[128:129], v15 offset:16384
    v_mfma_f32_16x16x32_bf16 v[64:67], v[96:99], v[168:171], v[64:67]
    ds_read_b64_tr_b16 v[130:131], v15 offset:18432
    s_setprio 1
    s_waitcnt vmcnt(2)
    s_waitcnt lgkmcnt(0)
    s_cmp_eq_u32 s77, 0
    s_cbranch_scc1 TL_84
    v_mfma_f32_16x16x32_bf16 v[36:39], v[100:103], v[172:175], v[36:39]
    v_mfma_f32_16x16x32_bf16 v[52:55], v[100:103], v[176:179], v[52:55]
    v_mfma_f32_16x16x32_bf16 v[40:43], v[104:107], v[172:175], v[40:43]
    v_mfma_f32_16x16x32_bf16 v[56:59], v[104:107], v[176:179], v[56:59]
    v_mfma_f32_16x16x32_bf16 v[44:47], v[108:111], v[172:175], v[44:47]
    v_mfma_f32_16x16x32_bf16 v[60:63], v[108:111], v[176:179], v[60:63]
    v_mfma_f32_16x16x32_bf16 v[48:51], v[112:115], v[172:175], v[48:51]
    v_mfma_f32_16x16x32_bf16 v[64:67], v[112:115], v[176:179], v[64:67]
    s_branch TL_85
TL_84:
    v_mfma_f32_16x16x32_bf16 v[220:223], v[100:103], v[172:175], 0
    v_mfma_f32_16x16x32_bf16 v[236:239], v[100:103], v[176:179], 0
    v_mfma_f32_16x16x32_bf16 v[224:227], v[104:107], v[172:175], 0
    v_mfma_f32_16x16x32_bf16 v[240:243], v[104:107], v[176:179], 0
    v_mfma_f32_16x16x32_bf16 v[228:231], v[108:111], v[172:175], 0
    v_mfma_f32_16x16x32_bf16 v[244:247], v[108:111], v[176:179], 0
    v_mfma_f32_16x16x32_bf16 v[232:235], v[112:115], v[172:175], 0
    v_mfma_f32_16x16x32_bf16 v[248:251], v[112:115], v[176:179], 0
TL_85:
    s_setprio 0
    s_waitcnt vmcnt(0)
    s_cmp_eq_u32 s77, 0
    s_cbranch_scc1 TL_86
    v_mfma_f32_16x16x32_bf16 v[36:39], v[116:119], v[180:183], v[36:39]
    v_mfma_f32_16x16x32_bf16 v[52:55], v[116:119], v[184:187], v[52:55]
    v_mfma_f32_16x16x32_bf16 v[40:43], v[120:123], v[180:183], v[40:43]
    v_mfma_f32_16x16x32_bf16 v[56:59], v[120:123], v[184:187], v[56:59]
    v_mfma_f32_16x16x32_bf16 v[44:47], v[124:127], v[180:183], v[44:47]
    v_mfma_f32_16x16x32_bf16 v[60:63], v[124:127], v[184:187], v[60:63]
    v_mfma_f32_16x16x32_bf16 v[48:51], v[128:131], v[180:183], v[48:51]
    v_mfma_f32_16x16x32_bf16 v[64:67], v[128:131], v[184:187], v[64:67]
    s_branch TL_87
TL_86:
    v_mfma_f32_16x16x32_bf16 v[220:223], v[116:119], v[180:183], v[220:223]
    ds_write_b128 v16, v[36:39] offset:0
    v_mfma_f32_16x16x32_bf16 v[236:239], v[116:119], v[184:187], v[236:239]
    ds_write_b128 v16, v[52:55] offset:4352
    v_mfma_f32_16x16x32_bf16 v[224:227], v[120:123], v[180:183], v[224:227]
    ds_write_b128 v16, v[40:43] offset:64
    v_mfma_f32_16x16x32_bf16 v[240:243], v[120:123], v[184:187], v[240:243]
    ds_write_b128 v16, v[56:59] offset:4416
    v_mfma_f32_16x16x32_bf16 v[228:231], v[124:127], v[180:183], v[228:231]
    ds_write_b128 v16, v[44:47] offset:128
    v_mfma_f32_16x16x32_bf16 v[244:247], v[124:127], v[184:187], v[244:247]
    ds_write_b128 v16, v[60:63] offset:4480
    v_mfma_f32_16x16x32_bf16 v[232:235], v[128:131], v[180:183], v[232:235]
    ds_write_b128 v16, v[48:51] offset:192
    v_mfma_f32_16x16x32_bf16 v[248:251], v[128:131], v[184:187], v[248:251]
    ds_write_b128 v16, v[64:67] offset:4544
TL_87:
    s_waitcnt vmcnt(0)
    v_lshlrev_b32 v140, 16, v26
    v_and_b32 v141, 0xffff0000, v26
    v_lshlrev_b32 v142, 16, v27
    v_and_b32 v143, 0xffff0000, v27
    v_lshlrev_b32 v144, 16, v28
    v_and_b32 v145, 0xffff0000, v28
    v_lshlrev_b32 v146, 16, v29
    v_and_b32 v147, 0xffff0000, v29
    s_cmp_eq_u32 s77, 0
    s_cbranch_scc1 TL_88
    ds_write_b128 v16, v[36:39] offset:0
    ds_write_b128 v16, v[52:55] offset:4352
    ds_write_b128 v16, v[40:43] offset:64
    ds_write_b128 v16, v[56:59] offset:4416
    ds_write_b128 v16, v[44:47] offset:128
    ds_write_b128 v16, v[60:63] offset:4480
    ds_write_b128 v16, v[48:51] offset:192
    ds_write_b128 v16, v[64:67] offset:4544
    s_branch TL_89
TL_88:
    ds_write_b128 v19, v[220:223] offset:0
    ds_write_b128 v19, v[236:239] offset:4352
    ds_write_b128 v19, v[224:227] offset:64
    ds_write_b128 v19, v[240:243] offset:4416
    ds_write_b128 v19, v[228:231] offset:128
    ds_write_b128 v19, v[244:247] offset:4480
    ds_write_b128 v19, v[232:235] offset:192
    ds_write_b128 v19, v[248:251] offset:4544
TL_89:
    s_waitcnt lgkmcnt(0)
    s_barrier
    ds_read_b128 v[76:79], v17 offset:17408
    ds_read_b128 v[80:83], v17 offset:17424
    ds_read_b128 v[84:87], v17 offset:34816
    ds_read_b128 v[88:91], v17 offset:34832
    ds_read_b128 v[92:95], v17 offset:52224
    ds_read_b128 v[96:99], v17 offset:52240
    ds_read_b128 v[100:103], v18 offset:0
    ds_read_b128 v[104:107], v18 offset:16
    ds_read_b128 v[68:71], v17 offset:0
    ds_read_b128 v[72:75], v17 offset:16
    s_waitcnt lgkmcnt(6)
    v_add_f32 v76, v76, v84
    v_add_f32 v77, v77, v85
    v_add_f32 v78, v78, v86
    v_add_f32 v79, v79, v87
    v_add_f32 v80, v80, v88
    v_add_f32 v81, v81, v89
    v_add_f32 v82, v82, v90
    v_add_f32 v83, v83, v91
    s_waitcnt lgkmcnt(2)
    v_add_f32 v92, v92, v100
    v_add_f32 v93, v93, v101
    v_add_f32 v94, v94, v102
    v_add_f32 v95, v95, v103
    v_add_f32 v96, v96, v104
    v_add_f32 v97, v97, v105
    v_add_f32 v98, v98, v106
    v_add_f32 v99, v99, v107
    v_add_f32 v76, v76, v92
    v_add_f32 v77, v77, v93
    v_add_f32 v78, v78, v94
    v_add_f32 v79, v79, v95
    v_add_f32 v80, v80, v96
    v_add_f32 v81, v81, v97
    v_add_f32 v82, v82, v98
    v_add_f32 v83, v83, v99
    v_mul_f32 v132, s57, v76
    v_mul_f32 v133, s57, v77
    v_mul_f32 v134, s57, v78
    v_mul_f32 v135, s57, v79
    v_mul_f32 v136, s57, v80
    v_mul_f32 v137, s57, v81
    v_mul_f32 v138, s57, v82
    v_mul_f32 v139, s57, v83
    v_exp_f32 v132, v132
    v_exp_f32 v133, v133
    v_exp_f32 v134, v134
    v_exp_f32 v135, v135
    v_exp_f32 v136, v136
    v_exp_f32 v137, v137
    v_exp_f32 v138, v138
    v_exp_f32 v139, v139
    s_waitcnt lgkmcnt(0)
    v_mul_f32 v68, v68, v76
    v_mul_f32 v69, v69, v77
    v_mul_f32 v70, v70, v78
    v_mul_f32 v71, v71, v79
    v_mul_f32 v72, v72, v80
    v_mul_f32 v73, v73, v81
    v_mul_f32 v74, v74, v82
    v_mul_f32 v75, v75, v83
    v_add_f32 v132, 1.0, v132
    v_add_f32 v133, 1.0, v133
    v_add_f32 v134, 1.0, v134
    v_add_f32 v135, 1.0, v135
    v_add_f32 v136, 1.0, v136
    v_add_f32 v137, 1.0, v137
    v_add_f32 v138, 1.0, v138
    v_add_f32 v139, 1.0, v139
    v_rcp_f32 v132, v132
    v_rcp_f32 v133, v133
    v_rcp_f32 v134, v134
    v_rcp_f32 v135, v135
    v_rcp_f32 v136, v136
    v_rcp_f32 v137, v137
    v_rcp_f32 v138, v138
    v_rcp_f32 v139, v139
    v_fmac_f32 v140, v68, v132
    v_fmac_f32 v141, v69, v133
    v_fmac_f32 v142, v70, v134
    v_fmac_f32 v143, v71, v135
    v_fmac_f32 v144, v72, v136
    v_fmac_f32 v145, v73, v137
    v_fmac_f32 v146, v74, v138
    v_fmac_f32 v147, v75, v139
    v_cvt_pk_bf16_f32 v26, v140, v141
    v_cvt_pk_bf16_f32 v27, v142, v143
    v_cvt_pk_bf16_f32 v28, v144, v145
    v_cvt_pk_bf16_f32 v29, v146, v147
    buffer_store_dwordx4 v[26:29], v7, s[16:19], 0 offen sc1 nt
K_exit:
    s_endpgm
HP_49:
    s_mov_b32 s98, 0
HP_49l:
    buffer_load_dword v2, v6, s[24:27], 0 offen sc1
    s_waitcnt vmcnt(0)
    v_cmp_ne_u32 vcc, 0, v2
    s_nop 0
    s_lshr_b64 s[68:69], vcc, 1
    s_and_b64 s[68:69], s[68:69], vcc
    s_add_u32 s98, s98, 1
    s_cmp_ge_u32 s98, 100000
    s_cbranch_scc1 HR_48
    s_bitcmp1_b64 s[68:69], 0
    s_cbranch_scc0 HP_49l
    s_branch HR_48
HP_51:
    s_mov_b32 s98, 0
HP_51l:
    buffer_load_dword v2, v6, s[24:27], 0 offen sc1
    s_waitcnt vmcnt(0)
    v_cmp_ne_u32 vcc, 0, v2
    s_nop 0
    s_lshr_b64 s[68:69], vcc, 1
    s_and_b64 s[68:69], s[68:69], vcc
    s_add_u32 s98, s98, 1
    s_cmp_ge_u32 s98, 100000
    s_cbranch_scc1 HR_50
    s_bitcmp1_b64 s[68:69], 2
    s_cbranch_scc0 HP_51l
    s_branch HR_50
HP_53:
    s_mov_b32 s98, 0
HP_53l:
    buffer_load_dword v2, v6, s[24:27], 0 offen sc1
    s_waitcnt vmcnt(0)
    v_cmp_ne_u32 vcc, 0, v2
    s_nop 0
    s_lshr_b64 s[68:69], vcc, 1
    s_and_b64 s[68:69], s[68:69], vcc
    s_add_u32 s98, s98, 1
    s_cmp_ge_u32 s98, 100000
    s_cbranch_scc1 HR_52
    s_bitcmp1_b64 s[68:69], 4
    s_cbranch_scc0 HP_53l
    s_branch HR_52
HP_55:
    s_mov_b32 s98, 0
HP_55l:
    buffer_load_dword v2, v6, s[24:27], 0 offen sc1
    s_waitcnt vmcnt(0)
    v_cmp_ne_u32 vcc, 0, v2
    s_nop 0
    s_lshr_b64 s[68:69], vcc, 1
    s_and_b64 s[68:69], s[68:69], vcc
    s_add_u32 s98, s98, 1
    s_cmp_ge_u32 s98, 100000
    s_cbranch_scc1 HR_54
    s_bitcmp1_b64 s[68:69], 6
    s_cbranch_scc0 HP_55l
    s_branch HR_54
HP_57:
    s_mov_b32 s98, 0
HP_57l:
    buffer_load_dword v2, v6, s[24:27], 0 offen sc1
    s_waitcnt vmcnt(0)
    v_cmp_ne_u32 vcc, 0, v2
    s_nop 0
    s_lshr_b64 s[68:69], vcc, 1
    s_and_b64 s[68:69], s[68:69], vcc
    s_add_u32 s98, s98, 1
    s_cmp_ge_u32 s98, 100000
    s_cbranch_scc1 HR_56
    s_bitcmp1_b64 s[68:69], 8
    s_cbranch_scc0 HP_57l
    s_branch HR_56
HP_59:
    s_mov_b32 s98, 0
HP_59l:
    buffer_load_dword v2, v6, s[24:27], 0 offen sc1
    s_waitcnt vmcnt(0)
    v_cmp_ne_u32 vcc, 0, v2
    s_nop 0
    s_lshr_b64 s[68:69], vcc, 1
    s_and_b64 s[68:69], s[68:69], vcc
    s_add_u32 s98, s98, 1
    s_cmp_ge_u32 s98, 100000
    s_cbranch_scc1 HR_58
    s_bitcmp1_b64 s[68:69], 10
    s_cbranch_scc0 HP_59l
    s_branch HR_58
HP_61:
    s_mov_b32 s98, 0
HP_61l:
    buffer_load_dword v2, v6, s[24:27], 0 offen sc1
    s_waitcnt vmcnt(0)
    v_cmp_ne_u32 vcc, 0, v2
    s_nop 0
    s_lshr_b64 s[68:69], vcc, 1
    s_and_b64 s[68:69], s[68:69], vcc
    s_add_u32 s98, s98, 1
    s_cmp_ge_u32 s98, 100000
    s_cbranch_scc1 HR_60
    s_bitcmp1_b64 s[68:69], 12
    s_cbranch_scc0 HP_61l
    s_branch HR_60
HP_63:
    s_mov_b32 s98, 0
HP_63l:
    buffer_load_dword v2, v6, s[24:27], 0 offen sc1
    s_waitcnt vmcnt(0)
    v_cmp_ne_u32 vcc, 0, v2
    s_nop 0
    s_lshr_b64 s[68:69], vcc, 1
    s_and_b64 s[68:69], s[68:69], vcc
    s_add_u32 s98, s98, 1
    s_cmp_ge_u32 s98, 100000
    s_cbranch_scc1 HR_62
    s_bitcmp1_b64 s[68:69], 14
    s_cbranch_scc0 HP_63l
    s_branch HR_62
HP_65:
    s_mov_b32 s98, 0
HP_65l:
    buffer_load_dword v2, v6, s[24:27], 0 offen sc1
    s_waitcnt vmcnt(0)
    v_cmp_ne_u32 vcc, 0, v2
    s_nop 0
    s_lshr_b64 s[68:69], vcc, 1
    s_and_b64 s[68:69], s[68:69], vcc
    s_add_u32 s98, s98, 1
    s_cmp_ge_u32 s98, 100000
    s_cbranch_scc1 HR_64
    s_bitcmp1_b64 s[68:69], 16
    s_cbranch_scc0 HP_65l
    s_branch HR_64
HP_67:
    s_mov_b32 s98, 0
HP_67l:
    buffer_load_dword v2, v6, s[24:27], 0 offen sc1
    s_waitcnt vmcnt(0)
    v_cmp_ne_u32 vcc, 0, v2
    s_nop 0
    s_lshr_b64 s[68:69], vcc, 1
    s_and_b64 s[68:69], s[68:69], vcc
    s_add_u32 s98, s98, 1
    s_cmp_ge_u32 s98, 100000
    s_cbranch_scc1 HR_66
    s_bitcmp1_b64 s[68:69], 18
    s_cbranch_scc0 HP_67l
    s_branch HR_66
HP_69:
    s_mov_b32 s98, 0
HP_69l:
    buffer_load_dword v2, v6, s[24:27], 0 offen sc1
    s_waitcnt vmcnt(0)
    v_cmp_ne_u32 vcc, 0, v2
    s_nop 0
    s_lshr_b64 s[68:69], vcc, 1
    s_and_b64 s[68:69], s[68:69], vcc
    s_add_u32 s98, s98, 1
    s_cmp_ge_u32 s98, 100000
    s_cbranch_scc1 HR_68
    s_bitcmp1_b64 s[68:69], 20
    s_cbranch_scc0 HP_69l
    s_branch HR_68
HP_71:
    s_mov_b32 s98, 0
HP_71l:
    buffer_load_dword v2, v6, s[24:27], 0 offen sc1
    s_waitcnt vmcnt(0)
    v_cmp_ne_u32 vcc, 0, v2
    s_nop 0
    s_lshr_b64 s[68:69], vcc, 1
    s_and_b64 s[68:69], s[68:69], vcc
    s_add_u32 s98, s98, 1
    s_cmp_ge_u32 s98, 100000
    s_cbranch_scc1 HR_70
    s_bitcmp1_b64 s[68:69], 22
    s_cbranch_scc0 HP_71l
    s_branch HR_70
HP_73:
    s_mov_b32 s98, 0
HP_73l:
    buffer_load_dword v2, v6, s[24:27], 0 offen sc1
    s_waitcnt vmcnt(0)
    v_cmp_ne_u32 vcc, 0, v2
    s_nop 0
    s_lshr_b64 s[68:69], vcc, 1
    s_and_b64 s[68:69], s[68:69], vcc
    s_add_u32 s98, s98, 1
    s_cmp_ge_u32 s98, 100000
    s_cbranch_scc1 HR_72
    s_bitcmp1_b64 s[68:69], 24
    s_cbranch_scc0 HP_73l
    s_branch HR_72
HP_75:
    s_mov_b32 s98, 0
HP_75l:
    buffer_load_dword v2, v6, s[24:27], 0 offen sc1
    s_waitcnt vmcnt(0)
    v_cmp_ne_u32 vcc, 0, v2
    s_nop 0
    s_lshr_b64 s[68:69], vcc, 1
    s_and_b64 s[68:69], s[68:69], vcc
    s_add_u32 s98, s98, 1
    s_cmp_ge_u32 s98, 100000
    s_cbranch_scc1 HR_74
    s_bitcmp1_b64 s[68:69], 26
    s_cbranch_scc0 HP_75l
    s_branch HR_74
HP_77:
    s_mov_b32 s98, 0
HP_77l:
    buffer_load_dword v2, v6, s[24:27], 0 offen sc1
    s_waitcnt vmcnt(0)
    v_cmp_ne_u32 vcc, 0, v2
    s_nop 0
    s_lshr_b64 s[68:69], vcc, 1
    s_and_b64 s[68:69], s[68:69], vcc
    s_add_u32 s98, s98, 1
    s_cmp_ge_u32 s98, 100000
    s_cbranch_scc1 HR_76
    s_bitcmp1_b64 s[68:69], 28
    s_cbranch_scc0 HP_77l
    s_branch HR_76
HP_79:
    s_mov_b32 s98, 0
HP_79l:
    buffer_load_dword v2, v6, s[24:27], 0 offen sc1
    s_waitcnt vmcnt(0)
    v_cmp_ne_u32 vcc, 0, v2
    s_nop 0
    s_lshr_b64 s[68:69], vcc, 1
    s_and_b64 s[68:69], s[68:69], vcc
    s_add_u32 s98, s98, 1
    s_cmp_ge_u32 s98, 100000
    s_cbranch_scc1 HR_78
    s_bitcmp1_b64 s[68:69], 30
    s_cbranch_scc0 HP_79l
    s_branch HR_78
HP_81:
    s_mov_b32 s98, 0
HP_81l:
    buffer_load_dword v2, v6, s[24:27], 0 offen sc1
    s_waitcnt vmcnt(0)
    v_cmp_ne_u32 vcc, 0, v2
    s_nop 0
    s_lshr_b64 s[68:69], vcc, 1
    s_and_b64 s[68:69], s[68:69], vcc
    s_add_u32 s98, s98, 1
    s_cmp_ge_u32 s98, 100000
    s_cbranch_scc1 HR_80
    s_bitcmp1_b64 s[68:69], 32
    s_cbranch_scc0 HP_81l
    s_branch HR_80
HP_83:
    s_mov_b32 s98, 0
HP_83l:
    buffer_load_dword v2, v6, s[24:27], 0 offen sc1
    s_waitcnt vmcnt(0)
    v_cmp_ne_u32 vcc, 0, v2
    s_nop 0
    s_lshr_b64 s[68:69], vcc, 1
    s_and_b64 s[68:69], s[68:69], vcc
    s_add_u32 s98, s98, 1
    s_cmp_ge_u32 s98, 100000
    s_cbranch_scc1 HR_82
    s_bitcmp1_b64 s[68:69], 34
    s_cbranch_scc0 HP_83l
    s_branch HR_82
K_end:
.section .rodata,"a"
.p2align 6
.amdhsa_kernel recurrent_scan__sliding_local_dilated__glu_gated_glu__prompt_kernel
  .amdhsa_next_free_vgpr 256
  .amdhsa_next_free_sgpr 102
  .amdhsa_accum_offset 256
  .amdhsa_group_segment_fixed_size 0
  .amdhsa_kernarg_size 80
  .amdhsa_user_sgpr_count 2
  .amdhsa_user_sgpr_kernarg_segment_ptr 1
  .amdhsa_system_sgpr_workgroup_id_x 1
  .amdhsa_float_denorm_mode_32 3
.end_amdhsa_kernel
```
